```python
import torch

def _softmax(x, axis=-1):
    return torch.softmax(x, dim=axis)
def _gelu(x):
    return torch.nn.functional.gelu(x, approximate="tanh")
def _silu(x):
    return torch.nn.functional.silu(x)
def _sigmoid(x):
    return torch.sigmoid(x)
def _layernorm(x, axis=-1, eps=1e-5):
    m = x.mean(dim=axis, keepdim=True)
    v = x.var(dim=axis, keepdim=True, unbiased=False)
    return (x - m) / torch.sqrt(v + eps)
def _scatter_add(tgt, idx, src, axis=0):
    return tgt.clone().index_add_(axis, idx, src)
def _segment_sum(src, seg, n):
    out = torch.zeros((n,) + src.shape[1:], dtype=src.dtype)
    return out.index_add_(0, seg, src)
def _pad(x, pw):
    flat = tuple(v for pair in reversed(pw) for v in pair)
    return torch.nn.functional.pad(x, flat)

kernel_name = 'parallel_sum__mha_block__glu_gated_swiglu__prompt'

def setup_inputs():

    _w = (lambda a: (lambda t: t.to(torch.bfloat16) if t.is_floating_point() else t)(torch.as_tensor(a)))
    def _A_setup():
        B, S, D, H = 1, 2048, 576, 32
        return {
            "x": _w((lambda *s: torch.randn(*s, dtype=torch.bfloat16) * 0.05)(B, S, D)),
            "wqkv": _w((lambda *s: torch.randn(*s, dtype=torch.bfloat16) * 0.05)(D, 3 * D)),
            "wo": _w((lambda *s: torch.randn(*s, dtype=torch.bfloat16) * 0.05)(D, D)),
        }
    _A_in = _A_setup()

    def _B_setup():
        B, S, D, F = 1, 2048, 576, 4608
        return {
            "x": _w((lambda *s: torch.randn(*s, dtype=torch.bfloat16) * 0.05)(B, S, D)),
            "w1": _w((lambda *s: torch.randn(*s, dtype=torch.bfloat16) * 0.4)(D, F) * (2.0 / D) ** 0.5),
            "w3": _w((lambda *s: torch.randn(*s, dtype=torch.bfloat16) * 0.4)(D, F) * (2.0 / D) ** 0.5),
            "w2": _w((lambda *s: torch.randn(*s, dtype=torch.bfloat16) * 0.4)(F, D) * (2.0 / F) ** 0.5),
        }
    _B_in = _B_setup()

    return {
        "A_x": _A_in["x"],
        "A_wqkv": _A_in["wqkv"],
        "A_wo": _A_in["wo"],
        "B_x": _B_in["x"],
        "B_w1": _B_in["w1"],
        "B_w3": _B_in["w3"],
        "B_w2": _B_in["w2"],
    }

def reference(A_x, A_wqkv, A_wo, B_x, B_w1, B_w3, B_w2):
    def _A_ref(x, wqkv, wo):
        B, S, D = x.shape
        H = 32
        Dh = D // H
        qkv = (lambda x, *d: x.permute(*d))((x @ wqkv).reshape(B, S, 3, H, Dh), 2, 0, 3, 1, 4)
        q, k, v = qkv[0], qkv[1], qkv[2]
        scores = torch.einsum("bhqd,bhkd->bhqk", q, k) * (Dh ** -0.5)
        p = _softmax(scores, axis=-1)
        o = torch.einsum("bhqk,bhkd->bhqd", p, v)
        return (lambda x, *d: x.permute(*d))(o, 0, 2, 1, 3).reshape(B, S, D) @ wo

    def _B_ref(x, w1, w3, w2):
        gate = torch.einsum("bsd,df->bsf", x, w1)
        up = torch.einsum("bsd,df->bsf", x, w3)
        h = _silu(gate) * up
        out = torch.einsum("bsf,fd->bsd", h, w2)
        return out

    x = A_x
    xn = _layernorm(x, axis=-1)
    return x + _A_ref(xn, A_wqkv, A_wo) + _B_ref(xn, B_w1, B_w3, B_w2)
```

```asm
; @launch kernel=ln_kernel grid=(704,1,1) block=(256,1,1) lds=0
; @launch kernel=gemm1_kernel grid=(256,1,1) block=(512,1,1) lds=163840
; @launch kernel=attn_kernel grid=(512,1,1) block=(512,1,1) lds=77824
; @launch kernel=fin_kernel grid=(192,1,1) block=(256,1,1) lds=135168
.amdgcn_target "amdgcn-amd-amdhsa--gfx950"
.text
  .globl ln_kernel
  .p2align 8
  .type ln_kernel,@function
ln_kernel:
  s_cmp_ge_u32 s2, 704
  s_cbranch_scc1 LN_END
  s_load_dwordx2 s[4:5], s[0:1], 0
  s_load_dwordx2 s[6:7], s[0:1], 72
  s_load_dwordx2 s[26:27], s[0:1], 8
  s_load_dwordx2 s[28:29], s[0:1], 32
  s_load_dwordx2 s[30:31], s[0:1], 40
  s_lshl_b32 s3, s2, 8
  v_add_u32 v1, s3, v0
  v_lshlrev_b32 v70, 5, v1
  v_lshrrev_b32 v2, 5, v1
  v_and_b32 v3, 31, v1
  s_movk_i32 s20, 1152
  v_mul_lo_u32 v4, v2, s20
  v_lshl_add_u32 v4, v3, 2, v4
  s_waitcnt lgkmcnt(0)

  s_mov_b32 s12, s6
  s_and_b32 s13, s7, 0xffff
  s_mov_b32 s14, 268435456
  s_mov_b32 s15, 0x00020000
  s_cmp_lt_u32 s2, 256
  s_cbranch_scc1 LN_MAIN
  s_cmp_lg_u32 s2, 256
  s_cbranch_scc1 LN_NZ
  v_lshlrev_b32 v60, 2, v0
  v_add_u32 v60, 49283072, v60
  v_mov_b32 v61, 0
  buffer_store_dword v61, v60, s[12:15], 0 offen
LN_NZ:

  v_subrev_u32 v30, 65536, v1
  s_mov_b32 s21, 1198373
  v_mul_hi_u32 v31, v30, s21
  s_movk_i32 s21, 3584
  v_mul_lo_u32 v32, v31, s21
  v_sub_u32 v32, v30, v32
  v_lshrrev_b32 v33, 8, v32
  v_and_b32 v34, 255, v32
  v_add_u32 v33, 18, v33
  v_lshl_add_u32 v35, v31, 5, v33
  v_lshlrev_b32 v35, 12, v35
  v_lshl_add_u32 v35, v34, 4, v35
  v_add_u32 v35, 12582912, v35
  v_cmp_eq_u32 vcc, 18, v33
  v_cmp_eq_u32 s[22:23], 22, v33
  s_or_b64 vcc, vcc, s[22:23]
  v_mov_b32 v36, 0x3f803f80
  s_nop 1
  v_cndmask_b32 v44, 0, v36, vcc
  v_mov_b32 v45, v44
  v_mov_b32 v46, v44
  v_mov_b32 v47, v44
  v_cmp_gt_u32 vcc, 114688, v30
  s_and_saveexec_b64 s[24:25], vcc
  s_cbranch_execz LN_END
  buffer_store_dwordx4 v[44:47], v35, s[12:15], 0 offen
  s_branch LN_END
LN_MAIN:

  s_mov_b32 s8, s4
  s_and_b32 s9, s5, 0xffff
  s_mov_b32 s10, 2359296
  s_mov_b32 s11, 0x00020000
  buffer_load_dword v10, v4, s[8:11], 0 offen offset:0
  buffer_load_dword v11, v4, s[8:11], 0 offen offset:128
  buffer_load_dword v12, v4, s[8:11], 0 offen offset:256
  buffer_load_dword v13, v4, s[8:11], 0 offen offset:384
  buffer_load_dword v14, v4, s[8:11], 0 offen offset:512
  buffer_load_dword v15, v4, s[8:11], 0 offen offset:640
  buffer_load_dword v16, v4, s[8:11], 0 offen offset:768
  buffer_load_dword v17, v4, s[8:11], 0 offen offset:896
  buffer_load_dword v18, v4, s[8:11], 0 offen offset:1024
  s_waitcnt vmcnt(0)
  v_lshlrev_b32 v50, 16, v10
  v_and_b32 v51, 0xffff0000, v10
  v_lshlrev_b32 v52, 16, v11
  v_and_b32 v53, 0xffff0000, v11
  v_lshlrev_b32 v54, 16, v12
  v_and_b32 v55, 0xffff0000, v12
  v_lshlrev_b32 v56, 16, v13
  v_and_b32 v57, 0xffff0000, v13
  v_lshlrev_b32 v58, 16, v14
  v_and_b32 v59, 0xffff0000, v14
  v_lshlrev_b32 v60, 16, v15
  v_and_b32 v61, 0xffff0000, v15
  v_lshlrev_b32 v62, 16, v16
  v_and_b32 v63, 0xffff0000, v16
  v_lshlrev_b32 v64, 16, v17
  v_and_b32 v65, 0xffff0000, v17
  v_lshlrev_b32 v66, 16, v18
  v_and_b32 v67, 0xffff0000, v18
  v_add_f32 v20, v50, v51
  v_add_f32 v20, v20, v52
  v_add_f32 v20, v20, v53
  v_add_f32 v20, v20, v54
  v_add_f32 v20, v20, v55
  v_add_f32 v20, v20, v56
  v_add_f32 v20, v20, v57
  v_add_f32 v20, v20, v58
  v_add_f32 v20, v20, v59
  v_add_f32 v20, v20, v60
  v_add_f32 v20, v20, v61
  v_add_f32 v20, v20, v62
  v_add_f32 v20, v20, v63
  v_add_f32 v20, v20, v64
  v_add_f32 v20, v20, v65
  v_add_f32 v20, v20, v66
  v_add_f32 v20, v20, v67
  ds_swizzle_b32 v21, v20 offset:1055
  s_waitcnt lgkmcnt(0)
  v_add_f32 v20, v20, v21
  ds_swizzle_b32 v21, v20 offset:2079
  s_waitcnt lgkmcnt(0)
  v_add_f32 v20, v20, v21
  ds_swizzle_b32 v21, v20 offset:4127
  s_waitcnt lgkmcnt(0)
  v_add_f32 v20, v20, v21
  ds_swizzle_b32 v21, v20 offset:8223
  s_waitcnt lgkmcnt(0)
  v_add_f32 v20, v20, v21
  ds_swizzle_b32 v21, v20 offset:16415
  s_waitcnt lgkmcnt(0)
  v_add_f32 v20, v20, v21
  v_mul_f32 v20, 0x3ae38e39, v20
  v_sub_f32 v50, v50, v20
  v_sub_f32 v51, v51, v20
  v_sub_f32 v52, v52, v20
  v_sub_f32 v53, v53, v20
  v_sub_f32 v54, v54, v20
  v_sub_f32 v55, v55, v20
  v_sub_f32 v56, v56, v20
  v_sub_f32 v57, v57, v20
  v_sub_f32 v58, v58, v20
  v_sub_f32 v59, v59, v20
  v_sub_f32 v60, v60, v20
  v_sub_f32 v61, v61, v20
  v_sub_f32 v62, v62, v20
  v_sub_f32 v63, v63, v20
  v_sub_f32 v64, v64, v20
  v_sub_f32 v65, v65, v20
  v_sub_f32 v66, v66, v20
  v_sub_f32 v67, v67, v20
  v_mul_f32 v22, v50, v50
  v_fmac_f32 v22, v51, v51
  v_fmac_f32 v22, v52, v52
  v_fmac_f32 v22, v53, v53
  v_fmac_f32 v22, v54, v54
  v_fmac_f32 v22, v55, v55
  v_fmac_f32 v22, v56, v56
  v_fmac_f32 v22, v57, v57
  v_fmac_f32 v22, v58, v58
  v_fmac_f32 v22, v59, v59
  v_fmac_f32 v22, v60, v60
  v_fmac_f32 v22, v61, v61
  v_fmac_f32 v22, v62, v62
  v_fmac_f32 v22, v63, v63
  v_fmac_f32 v22, v64, v64
  v_fmac_f32 v22, v65, v65
  v_fmac_f32 v22, v66, v66
  v_fmac_f32 v22, v67, v67
  ds_swizzle_b32 v21, v22 offset:1055
  s_waitcnt lgkmcnt(0)
  v_add_f32 v22, v22, v21
  ds_swizzle_b32 v21, v22 offset:2079
  s_waitcnt lgkmcnt(0)
  v_add_f32 v22, v22, v21
  ds_swizzle_b32 v21, v22 offset:4127
  s_waitcnt lgkmcnt(0)
  v_add_f32 v22, v22, v21
  ds_swizzle_b32 v21, v22 offset:8223
  s_waitcnt lgkmcnt(0)
  v_add_f32 v22, v22, v21
  ds_swizzle_b32 v21, v22 offset:16415
  s_waitcnt lgkmcnt(0)
  v_add_f32 v22, v22, v21
  v_mov_b32 v23, 0x3727c5ac
  v_fmac_f32 v23, 0x3ae38e39, v22
  v_rsq_f32 v23, v23
  s_nop 1
  v_mul_f32 v50, v50, v23
  v_mul_f32 v51, v51, v23
  v_mul_f32 v52, v52, v23
  v_mul_f32 v53, v53, v23
  v_mul_f32 v54, v54, v23
  v_mul_f32 v55, v55, v23
  v_mul_f32 v56, v56, v23
  v_mul_f32 v57, v57, v23
  v_mul_f32 v58, v58, v23
  v_mul_f32 v59, v59, v23
  v_mul_f32 v60, v60, v23
  v_mul_f32 v61, v61, v23
  v_mul_f32 v62, v62, v23
  v_mul_f32 v63, v63, v23
  v_mul_f32 v64, v64, v23
  v_mul_f32 v65, v65, v23
  v_mul_f32 v66, v66, v23
  v_mul_f32 v67, v67, v23
  v_cvt_pk_bf16_f32 v10, v50, v51
  v_cvt_pk_bf16_f32 v11, v52, v53
  v_cvt_pk_bf16_f32 v12, v54, v55
  v_cvt_pk_bf16_f32 v13, v56, v57
  v_cvt_pk_bf16_f32 v14, v58, v59
  v_cvt_pk_bf16_f32 v15, v60, v61
  v_cvt_pk_bf16_f32 v16, v62, v63
  v_cvt_pk_bf16_f32 v17, v64, v65
  v_cvt_pk_bf16_f32 v18, v66, v67
  v_lshrrev_b32 v5, 5, v2
  v_mul_u32_u24 v5, 36864, v5
  v_and_b32 v6, 31, v2
  v_lshl_add_u32 v5, v6, 4, v5
  v_lshrrev_b32 v6, 3, v3
  v_lshl_add_u32 v5, v6, 10, v5
  v_bfe_u32 v6, v3, 2, 1
  v_lshl_add_u32 v5, v6, 9, v5
  v_and_b32 v6, 3, v3
  v_lshl_add_u32 v5, v6, 2, v5

  s_mov_b32 s20, 0
  buffer_store_dword v10, v5, s[12:15], s20 offen
  s_mov_b32 s20, 4096
  buffer_store_dword v11, v5, s[12:15], s20 offen
  s_mov_b32 s20, 8192
  buffer_store_dword v12, v5, s[12:15], s20 offen
  s_mov_b32 s20, 12288
  buffer_store_dword v13, v5, s[12:15], s20 offen
  s_mov_b32 s20, 16384
  buffer_store_dword v14, v5, s[12:15], s20 offen
  s_mov_b32 s20, 20480
  buffer_store_dword v15, v5, s[12:15], s20 offen
  s_mov_b32 s20, 24576
  buffer_store_dword v16, v5, s[12:15], s20 offen
  s_mov_b32 s20, 28672
  buffer_store_dword v17, v5, s[12:15], s20 offen
  s_mov_b32 s20, 32768
  buffer_store_dword v18, v5, s[12:15], s20 offen
LN_END:
  s_endpgm
  .globl gemm1_kernel
  .p2align 8
  .type gemm1_kernel,@function
gemm1_kernel:
  s_cmp_ge_u32 s2, 256
  s_cbranch_scc1 G1_END
  s_load_dwordx2 s[4:5], s[0:1], 8
  s_load_dwordx2 s[6:7], s[0:1], 32
  s_load_dwordx2 s[8:9], s[0:1], 40
  s_load_dwordx2 s[10:11], s[0:1], 72
  s_bfe_u32 s12, s2, 0x30003
  s_lshl_b32 s12, s12, 8
  s_lshr_b32 s13, s2, 6
  s_lshl_b32 s13, s13, 3
  s_and_b32 s14, s2, 7
  s_add_u32 s14, s13, s14
  v_and_b32 v245, 63, v0
  v_lshrrev_b32 v246, 6, v0
  s_nop 0
  v_readfirstlane_b32 s56, v246
  v_and_b32 v246, 31, v245
  v_lshrrev_b32 v247, 5, v245
  s_waitcnt lgkmcnt(0)

  s_mov_b32 s40, s10
  s_and_b32 s41, s11, 0xffff
  s_mov_b32 s42, 2359296
  s_mov_b32 s43, 0x00020000
  s_mov_b32 s60, s10
  s_and_b32 s61, s11, 0xffff
  s_mov_b32 s62, 268435456
  s_mov_b32 s63, 0x00020000
  v_bfe_u32 v248, v245, 2, 2
  v_lshl_add_u32 v248, v247, 3, v248
  v_lshlrev_b32 v248, 7, v248
  v_bfe_u32 v249, v245, 4, 1
  v_lshl_add_u32 v248, v249, 5, v248
  v_and_b32 v249, 3, v245
  v_lshl_add_u32 v248, v249, 3, v248
  v_bfe_u32 v249, v245, 3, 1
  v_lshl_add_u32 v242, v249, 6, v248
  v_xor_b32 v249, 1, v249
  v_lshl_add_u32 v243, v249, 6, v248
  v_add_u32 v252, 0x10000, v242
  v_add_u32 v253, 0x10000, v243
  v_add_u32 v254, 0x20000, v242
  v_add_u32 v255, 0x20000, v243
  s_lshl_b32 s55, s56, 10
  s_lshr_b32 s59, s12, 5
  s_add_u32 s59, s59, s56
  s_mul_i32 s59, s59, 36864
  v_lshl_add_u32 v244, v245, 4, s59

  s_cmp_ge_u32 s14, 8
  s_cbranch_scc1 G1_FFN
  s_lshl_b32 s13, s14, 1
  s_add_u32 s19, s13, 2
  s_min_u32 s19, s19, 15
  s_mov_b32 s30, 0
  s_lshl_b32 s57, s56, 14

  s_mov_b32 s44, s4
  s_and_b32 s45, s5, 0xffff
  s_mov_b32 s46, 1990656
  s_mov_b32 s47, 0x00020000
  s_add_u32 s48, s4, 128
  s_addc_u32 s49, s5, 0
  s_and_b32 s49, s49, 0xffff
  s_mov_b32 s50, 1990528
  s_mov_b32 s51, 0x00020000
G1_QT:
  s_mul_i32 s22, s13, 13
  s_lshr_b32 s22, s22, 6
  s_mul_i32 s23, s22, 5
  s_sub_u32 s23, s13, s23
  s_mul_i32 s15, s22, 576
  s_mul_i32 s59, s23, 126
  s_add_u32 s15, s15, s59
  s_mul_i32 s24, s23, 7
  s_movk_i32 s16, 3456

  s_lshl_b32 s17, s16, 6
  s_lshl_b32 s59, s56, 3
  v_lshrrev_b32 v248, 3, v245
  v_add_u32 v248, s59, v248
  v_and_b32 v249, 7, v245
  v_bfe_u32 v250, v245, 4, 1
  v_lshlrev_b32 v250, 2, v250
  v_xor_b32 v249, v249, v250
  v_lshlrev_b32 v249, 4, v249
  s_lshl_b32 s59, s15, 1
  v_add_u32 v249, s59, v249
  v_mul_lo_u32 v250, v248, s16
  v_add_u32 v240, v250, v249
  s_mov_b32 s53, 0
  s_nop 4

  s_cmp_lg_u32 s30, 0
  s_cbranch_scc1 G1_QNX
  s_add_u32 m0, s55, 0
  s_nop 0
  buffer_load_dwordx4 v240, s[44:47], s53 offen lds
  s_add_u32 m0, s55, 8192
  s_nop 0
  buffer_load_dwordx4 v240, s[48:51], s53 offen lds
  s_add_u32 s53, s53, s17
  s_mov_b32 s59, 0
  buffer_load_dwordx4 v[64:67], v244, s[40:43], s59 offen
  s_mov_b32 s59, 1024
  buffer_load_dwordx4 v[68:71], v244, s[40:43], s59 offen
  s_mov_b32 s59, 2048
  buffer_load_dwordx4 v[72:75], v244, s[40:43], s59 offen
  s_mov_b32 s59, 3072
  buffer_load_dwordx4 v[76:79], v244, s[40:43], s59 offen
  s_add_u32 m0, s55, 16384
  s_nop 0
  buffer_load_dwordx4 v240, s[44:47], s53 offen lds
  s_add_u32 m0, s55, 24576
  s_nop 0
  buffer_load_dwordx4 v240, s[48:51], s53 offen lds
  s_add_u32 s53, s53, s17
  s_mov_b32 s59, 4096
  buffer_load_dwordx4 v[80:83], v244, s[40:43], s59 offen
  s_mov_b32 s59, 5120
  buffer_load_dwordx4 v[84:87], v244, s[40:43], s59 offen
  s_mov_b32 s59, 6144
  buffer_load_dwordx4 v[88:91], v244, s[40:43], s59 offen
  s_mov_b32 s59, 7168
  buffer_load_dwordx4 v[92:95], v244, s[40:43], s59 offen
  s_branch G1_QNY
G1_QNX:
  s_add_u32 m0, s55, 0
  s_nop 0
  buffer_load_dwordx4 v240, s[44:47], s53 offen lds
  s_add_u32 m0, s55, 8192
  s_nop 0
  buffer_load_dwordx4 v240, s[48:51], s53 offen lds
  s_add_u32 s53, s53, s17
  s_add_u32 m0, s55, 16384
  s_nop 0
  buffer_load_dwordx4 v240, s[44:47], s53 offen lds
  s_add_u32 m0, s55, 24576
  s_nop 0
  buffer_load_dwordx4 v240, s[48:51], s53 offen lds
  s_add_u32 s53, s53, s17
  s_add_u32 m0, s55, 32768
  s_nop 0
  buffer_load_dwordx4 v240, s[44:47], s53 offen lds
  s_add_u32 m0, s55, 40960
  s_nop 0
  buffer_load_dwordx4 v240, s[48:51], s53 offen lds
  s_add_u32 s53, s53, s17
  s_add_u32 m0, s55, 49152
  s_nop 0
  buffer_load_dwordx4 v240, s[44:47], s53 offen lds
  s_add_u32 m0, s55, 57344
  s_nop 0
  buffer_load_dwordx4 v240, s[48:51], s53 offen lds
  s_add_u32 s53, s53, s17
  s_add_u32 m0, s55, 65536
  s_nop 0
  buffer_load_dwordx4 v240, s[44:47], s53 offen lds
  s_add_u32 m0, s55, 73728
  s_nop 0
  buffer_load_dwordx4 v240, s[48:51], s53 offen lds
  s_add_u32 s53, s53, s17
  s_add_u32 m0, s55, 81920
  s_nop 0
  buffer_load_dwordx4 v240, s[44:47], s53 offen lds
  s_add_u32 m0, s55, 90112
  s_nop 0
  buffer_load_dwordx4 v240, s[48:51], s53 offen lds
  s_add_u32 s53, s53, s17
  s_add_u32 m0, s55, 98304
  s_nop 0
  buffer_load_dwordx4 v240, s[44:47], s53 offen lds
  s_add_u32 m0, s55, 106496
  s_nop 0
  buffer_load_dwordx4 v240, s[48:51], s53 offen lds
  s_add_u32 s53, s53, s17
  s_add_u32 m0, s55, 114688
  s_nop 0
  buffer_load_dwordx4 v240, s[44:47], s53 offen lds
  s_add_u32 m0, s55, 122880
  s_nop 0
  buffer_load_dwordx4 v240, s[48:51], s53 offen lds
  s_add_u32 s53, s53, s17
  s_add_u32 m0, s55, 131072
  s_nop 0
  buffer_load_dwordx4 v240, s[44:47], s53 offen lds
  s_add_u32 m0, s55, 139264
  s_nop 0
  buffer_load_dwordx4 v240, s[48:51], s53 offen lds
  s_add_u32 s53, s53, s17
G1_QNY:
  s_cmp_ge_u32 s22, 2
  s_cbranch_scc1 G1_QV

  s_cmp_lg_u32 s30, 0
  s_cbranch_scc1 G1_QS1
  s_waitcnt vmcnt(6)
  s_barrier
  s_add_u32 m0, s55, 32768
  s_nop 0
  buffer_load_dwordx4 v240, s[44:47], s53 offen lds
  s_add_u32 m0, s55, 40960
  s_nop 0
  buffer_load_dwordx4 v240, s[48:51], s53 offen lds
  s_add_u32 s53, s53, s17
  s_mov_b32 s59, 8192
  buffer_load_dwordx4 v[96:99], v244, s[40:43], s59 offen
  s_mov_b32 s59, 9216
  buffer_load_dwordx4 v[100:103], v244, s[40:43], s59 offen
  s_mov_b32 s59, 10240
  buffer_load_dwordx4 v[104:107], v244, s[40:43], s59 offen
  s_mov_b32 s59, 11264
  buffer_load_dwordx4 v[108:111], v244, s[40:43], s59 offen
  s_branch G1_QR1
G1_QS1:
  s_waitcnt vmcnt(16)
  s_barrier
G1_QR1:
  ds_read_b64_tr_b16 v[208:209], v242 offset:0
  ds_read_b64_tr_b16 v[210:211], v242 offset:512
  ds_read_b64_tr_b16 v[212:213], v243 offset:0
  ds_read_b64_tr_b16 v[214:215], v243 offset:512
  ds_read_b64_tr_b16 v[216:217], v242 offset:8192
  ds_read_b64_tr_b16 v[218:219], v242 offset:8704
  ds_read_b64_tr_b16 v[220:221], v243 offset:8192
  ds_read_b64_tr_b16 v[222:223], v243 offset:8704
  ds_read_b64_tr_b16 v[224:225], v242 offset:2048
  ds_read_b64_tr_b16 v[226:227], v242 offset:2560
  ds_read_b64_tr_b16 v[228:229], v243 offset:2048
  ds_read_b64_tr_b16 v[230:231], v243 offset:2560
  ds_read_b64_tr_b16 v[232:233], v242 offset:10240
  ds_read_b64_tr_b16 v[234:235], v242 offset:10752
  ds_read_b64_tr_b16 v[236:237], v243 offset:10240
  ds_read_b64_tr_b16 v[238:239], v243 offset:10752
  s_waitcnt lgkmcnt(8)
  v_mfma_f32_32x32x16_bf16 v[0:15], v[208:211], v[64:67], 0
  v_mfma_f32_32x32x16_bf16 v[16:31], v[212:215], v[64:67], 0
  v_mfma_f32_32x32x16_bf16 v[32:47], v[216:219], v[64:67], 0
  v_mfma_f32_32x32x16_bf16 v[48:63], v[220:223], v[64:67], 0
  ds_read_b64_tr_b16 v[208:209], v242 offset:4096
  ds_read_b64_tr_b16 v[210:211], v242 offset:4608
  ds_read_b64_tr_b16 v[212:213], v243 offset:4096
  ds_read_b64_tr_b16 v[214:215], v243 offset:4608
  ds_read_b64_tr_b16 v[216:217], v242 offset:12288
  ds_read_b64_tr_b16 v[218:219], v242 offset:12800
  ds_read_b64_tr_b16 v[220:221], v243 offset:12288
  ds_read_b64_tr_b16 v[222:223], v243 offset:12800
  s_waitcnt lgkmcnt(8)
  v_mfma_f32_32x32x16_bf16 v[0:15], v[224:227], v[68:71], v[0:15]
  v_mfma_f32_32x32x16_bf16 v[16:31], v[228:231], v[68:71], v[16:31]
  v_mfma_f32_32x32x16_bf16 v[32:47], v[232:235], v[68:71], v[32:47]
  v_mfma_f32_32x32x16_bf16 v[48:63], v[236:239], v[68:71], v[48:63]
  s_cmp_lg_u32 s30, 0
  s_cbranch_scc1 G1_QS2
  s_waitcnt vmcnt(6)
  s_barrier
  s_add_u32 m0, s55, 49152
  s_nop 0
  buffer_load_dwordx4 v240, s[44:47], s53 offen lds
  s_add_u32 m0, s55, 57344
  s_nop 0
  buffer_load_dwordx4 v240, s[48:51], s53 offen lds
  s_add_u32 s53, s53, s17
  s_mov_b32 s59, 12288
  buffer_load_dwordx4 v[112:115], v244, s[40:43], s59 offen
  s_mov_b32 s59, 13312
  buffer_load_dwordx4 v[116:119], v244, s[40:43], s59 offen
  s_mov_b32 s59, 14336
  buffer_load_dwordx4 v[120:123], v244, s[40:43], s59 offen
  s_mov_b32 s59, 15360
  buffer_load_dwordx4 v[124:127], v244, s[40:43], s59 offen
  s_branch G1_QR2
G1_QS2:
  s_waitcnt vmcnt(14)
  s_barrier
G1_QR2:
  ds_read_b64_tr_b16 v[224:225], v242 offset:6144
  ds_read_b64_tr_b16 v[226:227], v242 offset:6656
  ds_read_b64_tr_b16 v[228:229], v243 offset:6144
  ds_read_b64_tr_b16 v[230:231], v243 offset:6656
  ds_read_b64_tr_b16 v[232:233], v242 offset:14336
  ds_read_b64_tr_b16 v[234:235], v242 offset:14848
  ds_read_b64_tr_b16 v[236:237], v243 offset:14336
  ds_read_b64_tr_b16 v[238:239], v243 offset:14848
  s_waitcnt lgkmcnt(8)
  v_mfma_f32_32x32x16_bf16 v[0:15], v[208:211], v[72:75], v[0:15]
  v_mfma_f32_32x32x16_bf16 v[16:31], v[212:215], v[72:75], v[16:31]
  v_mfma_f32_32x32x16_bf16 v[32:47], v[216:219], v[72:75], v[32:47]
  v_mfma_f32_32x32x16_bf16 v[48:63], v[220:223], v[72:75], v[48:63]
  ds_read_b64_tr_b16 v[208:209], v242 offset:16384
  ds_read_b64_tr_b16 v[210:211], v242 offset:16896
  ds_read_b64_tr_b16 v[212:213], v243 offset:16384
  ds_read_b64_tr_b16 v[214:215], v243 offset:16896
  ds_read_b64_tr_b16 v[216:217], v242 offset:24576
  ds_read_b64_tr_b16 v[218:219], v242 offset:25088
  ds_read_b64_tr_b16 v[220:221], v243 offset:24576
  ds_read_b64_tr_b16 v[222:223], v243 offset:25088
  s_waitcnt lgkmcnt(8)
  v_mfma_f32_32x32x16_bf16 v[0:15], v[224:227], v[76:79], v[0:15]
  v_mfma_f32_32x32x16_bf16 v[16:31], v[228:231], v[76:79], v[16:31]
  v_mfma_f32_32x32x16_bf16 v[32:47], v[232:235], v[76:79], v[32:47]
  v_mfma_f32_32x32x16_bf16 v[48:63], v[236:239], v[76:79], v[48:63]
  ds_read_b64_tr_b16 v[224:225], v242 offset:18432
  ds_read_b64_tr_b16 v[226:227], v242 offset:18944
  ds_read_b64_tr_b16 v[228:229], v243 offset:18432
  ds_read_b64_tr_b16 v[230:231], v243 offset:18944
  ds_read_b64_tr_b16 v[232:233], v242 offset:26624
  ds_read_b64_tr_b16 v[234:235], v242 offset:27136
  ds_read_b64_tr_b16 v[236:237], v243 offset:26624
  ds_read_b64_tr_b16 v[238:239], v243 offset:27136
  s_waitcnt lgkmcnt(8)
  v_mfma_f32_32x32x16_bf16 v[0:15], v[208:211], v[80:83], v[0:15]
  v_mfma_f32_32x32x16_bf16 v[16:31], v[212:215], v[80:83], v[16:31]
  v_mfma_f32_32x32x16_bf16 v[32:47], v[216:219], v[80:83], v[32:47]
  v_mfma_f32_32x32x16_bf16 v[48:63], v[220:223], v[80:83], v[48:63]
  ds_read_b64_tr_b16 v[208:209], v242 offset:20480
  ds_read_b64_tr_b16 v[210:211], v242 offset:20992
  ds_read_b64_tr_b16 v[212:213], v243 offset:20480
  ds_read_b64_tr_b16 v[214:215], v243 offset:20992
  ds_read_b64_tr_b16 v[216:217], v242 offset:28672
  ds_read_b64_tr_b16 v[218:219], v242 offset:29184
  ds_read_b64_tr_b16 v[220:221], v243 offset:28672
  ds_read_b64_tr_b16 v[222:223], v243 offset:29184
  s_waitcnt lgkmcnt(8)
  v_mfma_f32_32x32x16_bf16 v[0:15], v[224:227], v[84:87], v[0:15]
  v_mfma_f32_32x32x16_bf16 v[16:31], v[228:231], v[84:87], v[16:31]
  v_mfma_f32_32x32x16_bf16 v[32:47], v[232:235], v[84:87], v[32:47]
  v_mfma_f32_32x32x16_bf16 v[48:63], v[236:239], v[84:87], v[48:63]
  s_cmp_lg_u32 s30, 0
  s_cbranch_scc1 G1_QS3
  s_waitcnt vmcnt(6)
  s_barrier
  s_add_u32 m0, s55, 65536
  s_nop 0
  buffer_load_dwordx4 v240, s[44:47], s53 offen lds
  s_add_u32 m0, s55, 73728
  s_nop 0
  buffer_load_dwordx4 v240, s[48:51], s53 offen lds
  s_add_u32 s53, s53, s17
  s_mov_b32 s59, 16384
  buffer_load_dwordx4 v[128:131], v244, s[40:43], s59 offen
  s_mov_b32 s59, 17408
  buffer_load_dwordx4 v[132:135], v244, s[40:43], s59 offen
  s_mov_b32 s59, 18432
  buffer_load_dwordx4 v[136:139], v244, s[40:43], s59 offen
  s_mov_b32 s59, 19456
  buffer_load_dwordx4 v[140:143], v244, s[40:43], s59 offen
  s_branch G1_QR3
G1_QS3:
  s_waitcnt vmcnt(12)
  s_barrier
G1_QR3:
  ds_read_b64_tr_b16 v[224:225], v242 offset:22528
  ds_read_b64_tr_b16 v[226:227], v242 offset:23040
  ds_read_b64_tr_b16 v[228:229], v243 offset:22528
  ds_read_b64_tr_b16 v[230:231], v243 offset:23040
  ds_read_b64_tr_b16 v[232:233], v242 offset:30720
  ds_read_b64_tr_b16 v[234:235], v242 offset:31232
  ds_read_b64_tr_b16 v[236:237], v243 offset:30720
  ds_read_b64_tr_b16 v[238:239], v243 offset:31232
  s_waitcnt lgkmcnt(8)
  v_mfma_f32_32x32x16_bf16 v[0:15], v[208:211], v[88:91], v[0:15]
  v_mfma_f32_32x32x16_bf16 v[16:31], v[212:215], v[88:91], v[16:31]
  v_mfma_f32_32x32x16_bf16 v[32:47], v[216:219], v[88:91], v[32:47]
  v_mfma_f32_32x32x16_bf16 v[48:63], v[220:223], v[88:91], v[48:63]
  ds_read_b64_tr_b16 v[208:209], v242 offset:32768
  ds_read_b64_tr_b16 v[210:211], v242 offset:33280
  ds_read_b64_tr_b16 v[212:213], v243 offset:32768
  ds_read_b64_tr_b16 v[214:215], v243 offset:33280
  ds_read_b64_tr_b16 v[216:217], v242 offset:40960
  ds_read_b64_tr_b16 v[218:219], v242 offset:41472
  ds_read_b64_tr_b16 v[220:221], v243 offset:40960
  ds_read_b64_tr_b16 v[222:223], v243 offset:41472
  s_waitcnt lgkmcnt(8)
  v_mfma_f32_32x32x16_bf16 v[0:15], v[224:227], v[92:95], v[0:15]
  v_mfma_f32_32x32x16_bf16 v[16:31], v[228:231], v[92:95], v[16:31]
  v_mfma_f32_32x32x16_bf16 v[32:47], v[232:235], v[92:95], v[32:47]
  v_mfma_f32_32x32x16_bf16 v[48:63], v[236:239], v[92:95], v[48:63]
  ds_read_b64_tr_b16 v[224:225], v242 offset:34816
  ds_read_b64_tr_b16 v[226:227], v242 offset:35328
  ds_read_b64_tr_b16 v[228:229], v243 offset:34816
  ds_read_b64_tr_b16 v[230:231], v243 offset:35328
  ds_read_b64_tr_b16 v[232:233], v242 offset:43008
  ds_read_b64_tr_b16 v[234:235], v242 offset:43520
  ds_read_b64_tr_b16 v[236:237], v243 offset:43008
  ds_read_b64_tr_b16 v[238:239], v243 offset:43520
  s_waitcnt lgkmcnt(8)
  v_mfma_f32_32x32x16_bf16 v[0:15], v[208:211], v[96:99], v[0:15]
  v_mfma_f32_32x32x16_bf16 v[16:31], v[212:215], v[96:99], v[16:31]
  v_mfma_f32_32x32x16_bf16 v[32:47], v[216:219], v[96:99], v[32:47]
  v_mfma_f32_32x32x16_bf16 v[48:63], v[220:223], v[96:99], v[48:63]
  ds_read_b64_tr_b16 v[208:209], v242 offset:36864
  ds_read_b64_tr_b16 v[210:211], v242 offset:37376
  ds_read_b64_tr_b16 v[212:213], v243 offset:36864
  ds_read_b64_tr_b16 v[214:215], v243 offset:37376
  ds_read_b64_tr_b16 v[216:217], v242 offset:45056
  ds_read_b64_tr_b16 v[218:219], v242 offset:45568
  ds_read_b64_tr_b16 v[220:221], v243 offset:45056
  ds_read_b64_tr_b16 v[222:223], v243 offset:45568
  s_waitcnt lgkmcnt(8)
  v_mfma_f32_32x32x16_bf16 v[0:15], v[224:227], v[100:103], v[0:15]
  v_mfma_f32_32x32x16_bf16 v[16:31], v[228:231], v[100:103], v[16:31]
  v_mfma_f32_32x32x16_bf16 v[32:47], v[232:235], v[100:103], v[32:47]
  v_mfma_f32_32x32x16_bf16 v[48:63], v[236:239], v[100:103], v[48:63]
  s_cmp_lg_u32 s30, 0
  s_cbranch_scc1 G1_QS4
  s_waitcnt vmcnt(6)
  s_barrier
  s_add_u32 m0, s55, 81920
  s_nop 0
  buffer_load_dwordx4 v240, s[44:47], s53 offen lds
  s_add_u32 m0, s55, 90112
  s_nop 0
  buffer_load_dwordx4 v240, s[48:51], s53 offen lds
  s_add_u32 s53, s53, s17
  s_mov_b32 s59, 20480
  buffer_load_dwordx4 v[144:147], v244, s[40:43], s59 offen
  s_mov_b32 s59, 21504
  buffer_load_dwordx4 v[148:151], v244, s[40:43], s59 offen
  s_mov_b32 s59, 22528
  buffer_load_dwordx4 v[152:155], v244, s[40:43], s59 offen
  s_mov_b32 s59, 23552
  buffer_load_dwordx4 v[156:159], v244, s[40:43], s59 offen
  s_branch G1_QR4
G1_QS4:
  s_waitcnt vmcnt(10)
  s_barrier
G1_QR4:
  ds_read_b64_tr_b16 v[224:225], v242 offset:38912
  ds_read_b64_tr_b16 v[226:227], v242 offset:39424
  ds_read_b64_tr_b16 v[228:229], v243 offset:38912
  ds_read_b64_tr_b16 v[230:231], v243 offset:39424
  ds_read_b64_tr_b16 v[232:233], v242 offset:47104
  ds_read_b64_tr_b16 v[234:235], v242 offset:47616
  ds_read_b64_tr_b16 v[236:237], v243 offset:47104
  ds_read_b64_tr_b16 v[238:239], v243 offset:47616
  s_waitcnt lgkmcnt(8)
  v_mfma_f32_32x32x16_bf16 v[0:15], v[208:211], v[104:107], v[0:15]
  v_mfma_f32_32x32x16_bf16 v[16:31], v[212:215], v[104:107], v[16:31]
  v_mfma_f32_32x32x16_bf16 v[32:47], v[216:219], v[104:107], v[32:47]
  v_mfma_f32_32x32x16_bf16 v[48:63], v[220:223], v[104:107], v[48:63]
  ds_read_b64_tr_b16 v[208:209], v242 offset:49152
  ds_read_b64_tr_b16 v[210:211], v242 offset:49664
  ds_read_b64_tr_b16 v[212:213], v243 offset:49152
  ds_read_b64_tr_b16 v[214:215], v243 offset:49664
  ds_read_b64_tr_b16 v[216:217], v242 offset:57344
  ds_read_b64_tr_b16 v[218:219], v242 offset:57856
  ds_read_b64_tr_b16 v[220:221], v243 offset:57344
  ds_read_b64_tr_b16 v[222:223], v243 offset:57856
  s_waitcnt lgkmcnt(8)
  v_mfma_f32_32x32x16_bf16 v[0:15], v[224:227], v[108:111], v[0:15]
  v_mfma_f32_32x32x16_bf16 v[16:31], v[228:231], v[108:111], v[16:31]
  v_mfma_f32_32x32x16_bf16 v[32:47], v[232:235], v[108:111], v[32:47]
  v_mfma_f32_32x32x16_bf16 v[48:63], v[236:239], v[108:111], v[48:63]
  ds_read_b64_tr_b16 v[224:225], v242 offset:51200
  ds_read_b64_tr_b16 v[226:227], v242 offset:51712
  ds_read_b64_tr_b16 v[228:229], v243 offset:51200
  ds_read_b64_tr_b16 v[230:231], v243 offset:51712
  ds_read_b64_tr_b16 v[232:233], v242 offset:59392
  ds_read_b64_tr_b16 v[234:235], v242 offset:59904
  ds_read_b64_tr_b16 v[236:237], v243 offset:59392
  ds_read_b64_tr_b16 v[238:239], v243 offset:59904
  s_waitcnt lgkmcnt(8)
  v_mfma_f32_32x32x16_bf16 v[0:15], v[208:211], v[112:115], v[0:15]
  v_mfma_f32_32x32x16_bf16 v[16:31], v[212:215], v[112:115], v[16:31]
  v_mfma_f32_32x32x16_bf16 v[32:47], v[216:219], v[112:115], v[32:47]
  v_mfma_f32_32x32x16_bf16 v[48:63], v[220:223], v[112:115], v[48:63]
  ds_read_b64_tr_b16 v[208:209], v242 offset:53248
  ds_read_b64_tr_b16 v[210:211], v242 offset:53760
  ds_read_b64_tr_b16 v[212:213], v243 offset:53248
  ds_read_b64_tr_b16 v[214:215], v243 offset:53760
  ds_read_b64_tr_b16 v[216:217], v242 offset:61440
  ds_read_b64_tr_b16 v[218:219], v242 offset:61952
  ds_read_b64_tr_b16 v[220:221], v243 offset:61440
  ds_read_b64_tr_b16 v[222:223], v243 offset:61952
  s_waitcnt lgkmcnt(8)
  v_mfma_f32_32x32x16_bf16 v[0:15], v[224:227], v[116:119], v[0:15]
  v_mfma_f32_32x32x16_bf16 v[16:31], v[228:231], v[116:119], v[16:31]
  v_mfma_f32_32x32x16_bf16 v[32:47], v[232:235], v[116:119], v[32:47]
  v_mfma_f32_32x32x16_bf16 v[48:63], v[236:239], v[116:119], v[48:63]
  s_cmp_lg_u32 s30, 0
  s_cbranch_scc1 G1_QS5
  s_waitcnt vmcnt(6)
  s_barrier
  s_add_u32 m0, s55, 98304
  s_nop 0
  buffer_load_dwordx4 v240, s[44:47], s53 offen lds
  s_add_u32 m0, s55, 106496
  s_nop 0
  buffer_load_dwordx4 v240, s[48:51], s53 offen lds
  s_add_u32 s53, s53, s17
  s_mov_b32 s59, 24576
  buffer_load_dwordx4 v[160:163], v244, s[40:43], s59 offen
  s_mov_b32 s59, 25600
  buffer_load_dwordx4 v[164:167], v244, s[40:43], s59 offen
  s_mov_b32 s59, 26624
  buffer_load_dwordx4 v[168:171], v244, s[40:43], s59 offen
  s_mov_b32 s59, 27648
  buffer_load_dwordx4 v[172:175], v244, s[40:43], s59 offen
  s_branch G1_QR5
G1_QS5:
  s_waitcnt vmcnt(8)
  s_barrier
G1_QR5:
  ds_read_b64_tr_b16 v[224:225], v242 offset:55296
  ds_read_b64_tr_b16 v[226:227], v242 offset:55808
  ds_read_b64_tr_b16 v[228:229], v243 offset:55296
  ds_read_b64_tr_b16 v[230:231], v243 offset:55808
  ds_read_b64_tr_b16 v[232:233], v242 offset:63488
  ds_read_b64_tr_b16 v[234:235], v242 offset:64000
  ds_read_b64_tr_b16 v[236:237], v243 offset:63488
  ds_read_b64_tr_b16 v[238:239], v243 offset:64000
  s_waitcnt lgkmcnt(8)
  v_mfma_f32_32x32x16_bf16 v[0:15], v[208:211], v[120:123], v[0:15]
  v_mfma_f32_32x32x16_bf16 v[16:31], v[212:215], v[120:123], v[16:31]
  v_mfma_f32_32x32x16_bf16 v[32:47], v[216:219], v[120:123], v[32:47]
  v_mfma_f32_32x32x16_bf16 v[48:63], v[220:223], v[120:123], v[48:63]
  ds_read_b64_tr_b16 v[208:209], v252 offset:0
  ds_read_b64_tr_b16 v[210:211], v252 offset:512
  ds_read_b64_tr_b16 v[212:213], v253 offset:0
  ds_read_b64_tr_b16 v[214:215], v253 offset:512
  ds_read_b64_tr_b16 v[216:217], v252 offset:8192
  ds_read_b64_tr_b16 v[218:219], v252 offset:8704
  ds_read_b64_tr_b16 v[220:221], v253 offset:8192
  ds_read_b64_tr_b16 v[222:223], v253 offset:8704
  s_waitcnt lgkmcnt(8)
  v_mfma_f32_32x32x16_bf16 v[0:15], v[224:227], v[124:127], v[0:15]
  v_mfma_f32_32x32x16_bf16 v[16:31], v[228:231], v[124:127], v[16:31]
  v_mfma_f32_32x32x16_bf16 v[32:47], v[232:235], v[124:127], v[32:47]
  v_mfma_f32_32x32x16_bf16 v[48:63], v[236:239], v[124:127], v[48:63]
  ds_read_b64_tr_b16 v[224:225], v252 offset:2048
  ds_read_b64_tr_b16 v[226:227], v252 offset:2560
  ds_read_b64_tr_b16 v[228:229], v253 offset:2048
  ds_read_b64_tr_b16 v[230:231], v253 offset:2560
  ds_read_b64_tr_b16 v[232:233], v252 offset:10240
  ds_read_b64_tr_b16 v[234:235], v252 offset:10752
  ds_read_b64_tr_b16 v[236:237], v253 offset:10240
  ds_read_b64_tr_b16 v[238:239], v253 offset:10752
  s_waitcnt lgkmcnt(8)
  v_mfma_f32_32x32x16_bf16 v[0:15], v[208:211], v[128:131], v[0:15]
  v_mfma_f32_32x32x16_bf16 v[16:31], v[212:215], v[128:131], v[16:31]
  v_mfma_f32_32x32x16_bf16 v[32:47], v[216:219], v[128:131], v[32:47]
  v_mfma_f32_32x32x16_bf16 v[48:63], v[220:223], v[128:131], v[48:63]
  ds_read_b64_tr_b16 v[208:209], v252 offset:4096
  ds_read_b64_tr_b16 v[210:211], v252 offset:4608
  ds_read_b64_tr_b16 v[212:213], v253 offset:4096
  ds_read_b64_tr_b16 v[214:215], v253 offset:4608
  ds_read_b64_tr_b16 v[216:217], v252 offset:12288
  ds_read_b64_tr_b16 v[218:219], v252 offset:12800
  ds_read_b64_tr_b16 v[220:221], v253 offset:12288
  ds_read_b64_tr_b16 v[222:223], v253 offset:12800
  s_waitcnt lgkmcnt(8)
  v_mfma_f32_32x32x16_bf16 v[0:15], v[224:227], v[132:135], v[0:15]
  v_mfma_f32_32x32x16_bf16 v[16:31], v[228:231], v[132:135], v[16:31]
  v_mfma_f32_32x32x16_bf16 v[32:47], v[232:235], v[132:135], v[32:47]
  v_mfma_f32_32x32x16_bf16 v[48:63], v[236:239], v[132:135], v[48:63]
  s_cmp_lg_u32 s30, 0
  s_cbranch_scc1 G1_QS6
  s_waitcnt vmcnt(6)
  s_barrier
  s_add_u32 m0, s55, 114688
  s_nop 0
  buffer_load_dwordx4 v240, s[44:47], s53 offen lds
  s_add_u32 m0, s55, 122880
  s_nop 0
  buffer_load_dwordx4 v240, s[48:51], s53 offen lds
  s_add_u32 s53, s53, s17
  s_mov_b32 s59, 28672
  buffer_load_dwordx4 v[176:179], v244, s[40:43], s59 offen
  s_mov_b32 s59, 29696
  buffer_load_dwordx4 v[180:183], v244, s[40:43], s59 offen
  s_mov_b32 s59, 30720
  buffer_load_dwordx4 v[184:187], v244, s[40:43], s59 offen
  s_mov_b32 s59, 31744
  buffer_load_dwordx4 v[188:191], v244, s[40:43], s59 offen
  s_branch G1_QR6
G1_QS6:
  s_waitcnt vmcnt(6)
  s_barrier
G1_QR6:
  ds_read_b64_tr_b16 v[224:225], v252 offset:6144
  ds_read_b64_tr_b16 v[226:227], v252 offset:6656
  ds_read_b64_tr_b16 v[228:229], v253 offset:6144
  ds_read_b64_tr_b16 v[230:231], v253 offset:6656
  ds_read_b64_tr_b16 v[232:233], v252 offset:14336
  ds_read_b64_tr_b16 v[234:235], v252 offset:14848
  ds_read_b64_tr_b16 v[236:237], v253 offset:14336
  ds_read_b64_tr_b16 v[238:239], v253 offset:14848
  s_waitcnt lgkmcnt(8)
  v_mfma_f32_32x32x16_bf16 v[0:15], v[208:211], v[136:139], v[0:15]
  v_mfma_f32_32x32x16_bf16 v[16:31], v[212:215], v[136:139], v[16:31]
  v_mfma_f32_32x32x16_bf16 v[32:47], v[216:219], v[136:139], v[32:47]
  v_mfma_f32_32x32x16_bf16 v[48:63], v[220:223], v[136:139], v[48:63]
  ds_read_b64_tr_b16 v[208:209], v252 offset:16384
  ds_read_b64_tr_b16 v[210:211], v252 offset:16896
  ds_read_b64_tr_b16 v[212:213], v253 offset:16384
  ds_read_b64_tr_b16 v[214:215], v253 offset:16896
  ds_read_b64_tr_b16 v[216:217], v252 offset:24576
  ds_read_b64_tr_b16 v[218:219], v252 offset:25088
  ds_read_b64_tr_b16 v[220:221], v253 offset:24576
  ds_read_b64_tr_b16 v[222:223], v253 offset:25088
  s_waitcnt lgkmcnt(8)
  v_mfma_f32_32x32x16_bf16 v[0:15], v[224:227], v[140:143], v[0:15]
  v_mfma_f32_32x32x16_bf16 v[16:31], v[228:231], v[140:143], v[16:31]
  v_mfma_f32_32x32x16_bf16 v[32:47], v[232:235], v[140:143], v[32:47]
  v_mfma_f32_32x32x16_bf16 v[48:63], v[236:239], v[140:143], v[48:63]
  ds_read_b64_tr_b16 v[224:225], v252 offset:18432
  ds_read_b64_tr_b16 v[226:227], v252 offset:18944
  ds_read_b64_tr_b16 v[228:229], v253 offset:18432
  ds_read_b64_tr_b16 v[230:231], v253 offset:18944
  ds_read_b64_tr_b16 v[232:233], v252 offset:26624
  ds_read_b64_tr_b16 v[234:235], v252 offset:27136
  ds_read_b64_tr_b16 v[236:237], v253 offset:26624
  ds_read_b64_tr_b16 v[238:239], v253 offset:27136
  s_waitcnt lgkmcnt(8)
  v_mfma_f32_32x32x16_bf16 v[0:15], v[208:211], v[144:147], v[0:15]
  v_mfma_f32_32x32x16_bf16 v[16:31], v[212:215], v[144:147], v[16:31]
  v_mfma_f32_32x32x16_bf16 v[32:47], v[216:219], v[144:147], v[32:47]
  v_mfma_f32_32x32x16_bf16 v[48:63], v[220:223], v[144:147], v[48:63]
  ds_read_b64_tr_b16 v[208:209], v252 offset:20480
  ds_read_b64_tr_b16 v[210:211], v252 offset:20992
  ds_read_b64_tr_b16 v[212:213], v253 offset:20480
  ds_read_b64_tr_b16 v[214:215], v253 offset:20992
  ds_read_b64_tr_b16 v[216:217], v252 offset:28672
  ds_read_b64_tr_b16 v[218:219], v252 offset:29184
  ds_read_b64_tr_b16 v[220:221], v253 offset:28672
  ds_read_b64_tr_b16 v[222:223], v253 offset:29184
  s_waitcnt lgkmcnt(8)
  v_mfma_f32_32x32x16_bf16 v[0:15], v[224:227], v[148:151], v[0:15]
  v_mfma_f32_32x32x16_bf16 v[16:31], v[228:231], v[148:151], v[16:31]
  v_mfma_f32_32x32x16_bf16 v[32:47], v[232:235], v[148:151], v[32:47]
  v_mfma_f32_32x32x16_bf16 v[48:63], v[236:239], v[148:151], v[48:63]
  s_cmp_lg_u32 s30, 0
  s_cbranch_scc1 G1_QS7
  s_waitcnt vmcnt(6)
  s_barrier
  s_add_u32 m0, s55, 131072
  s_nop 0
  buffer_load_dwordx4 v240, s[44:47], s53 offen lds
  s_add_u32 m0, s55, 139264
  s_nop 0
  buffer_load_dwordx4 v240, s[48:51], s53 offen lds
  s_add_u32 s53, s53, s17
  s_mov_b32 s59, 32768
  buffer_load_dwordx4 v[192:195], v244, s[40:43], s59 offen
  s_mov_b32 s59, 33792
  buffer_load_dwordx4 v[196:199], v244, s[40:43], s59 offen
  s_mov_b32 s59, 34816
  buffer_load_dwordx4 v[200:203], v244, s[40:43], s59 offen
  s_mov_b32 s59, 35840
  buffer_load_dwordx4 v[204:207], v244, s[40:43], s59 offen
  s_branch G1_QR7
G1_QS7:
  s_waitcnt vmcnt(4)
  s_barrier
G1_QR7:
  ds_read_b64_tr_b16 v[224:225], v252 offset:22528
  ds_read_b64_tr_b16 v[226:227], v252 offset:23040
  ds_read_b64_tr_b16 v[228:229], v253 offset:22528
  ds_read_b64_tr_b16 v[230:231], v253 offset:23040
  ds_read_b64_tr_b16 v[232:233], v252 offset:30720
  ds_read_b64_tr_b16 v[234:235], v252 offset:31232
  ds_read_b64_tr_b16 v[236:237], v253 offset:30720
  ds_read_b64_tr_b16 v[238:239], v253 offset:31232
  s_waitcnt lgkmcnt(8)
  v_mfma_f32_32x32x16_bf16 v[0:15], v[208:211], v[152:155], v[0:15]
  v_mfma_f32_32x32x16_bf16 v[16:31], v[212:215], v[152:155], v[16:31]
  v_mfma_f32_32x32x16_bf16 v[32:47], v[216:219], v[152:155], v[32:47]
  v_mfma_f32_32x32x16_bf16 v[48:63], v[220:223], v[152:155], v[48:63]
  ds_read_b64_tr_b16 v[208:209], v252 offset:32768
  ds_read_b64_tr_b16 v[210:211], v252 offset:33280
  ds_read_b64_tr_b16 v[212:213], v253 offset:32768
  ds_read_b64_tr_b16 v[214:215], v253 offset:33280
  ds_read_b64_tr_b16 v[216:217], v252 offset:40960
  ds_read_b64_tr_b16 v[218:219], v252 offset:41472
  ds_read_b64_tr_b16 v[220:221], v253 offset:40960
  ds_read_b64_tr_b16 v[222:223], v253 offset:41472
  s_waitcnt lgkmcnt(8)
  v_mfma_f32_32x32x16_bf16 v[0:15], v[224:227], v[156:159], v[0:15]
  v_mfma_f32_32x32x16_bf16 v[16:31], v[228:231], v[156:159], v[16:31]
  v_mfma_f32_32x32x16_bf16 v[32:47], v[232:235], v[156:159], v[32:47]
  v_mfma_f32_32x32x16_bf16 v[48:63], v[236:239], v[156:159], v[48:63]
  ds_read_b64_tr_b16 v[224:225], v252 offset:34816
  ds_read_b64_tr_b16 v[226:227], v252 offset:35328
  ds_read_b64_tr_b16 v[228:229], v253 offset:34816
  ds_read_b64_tr_b16 v[230:231], v253 offset:35328
  ds_read_b64_tr_b16 v[232:233], v252 offset:43008
  ds_read_b64_tr_b16 v[234:235], v252 offset:43520
  ds_read_b64_tr_b16 v[236:237], v253 offset:43008
  ds_read_b64_tr_b16 v[238:239], v253 offset:43520
  s_waitcnt lgkmcnt(8)
  v_mfma_f32_32x32x16_bf16 v[0:15], v[208:211], v[160:163], v[0:15]
  v_mfma_f32_32x32x16_bf16 v[16:31], v[212:215], v[160:163], v[16:31]
  v_mfma_f32_32x32x16_bf16 v[32:47], v[216:219], v[160:163], v[32:47]
  v_mfma_f32_32x32x16_bf16 v[48:63], v[220:223], v[160:163], v[48:63]
  ds_read_b64_tr_b16 v[208:209], v252 offset:36864
  ds_read_b64_tr_b16 v[210:211], v252 offset:37376
  ds_read_b64_tr_b16 v[212:213], v253 offset:36864
  ds_read_b64_tr_b16 v[214:215], v253 offset:37376
  ds_read_b64_tr_b16 v[216:217], v252 offset:45056
  ds_read_b64_tr_b16 v[218:219], v252 offset:45568
  ds_read_b64_tr_b16 v[220:221], v253 offset:45056
  ds_read_b64_tr_b16 v[222:223], v253 offset:45568
  s_waitcnt lgkmcnt(8)
  v_mfma_f32_32x32x16_bf16 v[0:15], v[224:227], v[164:167], v[0:15]
  v_mfma_f32_32x32x16_bf16 v[16:31], v[228:231], v[164:167], v[16:31]
  v_mfma_f32_32x32x16_bf16 v[32:47], v[232:235], v[164:167], v[32:47]
  v_mfma_f32_32x32x16_bf16 v[48:63], v[236:239], v[164:167], v[48:63]
  s_cmp_lg_u32 s30, 0
  s_cbranch_scc1 G1_QS8
  s_waitcnt vmcnt(6)
  s_barrier
  s_branch G1_QR8
G1_QS8:
  s_waitcnt vmcnt(2)
  s_barrier
G1_QR8:
  ds_read_b64_tr_b16 v[224:225], v252 offset:38912
  ds_read_b64_tr_b16 v[226:227], v252 offset:39424
  ds_read_b64_tr_b16 v[228:229], v253 offset:38912
  ds_read_b64_tr_b16 v[230:231], v253 offset:39424
  ds_read_b64_tr_b16 v[232:233], v252 offset:47104
  ds_read_b64_tr_b16 v[234:235], v252 offset:47616
  ds_read_b64_tr_b16 v[236:237], v253 offset:47104
  ds_read_b64_tr_b16 v[238:239], v253 offset:47616
  s_waitcnt lgkmcnt(8)
  v_mfma_f32_32x32x16_bf16 v[0:15], v[208:211], v[168:171], v[0:15]
  v_mfma_f32_32x32x16_bf16 v[16:31], v[212:215], v[168:171], v[16:31]
  v_mfma_f32_32x32x16_bf16 v[32:47], v[216:219], v[168:171], v[32:47]
  v_mfma_f32_32x32x16_bf16 v[48:63], v[220:223], v[168:171], v[48:63]
  ds_read_b64_tr_b16 v[208:209], v252 offset:49152
  ds_read_b64_tr_b16 v[210:211], v252 offset:49664
  ds_read_b64_tr_b16 v[212:213], v253 offset:49152
  ds_read_b64_tr_b16 v[214:215], v253 offset:49664
  ds_read_b64_tr_b16 v[216:217], v252 offset:57344
  ds_read_b64_tr_b16 v[218:219], v252 offset:57856
  ds_read_b64_tr_b16 v[220:221], v253 offset:57344
  ds_read_b64_tr_b16 v[222:223], v253 offset:57856
  s_waitcnt lgkmcnt(8)
  v_mfma_f32_32x32x16_bf16 v[0:15], v[224:227], v[172:175], v[0:15]
  v_mfma_f32_32x32x16_bf16 v[16:31], v[228:231], v[172:175], v[16:31]
  v_mfma_f32_32x32x16_bf16 v[32:47], v[232:235], v[172:175], v[32:47]
  v_mfma_f32_32x32x16_bf16 v[48:63], v[236:239], v[172:175], v[48:63]
  ds_read_b64_tr_b16 v[224:225], v252 offset:51200
  ds_read_b64_tr_b16 v[226:227], v252 offset:51712
  ds_read_b64_tr_b16 v[228:229], v253 offset:51200
  ds_read_b64_tr_b16 v[230:231], v253 offset:51712
  ds_read_b64_tr_b16 v[232:233], v252 offset:59392
  ds_read_b64_tr_b16 v[234:235], v252 offset:59904
  ds_read_b64_tr_b16 v[236:237], v253 offset:59392
  ds_read_b64_tr_b16 v[238:239], v253 offset:59904
  s_waitcnt lgkmcnt(8)
  v_mfma_f32_32x32x16_bf16 v[0:15], v[208:211], v[176:179], v[0:15]
  v_mfma_f32_32x32x16_bf16 v[16:31], v[212:215], v[176:179], v[16:31]
  v_mfma_f32_32x32x16_bf16 v[32:47], v[216:219], v[176:179], v[32:47]
  v_mfma_f32_32x32x16_bf16 v[48:63], v[220:223], v[176:179], v[48:63]
  ds_read_b64_tr_b16 v[208:209], v252 offset:53248
  ds_read_b64_tr_b16 v[210:211], v252 offset:53760
  ds_read_b64_tr_b16 v[212:213], v253 offset:53248
  ds_read_b64_tr_b16 v[214:215], v253 offset:53760
  ds_read_b64_tr_b16 v[216:217], v252 offset:61440
  ds_read_b64_tr_b16 v[218:219], v252 offset:61952
  ds_read_b64_tr_b16 v[220:221], v253 offset:61440
  ds_read_b64_tr_b16 v[222:223], v253 offset:61952
  s_waitcnt lgkmcnt(8)
  v_mfma_f32_32x32x16_bf16 v[0:15], v[224:227], v[180:183], v[0:15]
  v_mfma_f32_32x32x16_bf16 v[16:31], v[228:231], v[180:183], v[16:31]
  v_mfma_f32_32x32x16_bf16 v[32:47], v[232:235], v[180:183], v[32:47]
  v_mfma_f32_32x32x16_bf16 v[48:63], v[236:239], v[180:183], v[48:63]
  s_cmp_lg_u32 s30, 0
  s_cbranch_scc1 G1_QS9
  s_waitcnt vmcnt(0)
  s_barrier
  s_branch G1_QR9
G1_QS9:
  s_waitcnt vmcnt(0)
  s_barrier
G1_QR9:
  ds_read_b64_tr_b16 v[224:225], v252 offset:55296
  ds_read_b64_tr_b16 v[226:227], v252 offset:55808
  ds_read_b64_tr_b16 v[228:229], v253 offset:55296
  ds_read_b64_tr_b16 v[230:231], v253 offset:55808
  ds_read_b64_tr_b16 v[232:233], v252 offset:63488
  ds_read_b64_tr_b16 v[234:235], v252 offset:64000
  ds_read_b64_tr_b16 v[236:237], v253 offset:63488
  ds_read_b64_tr_b16 v[238:239], v253 offset:64000
  s_waitcnt lgkmcnt(8)
  v_mfma_f32_32x32x16_bf16 v[0:15], v[208:211], v[184:187], v[0:15]
  v_mfma_f32_32x32x16_bf16 v[16:31], v[212:215], v[184:187], v[16:31]
  v_mfma_f32_32x32x16_bf16 v[32:47], v[216:219], v[184:187], v[32:47]
  v_mfma_f32_32x32x16_bf16 v[48:63], v[220:223], v[184:187], v[48:63]
  ds_read_b64_tr_b16 v[208:209], v254 offset:0
  ds_read_b64_tr_b16 v[210:211], v254 offset:512
  ds_read_b64_tr_b16 v[212:213], v255 offset:0
  ds_read_b64_tr_b16 v[214:215], v255 offset:512
  ds_read_b64_tr_b16 v[216:217], v254 offset:8192
  ds_read_b64_tr_b16 v[218:219], v254 offset:8704
  ds_read_b64_tr_b16 v[220:221], v255 offset:8192
  ds_read_b64_tr_b16 v[222:223], v255 offset:8704
  s_waitcnt lgkmcnt(8)
  v_mfma_f32_32x32x16_bf16 v[0:15], v[224:227], v[188:191], v[0:15]
  v_mfma_f32_32x32x16_bf16 v[16:31], v[228:231], v[188:191], v[16:31]
  v_mfma_f32_32x32x16_bf16 v[32:47], v[232:235], v[188:191], v[32:47]
  v_mfma_f32_32x32x16_bf16 v[48:63], v[236:239], v[188:191], v[48:63]
  ds_read_b64_tr_b16 v[224:225], v254 offset:2048
  ds_read_b64_tr_b16 v[226:227], v254 offset:2560
  ds_read_b64_tr_b16 v[228:229], v255 offset:2048
  ds_read_b64_tr_b16 v[230:231], v255 offset:2560
  ds_read_b64_tr_b16 v[232:233], v254 offset:10240
  ds_read_b64_tr_b16 v[234:235], v254 offset:10752
  ds_read_b64_tr_b16 v[236:237], v255 offset:10240
  ds_read_b64_tr_b16 v[238:239], v255 offset:10752
  s_waitcnt lgkmcnt(8)
  v_mfma_f32_32x32x16_bf16 v[0:15], v[208:211], v[192:195], v[0:15]
  v_mfma_f32_32x32x16_bf16 v[16:31], v[212:215], v[192:195], v[16:31]
  v_mfma_f32_32x32x16_bf16 v[32:47], v[216:219], v[192:195], v[32:47]
  v_mfma_f32_32x32x16_bf16 v[48:63], v[220:223], v[192:195], v[48:63]
  ds_read_b64_tr_b16 v[208:209], v254 offset:4096
  ds_read_b64_tr_b16 v[210:211], v254 offset:4608
  ds_read_b64_tr_b16 v[212:213], v255 offset:4096
  ds_read_b64_tr_b16 v[214:215], v255 offset:4608
  ds_read_b64_tr_b16 v[216:217], v254 offset:12288
  ds_read_b64_tr_b16 v[218:219], v254 offset:12800
  ds_read_b64_tr_b16 v[220:221], v255 offset:12288
  ds_read_b64_tr_b16 v[222:223], v255 offset:12800
  s_waitcnt lgkmcnt(8)
  v_mfma_f32_32x32x16_bf16 v[0:15], v[224:227], v[196:199], v[0:15]
  v_mfma_f32_32x32x16_bf16 v[16:31], v[228:231], v[196:199], v[16:31]
  v_mfma_f32_32x32x16_bf16 v[32:47], v[232:235], v[196:199], v[32:47]
  v_mfma_f32_32x32x16_bf16 v[48:63], v[236:239], v[196:199], v[48:63]
  ds_read_b64_tr_b16 v[224:225], v254 offset:6144
  ds_read_b64_tr_b16 v[226:227], v254 offset:6656
  ds_read_b64_tr_b16 v[228:229], v255 offset:6144
  ds_read_b64_tr_b16 v[230:231], v255 offset:6656
  ds_read_b64_tr_b16 v[232:233], v254 offset:14336
  ds_read_b64_tr_b16 v[234:235], v254 offset:14848
  ds_read_b64_tr_b16 v[236:237], v255 offset:14336
  ds_read_b64_tr_b16 v[238:239], v255 offset:14848
  s_waitcnt lgkmcnt(8)
  v_mfma_f32_32x32x16_bf16 v[0:15], v[208:211], v[200:203], v[0:15]
  v_mfma_f32_32x32x16_bf16 v[16:31], v[212:215], v[200:203], v[16:31]
  v_mfma_f32_32x32x16_bf16 v[32:47], v[216:219], v[200:203], v[32:47]
  v_mfma_f32_32x32x16_bf16 v[48:63], v[220:223], v[200:203], v[48:63]
  s_waitcnt lgkmcnt(0)
  v_mfma_f32_32x32x16_bf16 v[0:15], v[224:227], v[204:207], v[0:15]
  v_mfma_f32_32x32x16_bf16 v[16:31], v[228:231], v[204:207], v[16:31]
  v_mfma_f32_32x32x16_bf16 v[32:47], v[232:235], v[204:207], v[32:47]
  v_mfma_f32_32x32x16_bf16 v[48:63], v[236:239], v[204:207], v[48:63]
  s_barrier
  s_nop 15
  s_mov_b32 s30, 1
  s_mov_b32 s20, 0x3eae1a93
  s_cmp_eq_u32 s22, 0
  s_cselect_b32 s20, s20, 1.0
  v_lshl_add_u32 v248, v246, 6, s57
  v_bfe_u32 v249, v246, 1, 2
  v_lshlrev_b32 v249, 4, v249

  v_mul_u32_u24 v208, 8, v247
  v_mul_f32 v209, s20, v0
  v_mul_f32 v210, s20, v1
  v_add_u32 v208, 0, v208
  v_xor_b32 v208, v208, v249
  v_cvt_pk_bf16_f32 v209, v209, v210
  v_add_u32 v208, v208, v248
  ds_write_b32 v208, v209
  v_mul_u32_u24 v212, 8, v247
  v_mul_f32 v213, s20, v2
  v_mul_f32 v214, s20, v3
  v_add_u32 v212, 4, v212
  v_xor_b32 v212, v212, v249
  v_cvt_pk_bf16_f32 v213, v213, v214
  v_add_u32 v212, v212, v248
  ds_write_b32 v212, v213
  v_mul_u32_u24 v216, 8, v247
  v_mul_f32 v217, s20, v4
  v_mul_f32 v218, s20, v5
  v_add_u32 v216, 16, v216
  v_xor_b32 v216, v216, v249
  v_cvt_pk_bf16_f32 v217, v217, v218
  v_add_u32 v216, v216, v248
  ds_write_b32 v216, v217
  v_mul_u32_u24 v220, 8, v247
  v_mul_f32 v221, s20, v6
  v_mul_f32 v222, s20, v7
  v_add_u32 v220, 20, v220
  v_xor_b32 v220, v220, v249
  v_cvt_pk_bf16_f32 v221, v221, v222
  v_add_u32 v220, v220, v248
  ds_write_b32 v220, v221
  v_mul_u32_u24 v208, 2020, v247
  v_mul_f32 v209, s20, v8
  v_mul_f32 v210, s20, v9
  v_add_u32 v208, 32, v208
  v_xor_b32 v208, v208, v249
  v_cvt_pk_bf16_f32 v209, v209, v210
  v_add_u32 v208, v208, v248
  ds_write_b32 v208, v209
  v_mul_u32_u24 v212, 8, v247
  v_mul_f32 v213, s20, v10
  v_mul_f32 v214, s20, v11
  v_add_u32 v212, 2048, v212
  v_xor_b32 v212, v212, v249
  v_cvt_pk_bf16_f32 v213, v213, v214
  v_add_u32 v212, v212, v248
  ds_write_b32 v212, v213
  v_mul_u32_u24 v216, 8, v247
  v_mul_f32 v217, s20, v12
  v_mul_f32 v218, s20, v13
  v_add_u32 v216, 2060, v216
  v_xor_b32 v216, v216, v249
  v_cvt_pk_bf16_f32 v217, v217, v218
  v_add_u32 v216, v216, v248
  ds_write_b32 v216, v217
  v_mul_u32_u24 v220, 8, v247
  v_mul_f32 v221, s20, v14
  v_mul_f32 v222, s20, v15
  v_add_u32 v220, 2064, v220
  v_xor_b32 v220, v220, v249
  v_cvt_pk_bf16_f32 v221, v221, v222
  v_add_u32 v220, v220, v248
  ds_write_b32 v220, v221
  v_mul_u32_u24 v208, 2020, v247
  v_mul_f32 v209, s20, v16
  v_mul_f32 v210, s20, v17
  v_add_u32 v208, 2076, v208
  v_xor_b32 v208, v208, v249
  v_cvt_pk_bf16_f32 v209, v209, v210
  v_add_u32 v208, v208, v248
  ds_write_b32 v208, v209
  v_mul_u32_u24 v212, 2020, v247
  v_mul_f32 v213, s20, v18
  v_mul_f32 v214, s20, v19
  v_add_u32 v212, 2080, v212
  v_xor_b32 v212, v212, v249
  v_cvt_pk_bf16_f32 v213, v213, v214
  v_add_u32 v212, v212, v248
  ds_write_b32 v212, v213
  v_mul_u32_u24 v216, 8, v247
  v_mul_f32 v217, s20, v20
  v_mul_f32 v218, s20, v21
  v_add_u32 v216, 4104, v216
  v_xor_b32 v216, v216, v249
  v_cvt_pk_bf16_f32 v217, v217, v218
  v_add_u32 v216, v216, v248
  ds_write_b32 v216, v217
  v_mul_u32_u24 v220, 8, v247
  v_mul_f32 v221, s20, v22
  v_mul_f32 v222, s20, v23
  v_add_u32 v220, 4108, v220
  v_xor_b32 v220, v220, v249
  v_cvt_pk_bf16_f32 v221, v221, v222
  v_add_u32 v220, v220, v248
  ds_write_b32 v220, v221
  v_mul_u32_u24 v208, 8, v247
  v_mul_f32 v209, s20, v24
  v_mul_f32 v210, s20, v25
  v_add_u32 v208, 4120, v208
  v_xor_b32 v208, v208, v249
  v_cvt_pk_bf16_f32 v209, v209, v210
  v_add_u32 v208, v208, v248
  ds_write_b32 v208, v209
  v_mul_u32_u24 v212, 2020, v247
  v_mul_f32 v213, s20, v26
  v_mul_f32 v214, s20, v27
  v_add_u32 v212, 4124, v212
  v_xor_b32 v212, v212, v249
  v_cvt_pk_bf16_f32 v213, v213, v214
  v_add_u32 v212, v212, v248
  ds_write_b32 v212, v213
  v_mul_u32_u24 v216, 8, v247
  v_mul_f32 v217, s20, v28
  v_mul_f32 v218, s20, v29
  v_add_u32 v216, 6148, v216
  v_xor_b32 v216, v216, v249
  v_cvt_pk_bf16_f32 v217, v217, v218
  v_add_u32 v216, v216, v248
  ds_write_b32 v216, v217
  v_mul_u32_u24 v220, 8, v247
  v_mul_f32 v221, s20, v30
  v_mul_f32 v222, s20, v31
  v_add_u32 v220, 6152, v220
  v_xor_b32 v220, v220, v249
  v_cvt_pk_bf16_f32 v221, v221, v222
  v_add_u32 v220, v220, v248
  ds_write_b32 v220, v221
  v_mul_u32_u24 v208, 8, v247
  v_mul_f32 v209, s20, v32
  v_mul_f32 v210, s20, v33
  v_add_u32 v208, 6164, v208
  v_xor_b32 v208, v208, v249
  v_cvt_pk_bf16_f32 v209, v209, v210
  v_add_u32 v208, v208, v248
  ds_write_b32 v208, v209
  v_mul_u32_u24 v212, 8, v247
  v_mul_f32 v213, s20, v34
  v_mul_f32 v214, s20, v35
  v_add_u32 v212, 6168, v212
  v_xor_b32 v212, v212, v249
  v_cvt_pk_bf16_f32 v213, v213, v214
  v_add_u32 v212, v212, v248
  ds_write_b32 v212, v213
  v_mul_u32_u24 v216, 8, v247
  v_mul_f32 v217, s20, v36
  v_mul_f32 v218, s20, v37
  v_add_u32 v216, 8192, v216
  v_xor_b32 v216, v216, v249
  v_cvt_pk_bf16_f32 v217, v217, v218
  v_add_u32 v216, v216, v248
  ds_write_b32 v216, v217
  v_mul_u32_u24 v220, 8, v247
  v_mul_f32 v221, s20, v38
  v_mul_f32 v222, s20, v39
  v_add_u32 v220, 8196, v220
  v_xor_b32 v220, v220, v249
  v_cvt_pk_bf16_f32 v221, v221, v222
  v_add_u32 v220, v220, v248
  ds_write_b32 v220, v221
  v_mul_u32_u24 v208, 8, v247
  v_mul_f32 v209, s20, v40
  v_mul_f32 v210, s20, v41
  v_add_u32 v208, 8208, v208
  v_xor_b32 v208, v208, v249
  v_cvt_pk_bf16_f32 v209, v209, v210
  v_add_u32 v208, v208, v248
  ds_write_b32 v208, v209
  v_mul_u32_u24 v212, 8, v247
  v_mul_f32 v213, s20, v42
  v_mul_f32 v214, s20, v43
  v_add_u32 v212, 8212, v212
  v_xor_b32 v212, v212, v249
  v_cvt_pk_bf16_f32 v213, v213, v214
  v_add_u32 v212, v212, v248
  ds_write_b32 v212, v213
  v_mul_u32_u24 v216, 2020, v247
  v_mul_f32 v217, s20, v44
  v_mul_f32 v218, s20, v45
  v_add_u32 v216, 8224, v216
  v_xor_b32 v216, v216, v249
  v_cvt_pk_bf16_f32 v217, v217, v218
  v_add_u32 v216, v216, v248
  ds_write_b32 v216, v217
  v_mul_u32_u24 v220, 8, v247
  v_mul_f32 v221, s20, v46
  v_mul_f32 v222, s20, v47
  v_add_u32 v220, 10240, v220
  v_xor_b32 v220, v220, v249
  v_cvt_pk_bf16_f32 v221, v221, v222
  v_add_u32 v220, v220, v248
  ds_write_b32 v220, v221
  v_mul_u32_u24 v208, 8, v247
  v_mul_f32 v209, s20, v48
  v_mul_f32 v210, s20, v49
  v_add_u32 v208, 10252, v208
  v_xor_b32 v208, v208, v249
  v_cvt_pk_bf16_f32 v209, v209, v210
  v_add_u32 v208, v208, v248
  ds_write_b32 v208, v209
  v_mul_u32_u24 v212, 8, v247
  v_mul_f32 v213, s20, v50
  v_mul_f32 v214, s20, v51
  v_add_u32 v212, 10256, v212
  v_xor_b32 v212, v212, v249
  v_cvt_pk_bf16_f32 v213, v213, v214
  v_add_u32 v212, v212, v248
  ds_write_b32 v212, v213
  v_mul_u32_u24 v216, 2020, v247
  v_mul_f32 v217, s20, v52
  v_mul_f32 v218, s20, v53
  v_add_u32 v216, 10268, v216
  v_xor_b32 v216, v216, v249
  v_cvt_pk_bf16_f32 v217, v217, v218
  v_add_u32 v216, v216, v248
  ds_write_b32 v216, v217
  v_mul_u32_u24 v220, 2020, v247
  v_mul_f32 v221, s20, v54
  v_mul_f32 v222, s20, v55
  v_add_u32 v220, 10272, v220
  v_xor_b32 v220, v220, v249
  v_cvt_pk_bf16_f32 v221, v221, v222
  v_add_u32 v220, v220, v248
  ds_write_b32 v220, v221
  v_mul_u32_u24 v208, 8, v247
  v_mul_f32 v209, s20, v56
  v_mul_f32 v210, s20, v57
  v_add_u32 v208, 12296, v208
  v_xor_b32 v208, v208, v249
  v_cvt_pk_bf16_f32 v209, v209, v210
  v_add_u32 v208, v208, v248
  ds_write_b32 v208, v209
  v_mul_u32_u24 v212, 8, v247
  v_mul_f32 v213, s20, v58
  v_mul_f32 v214, s20, v59
  v_add_u32 v212, 12300, v212
  v_xor_b32 v212, v212, v249
  v_cvt_pk_bf16_f32 v213, v213, v214
  v_add_u32 v212, v212, v248
  ds_write_b32 v212, v213
  v_mul_u32_u24 v216, 8, v247
  v_mul_f32 v217, s20, v60
  v_mul_f32 v218, s20, v61
  v_add_u32 v216, 12312, v216
  v_xor_b32 v216, v216, v249
  v_cvt_pk_bf16_f32 v217, v217, v218
  v_add_u32 v216, v216, v248
  ds_write_b32 v216, v217
  v_mul_u32_u24 v220, 2020, v247
  v_mul_f32 v221, s20, v62
  v_mul_f32 v222, s20, v63
  v_add_u32 v220, 12316, v220
  v_xor_b32 v220, v220, v249
  v_cvt_pk_bf16_f32 v221, v221, v222
  v_add_u32 v220, v220, v248
  ds_write_b32 v220, v221
  v_lshrrev_b32 v248, 2, v245
  v_and_b32 v249, 3, v245
  v_bfe_u32 v250, v245, 3, 2
  v_xor_b32 v250, v250, v249
  v_lshlrev_b32 v250, 4, v250
  v_lshl_add_u32 v250, v248, 6, v250
  v_add_u32 v250, s57, v250
  v_cmp_gt_u32 vcc, 3, v249
  v_cndmask_b32 v251, 0, -1, vcc
  v_cmp_gt_u32 vcc, 2, v249
  v_cndmask_b32 v241, 0, -1, vcc
  s_lshl_b32 s59, s56, 5
  s_add_u32 s59, s59, s12
  v_add_u32 v248, s59, v248
  v_lshlrev_b32 v248, 6, v248
  v_lshl_add_u32 v248, v249, 4, v248
  s_lshl_b32 s59, s22, 22
  s_add_u32 s59, s59, 4194304
  s_lshl_b32 s25, s24, 17
  s_add_u32 s59, s59, s25
  v_add_u32 v248, s59, v248
  s_waitcnt lgkmcnt(0)

  ds_read_b128 v[208:211], v250 offset:0
  ds_read_b128 v[212:215], v250 offset:1024
  ds_read_b128 v[216:219], v250 offset:2048
  ds_read_b128 v[220:223], v250 offset:3072
  s_waitcnt lgkmcnt(3)
  v_and_b32 v208, v208, v251
  v_and_b32 v209, v209, v241
  v_and_b32 v210, v210, v241
  v_and_b32 v211, v211, v241
  s_mov_b32 s59, 0
  buffer_store_dwordx4 v[208:211], v248, s[60:63], s59 offen
  s_waitcnt lgkmcnt(2)
  v_and_b32 v212, v212, v251
  v_and_b32 v213, v213, v241
  v_and_b32 v214, v214, v241
  v_and_b32 v215, v215, v241
  s_mov_b32 s59, 1024
  buffer_store_dwordx4 v[212:215], v248, s[60:63], s59 offen
  s_waitcnt lgkmcnt(1)
  v_and_b32 v216, v216, v251
  v_and_b32 v217, v217, v241
  v_and_b32 v218, v218, v241
  v_and_b32 v219, v219, v241
  s_mov_b32 s59, 131072
  buffer_store_dwordx4 v[216:219], v248, s[60:63], s59 offen
  s_waitcnt lgkmcnt(0)
  v_and_b32 v220, v220, v251
  v_and_b32 v221, v221, v241
  v_and_b32 v222, v222, v241
  v_and_b32 v223, v223, v241
  s_mov_b32 s59, 132096
  buffer_store_dwordx4 v[220:223], v248, s[60:63], s59 offen
  ds_read_b128 v[208:211], v250 offset:4096
  ds_read_b128 v[212:215], v250 offset:5120
  ds_read_b128 v[216:219], v250 offset:6144
  ds_read_b128 v[220:223], v250 offset:7168
  s_waitcnt lgkmcnt(3)
  v_and_b32 v208, v208, v251
  v_and_b32 v209, v209, v241
  v_and_b32 v210, v210, v241
  v_and_b32 v211, v211, v241
  s_mov_b32 s59, 262144
  buffer_store_dwordx4 v[208:211], v248, s[60:63], s59 offen
  s_waitcnt lgkmcnt(2)
  v_and_b32 v212, v212, v251
  v_and_b32 v213, v213, v241
  v_and_b32 v214, v214, v241
  v_and_b32 v215, v215, v241
  s_mov_b32 s59, 263168
  buffer_store_dwordx4 v[212:215], v248, s[60:63], s59 offen
  s_waitcnt lgkmcnt(1)
  v_and_b32 v216, v216, v251
  v_and_b32 v217, v217, v241
  v_and_b32 v218, v218, v241
  v_and_b32 v219, v219, v241
  s_mov_b32 s59, 393216
  buffer_store_dwordx4 v[216:219], v248, s[60:63], s59 offen
  s_waitcnt lgkmcnt(0)
  v_and_b32 v220, v220, v251
  v_and_b32 v221, v221, v241
  v_and_b32 v222, v222, v241
  v_and_b32 v223, v223, v241
  s_mov_b32 s59, 394240
  buffer_store_dwordx4 v[220:223], v248, s[60:63], s59 offen
  s_cmp_eq_u32 s23, 4
  s_cbranch_scc1 G1_QNEXT
  ds_read_b128 v[208:211], v250 offset:8192
  ds_read_b128 v[212:215], v250 offset:9216
  ds_read_b128 v[216:219], v250 offset:10240
  ds_read_b128 v[220:223], v250 offset:11264
  s_waitcnt lgkmcnt(3)
  v_and_b32 v208, v208, v251
  v_and_b32 v209, v209, v241
  v_and_b32 v210, v210, v241
  v_and_b32 v211, v211, v241
  s_mov_b32 s59, 524288
  buffer_store_dwordx4 v[208:211], v248, s[60:63], s59 offen
  s_waitcnt lgkmcnt(2)
  v_and_b32 v212, v212, v251
  v_and_b32 v213, v213, v241
  v_and_b32 v214, v214, v241
  v_and_b32 v215, v215, v241
  s_mov_b32 s59, 525312
  buffer_store_dwordx4 v[212:215], v248, s[60:63], s59 offen
  s_waitcnt lgkmcnt(1)
  v_and_b32 v216, v216, v251
  v_and_b32 v217, v217, v241
  v_and_b32 v218, v218, v241
  v_and_b32 v219, v219, v241
  s_mov_b32 s59, 655360
  buffer_store_dwordx4 v[216:219], v248, s[60:63], s59 offen
  s_waitcnt lgkmcnt(0)
  v_and_b32 v220, v220, v251
  v_and_b32 v221, v221, v241
  v_and_b32 v222, v222, v241
  v_and_b32 v223, v223, v241
  s_mov_b32 s59, 656384
  buffer_store_dwordx4 v[220:223], v248, s[60:63], s59 offen
  ds_read_b128 v[208:211], v250 offset:12288
  ds_read_b128 v[212:215], v250 offset:13312
  s_waitcnt lgkmcnt(1)
  v_and_b32 v208, v208, v251
  v_and_b32 v209, v209, v241
  v_and_b32 v210, v210, v241
  v_and_b32 v211, v211, v241
  s_mov_b32 s59, 786432
  buffer_store_dwordx4 v[208:211], v248, s[60:63], s59 offen
  s_waitcnt lgkmcnt(0)
  v_and_b32 v212, v212, v251
  v_and_b32 v213, v213, v241
  v_and_b32 v214, v214, v241
  v_and_b32 v215, v215, v241
  s_mov_b32 s59, 787456
  buffer_store_dwordx4 v[212:215], v248, s[60:63], s59 offen
  s_branch G1_QNEXT
G1_QV:
  s_cmp_lg_u32 s30, 0
  s_cbranch_scc1 G1_QS10
  s_waitcnt vmcnt(6)
  s_barrier
  s_add_u32 m0, s55, 32768
  s_nop 0
  buffer_load_dwordx4 v240, s[44:47], s53 offen lds
  s_add_u32 m0, s55, 40960
  s_nop 0
  buffer_load_dwordx4 v240, s[48:51], s53 offen lds
  s_add_u32 s53, s53, s17
  s_mov_b32 s59, 8192
  buffer_load_dwordx4 v[96:99], v244, s[40:43], s59 offen
  s_mov_b32 s59, 9216
  buffer_load_dwordx4 v[100:103], v244, s[40:43], s59 offen
  s_mov_b32 s59, 10240
  buffer_load_dwordx4 v[104:107], v244, s[40:43], s59 offen
  s_mov_b32 s59, 11264
  buffer_load_dwordx4 v[108:111], v244, s[40:43], s59 offen
  s_branch G1_QR10
G1_QS10:
  s_waitcnt vmcnt(16)
  s_barrier
G1_QR10:
  ds_read_b64_tr_b16 v[208:209], v242 offset:0
  ds_read_b64_tr_b16 v[210:211], v242 offset:512
  ds_read_b64_tr_b16 v[212:213], v243 offset:0
  ds_read_b64_tr_b16 v[214:215], v243 offset:512
  ds_read_b64_tr_b16 v[216:217], v242 offset:8192
  ds_read_b64_tr_b16 v[218:219], v242 offset:8704
  ds_read_b64_tr_b16 v[220:221], v243 offset:8192
  ds_read_b64_tr_b16 v[222:223], v243 offset:8704
  ds_read_b64_tr_b16 v[224:225], v242 offset:2048
  ds_read_b64_tr_b16 v[226:227], v242 offset:2560
  ds_read_b64_tr_b16 v[228:229], v243 offset:2048
  ds_read_b64_tr_b16 v[230:231], v243 offset:2560
  ds_read_b64_tr_b16 v[232:233], v242 offset:10240
  ds_read_b64_tr_b16 v[234:235], v242 offset:10752
  ds_read_b64_tr_b16 v[236:237], v243 offset:10240
  ds_read_b64_tr_b16 v[238:239], v243 offset:10752
  s_waitcnt lgkmcnt(8)
  v_mfma_f32_32x32x16_bf16 v[0:15], v[64:67], v[208:211], 0
  v_mfma_f32_32x32x16_bf16 v[16:31], v[64:67], v[212:215], 0
  v_mfma_f32_32x32x16_bf16 v[32:47], v[64:67], v[216:219], 0
  v_mfma_f32_32x32x16_bf16 v[48:63], v[64:67], v[220:223], 0
  ds_read_b64_tr_b16 v[208:209], v242 offset:4096
  ds_read_b64_tr_b16 v[210:211], v242 offset:4608
  ds_read_b64_tr_b16 v[212:213], v243 offset:4096
  ds_read_b64_tr_b16 v[214:215], v243 offset:4608
  ds_read_b64_tr_b16 v[216:217], v242 offset:12288
  ds_read_b64_tr_b16 v[218:219], v242 offset:12800
  ds_read_b64_tr_b16 v[220:221], v243 offset:12288
  ds_read_b64_tr_b16 v[222:223], v243 offset:12800
  s_waitcnt lgkmcnt(8)
  v_mfma_f32_32x32x16_bf16 v[0:15], v[68:71], v[224:227], v[0:15]
  v_mfma_f32_32x32x16_bf16 v[16:31], v[68:71], v[228:231], v[16:31]
  v_mfma_f32_32x32x16_bf16 v[32:47], v[68:71], v[232:235], v[32:47]
  v_mfma_f32_32x32x16_bf16 v[48:63], v[68:71], v[236:239], v[48:63]
  s_cmp_lg_u32 s30, 0
  s_cbranch_scc1 G1_QS11
  s_waitcnt vmcnt(6)
  s_barrier
  s_add_u32 m0, s55, 49152
  s_nop 0
  buffer_load_dwordx4 v240, s[44:47], s53 offen lds
  s_add_u32 m0, s55, 57344
  s_nop 0
  buffer_load_dwordx4 v240, s[48:51], s53 offen lds
  s_add_u32 s53, s53, s17
  s_mov_b32 s59, 12288
  buffer_load_dwordx4 v[112:115], v244, s[40:43], s59 offen
  s_mov_b32 s59, 13312
  buffer_load_dwordx4 v[116:119], v244, s[40:43], s59 offen
  s_mov_b32 s59, 14336
  buffer_load_dwordx4 v[120:123], v244, s[40:43], s59 offen
  s_mov_b32 s59, 15360
  buffer_load_dwordx4 v[124:127], v244, s[40:43], s59 offen
  s_branch G1_QR11
G1_QS11:
  s_waitcnt vmcnt(14)
  s_barrier
G1_QR11:
  ds_read_b64_tr_b16 v[224:225], v242 offset:6144
  ds_read_b64_tr_b16 v[226:227], v242 offset:6656
  ds_read_b64_tr_b16 v[228:229], v243 offset:6144
  ds_read_b64_tr_b16 v[230:231], v243 offset:6656
  ds_read_b64_tr_b16 v[232:233], v242 offset:14336
  ds_read_b64_tr_b16 v[234:235], v242 offset:14848
  ds_read_b64_tr_b16 v[236:237], v243 offset:14336
  ds_read_b64_tr_b16 v[238:239], v243 offset:14848
  s_waitcnt lgkmcnt(8)
  v_mfma_f32_32x32x16_bf16 v[0:15], v[72:75], v[208:211], v[0:15]
  v_mfma_f32_32x32x16_bf16 v[16:31], v[72:75], v[212:215], v[16:31]
  v_mfma_f32_32x32x16_bf16 v[32:47], v[72:75], v[216:219], v[32:47]
  v_mfma_f32_32x32x16_bf16 v[48:63], v[72:75], v[220:223], v[48:63]
  ds_read_b64_tr_b16 v[208:209], v242 offset:16384
  ds_read_b64_tr_b16 v[210:211], v242 offset:16896
  ds_read_b64_tr_b16 v[212:213], v243 offset:16384
  ds_read_b64_tr_b16 v[214:215], v243 offset:16896
  ds_read_b64_tr_b16 v[216:217], v242 offset:24576
  ds_read_b64_tr_b16 v[218:219], v242 offset:25088
  ds_read_b64_tr_b16 v[220:221], v243 offset:24576
  ds_read_b64_tr_b16 v[222:223], v243 offset:25088
  s_waitcnt lgkmcnt(8)
  v_mfma_f32_32x32x16_bf16 v[0:15], v[76:79], v[224:227], v[0:15]
  v_mfma_f32_32x32x16_bf16 v[16:31], v[76:79], v[228:231], v[16:31]
  v_mfma_f32_32x32x16_bf16 v[32:47], v[76:79], v[232:235], v[32:47]
  v_mfma_f32_32x32x16_bf16 v[48:63], v[76:79], v[236:239], v[48:63]
  ds_read_b64_tr_b16 v[224:225], v242 offset:18432
  ds_read_b64_tr_b16 v[226:227], v242 offset:18944
  ds_read_b64_tr_b16 v[228:229], v243 offset:18432
  ds_read_b64_tr_b16 v[230:231], v243 offset:18944
  ds_read_b64_tr_b16 v[232:233], v242 offset:26624
  ds_read_b64_tr_b16 v[234:235], v242 offset:27136
  ds_read_b64_tr_b16 v[236:237], v243 offset:26624
  ds_read_b64_tr_b16 v[238:239], v243 offset:27136
  s_waitcnt lgkmcnt(8)
  v_mfma_f32_32x32x16_bf16 v[0:15], v[80:83], v[208:211], v[0:15]
  v_mfma_f32_32x32x16_bf16 v[16:31], v[80:83], v[212:215], v[16:31]
  v_mfma_f32_32x32x16_bf16 v[32:47], v[80:83], v[216:219], v[32:47]
  v_mfma_f32_32x32x16_bf16 v[48:63], v[80:83], v[220:223], v[48:63]
  ds_read_b64_tr_b16 v[208:209], v242 offset:20480
  ds_read_b64_tr_b16 v[210:211], v242 offset:20992
  ds_read_b64_tr_b16 v[212:213], v243 offset:20480
  ds_read_b64_tr_b16 v[214:215], v243 offset:20992
  ds_read_b64_tr_b16 v[216:217], v242 offset:28672
  ds_read_b64_tr_b16 v[218:219], v242 offset:29184
  ds_read_b64_tr_b16 v[220:221], v243 offset:28672
  ds_read_b64_tr_b16 v[222:223], v243 offset:29184
  s_waitcnt lgkmcnt(8)
  v_mfma_f32_32x32x16_bf16 v[0:15], v[84:87], v[224:227], v[0:15]
  v_mfma_f32_32x32x16_bf16 v[16:31], v[84:87], v[228:231], v[16:31]
  v_mfma_f32_32x32x16_bf16 v[32:47], v[84:87], v[232:235], v[32:47]
  v_mfma_f32_32x32x16_bf16 v[48:63], v[84:87], v[236:239], v[48:63]
  s_cmp_lg_u32 s30, 0
  s_cbranch_scc1 G1_QS12
  s_waitcnt vmcnt(6)
  s_barrier
  s_add_u32 m0, s55, 65536
  s_nop 0
  buffer_load_dwordx4 v240, s[44:47], s53 offen lds
  s_add_u32 m0, s55, 73728
  s_nop 0
  buffer_load_dwordx4 v240, s[48:51], s53 offen lds
  s_add_u32 s53, s53, s17
  s_mov_b32 s59, 16384
  buffer_load_dwordx4 v[128:131], v244, s[40:43], s59 offen
  s_mov_b32 s59, 17408
  buffer_load_dwordx4 v[132:135], v244, s[40:43], s59 offen
  s_mov_b32 s59, 18432
  buffer_load_dwordx4 v[136:139], v244, s[40:43], s59 offen
  s_mov_b32 s59, 19456
  buffer_load_dwordx4 v[140:143], v244, s[40:43], s59 offen
  s_branch G1_QR12
G1_QS12:
  s_waitcnt vmcnt(12)
  s_barrier
G1_QR12:
  ds_read_b64_tr_b16 v[224:225], v242 offset:22528
  ds_read_b64_tr_b16 v[226:227], v242 offset:23040
  ds_read_b64_tr_b16 v[228:229], v243 offset:22528
  ds_read_b64_tr_b16 v[230:231], v243 offset:23040
  ds_read_b64_tr_b16 v[232:233], v242 offset:30720
  ds_read_b64_tr_b16 v[234:235], v242 offset:31232
  ds_read_b64_tr_b16 v[236:237], v243 offset:30720
  ds_read_b64_tr_b16 v[238:239], v243 offset:31232
  s_waitcnt lgkmcnt(8)
  v_mfma_f32_32x32x16_bf16 v[0:15], v[88:91], v[208:211], v[0:15]
  v_mfma_f32_32x32x16_bf16 v[16:31], v[88:91], v[212:215], v[16:31]
  v_mfma_f32_32x32x16_bf16 v[32:47], v[88:91], v[216:219], v[32:47]
  v_mfma_f32_32x32x16_bf16 v[48:63], v[88:91], v[220:223], v[48:63]
  ds_read_b64_tr_b16 v[208:209], v242 offset:32768
  ds_read_b64_tr_b16 v[210:211], v242 offset:33280
  ds_read_b64_tr_b16 v[212:213], v243 offset:32768
  ds_read_b64_tr_b16 v[214:215], v243 offset:33280
  ds_read_b64_tr_b16 v[216:217], v242 offset:40960
  ds_read_b64_tr_b16 v[218:219], v242 offset:41472
  ds_read_b64_tr_b16 v[220:221], v243 offset:40960
  ds_read_b64_tr_b16 v[222:223], v243 offset:41472
  s_waitcnt lgkmcnt(8)
  v_mfma_f32_32x32x16_bf16 v[0:15], v[92:95], v[224:227], v[0:15]
  v_mfma_f32_32x32x16_bf16 v[16:31], v[92:95], v[228:231], v[16:31]
  v_mfma_f32_32x32x16_bf16 v[32:47], v[92:95], v[232:235], v[32:47]
  v_mfma_f32_32x32x16_bf16 v[48:63], v[92:95], v[236:239], v[48:63]
  ds_read_b64_tr_b16 v[224:225], v242 offset:34816
  ds_read_b64_tr_b16 v[226:227], v242 offset:35328
  ds_read_b64_tr_b16 v[228:229], v243 offset:34816
  ds_read_b64_tr_b16 v[230:231], v243 offset:35328
  ds_read_b64_tr_b16 v[232:233], v242 offset:43008
  ds_read_b64_tr_b16 v[234:235], v242 offset:43520
  ds_read_b64_tr_b16 v[236:237], v243 offset:43008
  ds_read_b64_tr_b16 v[238:239], v243 offset:43520
  s_waitcnt lgkmcnt(8)
  v_mfma_f32_32x32x16_bf16 v[0:15], v[96:99], v[208:211], v[0:15]
  v_mfma_f32_32x32x16_bf16 v[16:31], v[96:99], v[212:215], v[16:31]
  v_mfma_f32_32x32x16_bf16 v[32:47], v[96:99], v[216:219], v[32:47]
  v_mfma_f32_32x32x16_bf16 v[48:63], v[96:99], v[220:223], v[48:63]
  ds_read_b64_tr_b16 v[208:209], v242 offset:36864
  ds_read_b64_tr_b16 v[210:211], v242 offset:37376
  ds_read_b64_tr_b16 v[212:213], v243 offset:36864
  ds_read_b64_tr_b16 v[214:215], v243 offset:37376
  ds_read_b64_tr_b16 v[216:217], v242 offset:45056
  ds_read_b64_tr_b16 v[218:219], v242 offset:45568
  ds_read_b64_tr_b16 v[220:221], v243 offset:45056
  ds_read_b64_tr_b16 v[222:223], v243 offset:45568
  s_waitcnt lgkmcnt(8)
  v_mfma_f32_32x32x16_bf16 v[0:15], v[100:103], v[224:227], v[0:15]
  v_mfma_f32_32x32x16_bf16 v[16:31], v[100:103], v[228:231], v[16:31]
  v_mfma_f32_32x32x16_bf16 v[32:47], v[100:103], v[232:235], v[32:47]
  v_mfma_f32_32x32x16_bf16 v[48:63], v[100:103], v[236:239], v[48:63]
  s_cmp_lg_u32 s30, 0
  s_cbranch_scc1 G1_QS13
  s_waitcnt vmcnt(6)
  s_barrier
  s_add_u32 m0, s55, 81920
  s_nop 0
  buffer_load_dwordx4 v240, s[44:47], s53 offen lds
  s_add_u32 m0, s55, 90112
  s_nop 0
  buffer_load_dwordx4 v240, s[48:51], s53 offen lds
  s_add_u32 s53, s53, s17
  s_mov_b32 s59, 20480
  buffer_load_dwordx4 v[144:147], v244, s[40:43], s59 offen
  s_mov_b32 s59, 21504
  buffer_load_dwordx4 v[148:151], v244, s[40:43], s59 offen
  s_mov_b32 s59, 22528
  buffer_load_dwordx4 v[152:155], v244, s[40:43], s59 offen
  s_mov_b32 s59, 23552
  buffer_load_dwordx4 v[156:159], v244, s[40:43], s59 offen
  s_branch G1_QR13
G1_QS13:
  s_waitcnt vmcnt(10)
  s_barrier
G1_QR13:
  ds_read_b64_tr_b16 v[224:225], v242 offset:38912
  ds_read_b64_tr_b16 v[226:227], v242 offset:39424
  ds_read_b64_tr_b16 v[228:229], v243 offset:38912
  ds_read_b64_tr_b16 v[230:231], v243 offset:39424
  ds_read_b64_tr_b16 v[232:233], v242 offset:47104
  ds_read_b64_tr_b16 v[234:235], v242 offset:47616
  ds_read_b64_tr_b16 v[236:237], v243 offset:47104
  ds_read_b64_tr_b16 v[238:239], v243 offset:47616
  s_waitcnt lgkmcnt(8)
  v_mfma_f32_32x32x16_bf16 v[0:15], v[104:107], v[208:211], v[0:15]
  v_mfma_f32_32x32x16_bf16 v[16:31], v[104:107], v[212:215], v[16:31]
  v_mfma_f32_32x32x16_bf16 v[32:47], v[104:107], v[216:219], v[32:47]
  v_mfma_f32_32x32x16_bf16 v[48:63], v[104:107], v[220:223], v[48:63]
  ds_read_b64_tr_b16 v[208:209], v242 offset:49152
  ds_read_b64_tr_b16 v[210:211], v242 offset:49664
  ds_read_b64_tr_b16 v[212:213], v243 offset:49152
  ds_read_b64_tr_b16 v[214:215], v243 offset:49664
  ds_read_b64_tr_b16 v[216:217], v242 offset:57344
  ds_read_b64_tr_b16 v[218:219], v242 offset:57856
  ds_read_b64_tr_b16 v[220:221], v243 offset:57344
  ds_read_b64_tr_b16 v[222:223], v243 offset:57856
  s_waitcnt lgkmcnt(8)
  v_mfma_f32_32x32x16_bf16 v[0:15], v[108:111], v[224:227], v[0:15]
  v_mfma_f32_32x32x16_bf16 v[16:31], v[108:111], v[228:231], v[16:31]
  v_mfma_f32_32x32x16_bf16 v[32:47], v[108:111], v[232:235], v[32:47]
  v_mfma_f32_32x32x16_bf16 v[48:63], v[108:111], v[236:239], v[48:63]
  ds_read_b64_tr_b16 v[224:225], v242 offset:51200
  ds_read_b64_tr_b16 v[226:227], v242 offset:51712
  ds_read_b64_tr_b16 v[228:229], v243 offset:51200
  ds_read_b64_tr_b16 v[230:231], v243 offset:51712
  ds_read_b64_tr_b16 v[232:233], v242 offset:59392
  ds_read_b64_tr_b16 v[234:235], v242 offset:59904
  ds_read_b64_tr_b16 v[236:237], v243 offset:59392
  ds_read_b64_tr_b16 v[238:239], v243 offset:59904
  s_waitcnt lgkmcnt(8)
  v_mfma_f32_32x32x16_bf16 v[0:15], v[112:115], v[208:211], v[0:15]
  v_mfma_f32_32x32x16_bf16 v[16:31], v[112:115], v[212:215], v[16:31]
  v_mfma_f32_32x32x16_bf16 v[32:47], v[112:115], v[216:219], v[32:47]
  v_mfma_f32_32x32x16_bf16 v[48:63], v[112:115], v[220:223], v[48:63]
  ds_read_b64_tr_b16 v[208:209], v242 offset:53248
  ds_read_b64_tr_b16 v[210:211], v242 offset:53760
  ds_read_b64_tr_b16 v[212:213], v243 offset:53248
  ds_read_b64_tr_b16 v[214:215], v243 offset:53760
  ds_read_b64_tr_b16 v[216:217], v242 offset:61440
  ds_read_b64_tr_b16 v[218:219], v242 offset:61952
  ds_read_b64_tr_b16 v[220:221], v243 offset:61440
  ds_read_b64_tr_b16 v[222:223], v243 offset:61952
  s_waitcnt lgkmcnt(8)
  v_mfma_f32_32x32x16_bf16 v[0:15], v[116:119], v[224:227], v[0:15]
  v_mfma_f32_32x32x16_bf16 v[16:31], v[116:119], v[228:231], v[16:31]
  v_mfma_f32_32x32x16_bf16 v[32:47], v[116:119], v[232:235], v[32:47]
  v_mfma_f32_32x32x16_bf16 v[48:63], v[116:119], v[236:239], v[48:63]
  s_cmp_lg_u32 s30, 0
  s_cbranch_scc1 G1_QS14
  s_waitcnt vmcnt(6)
  s_barrier
  s_add_u32 m0, s55, 98304
  s_nop 0
  buffer_load_dwordx4 v240, s[44:47], s53 offen lds
  s_add_u32 m0, s55, 106496
  s_nop 0
  buffer_load_dwordx4 v240, s[48:51], s53 offen lds
  s_add_u32 s53, s53, s17
  s_mov_b32 s59, 24576
  buffer_load_dwordx4 v[160:163], v244, s[40:43], s59 offen
  s_mov_b32 s59, 25600
  buffer_load_dwordx4 v[164:167], v244, s[40:43], s59 offen
  s_mov_b32 s59, 26624
  buffer_load_dwordx4 v[168:171], v244, s[40:43], s59 offen
  s_mov_b32 s59, 27648
  buffer_load_dwordx4 v[172:175], v244, s[40:43], s59 offen
  s_branch G1_QR14
G1_QS14:
  s_waitcnt vmcnt(8)
  s_barrier
G1_QR14:
  ds_read_b64_tr_b16 v[224:225], v242 offset:55296
  ds_read_b64_tr_b16 v[226:227], v242 offset:55808
  ds_read_b64_tr_b16 v[228:229], v243 offset:55296
  ds_read_b64_tr_b16 v[230:231], v243 offset:55808
  ds_read_b64_tr_b16 v[232:233], v242 offset:63488
  ds_read_b64_tr_b16 v[234:235], v242 offset:64000
  ds_read_b64_tr_b16 v[236:237], v243 offset:63488
  ds_read_b64_tr_b16 v[238:239], v243 offset:64000
  s_waitcnt lgkmcnt(8)
  v_mfma_f32_32x32x16_bf16 v[0:15], v[120:123], v[208:211], v[0:15]
  v_mfma_f32_32x32x16_bf16 v[16:31], v[120:123], v[212:215], v[16:31]
  v_mfma_f32_32x32x16_bf16 v[32:47], v[120:123], v[216:219], v[32:47]
  v_mfma_f32_32x32x16_bf16 v[48:63], v[120:123], v[220:223], v[48:63]
  ds_read_b64_tr_b16 v[208:209], v252 offset:0
  ds_read_b64_tr_b16 v[210:211], v252 offset:512
  ds_read_b64_tr_b16 v[212:213], v253 offset:0
  ds_read_b64_tr_b16 v[214:215], v253 offset:512
  ds_read_b64_tr_b16 v[216:217], v252 offset:8192
  ds_read_b64_tr_b16 v[218:219], v252 offset:8704
  ds_read_b64_tr_b16 v[220:221], v253 offset:8192
  ds_read_b64_tr_b16 v[222:223], v253 offset:8704
  s_waitcnt lgkmcnt(8)
  v_mfma_f32_32x32x16_bf16 v[0:15], v[124:127], v[224:227], v[0:15]
  v_mfma_f32_32x32x16_bf16 v[16:31], v[124:127], v[228:231], v[16:31]
  v_mfma_f32_32x32x16_bf16 v[32:47], v[124:127], v[232:235], v[32:47]
  v_mfma_f32_32x32x16_bf16 v[48:63], v[124:127], v[236:239], v[48:63]
  ds_read_b64_tr_b16 v[224:225], v252 offset:2048
  ds_read_b64_tr_b16 v[226:227], v252 offset:2560
  ds_read_b64_tr_b16 v[228:229], v253 offset:2048
  ds_read_b64_tr_b16 v[230:231], v253 offset:2560
  ds_read_b64_tr_b16 v[232:233], v252 offset:10240
  ds_read_b64_tr_b16 v[234:235], v252 offset:10752
  ds_read_b64_tr_b16 v[236:237], v253 offset:10240
  ds_read_b64_tr_b16 v[238:239], v253 offset:10752
  s_waitcnt lgkmcnt(8)
  v_mfma_f32_32x32x16_bf16 v[0:15], v[128:131], v[208:211], v[0:15]
  v_mfma_f32_32x32x16_bf16 v[16:31], v[128:131], v[212:215], v[16:31]
  v_mfma_f32_32x32x16_bf16 v[32:47], v[128:131], v[216:219], v[32:47]
  v_mfma_f32_32x32x16_bf16 v[48:63], v[128:131], v[220:223], v[48:63]
  ds_read_b64_tr_b16 v[208:209], v252 offset:4096
  ds_read_b64_tr_b16 v[210:211], v252 offset:4608
  ds_read_b64_tr_b16 v[212:213], v253 offset:4096
  ds_read_b64_tr_b16 v[214:215], v253 offset:4608
  ds_read_b64_tr_b16 v[216:217], v252 offset:12288
  ds_read_b64_tr_b16 v[218:219], v252 offset:12800
  ds_read_b64_tr_b16 v[220:221], v253 offset:12288
  ds_read_b64_tr_b16 v[222:223], v253 offset:12800
  s_waitcnt lgkmcnt(8)
  v_mfma_f32_32x32x16_bf16 v[0:15], v[132:135], v[224:227], v[0:15]
  v_mfma_f32_32x32x16_bf16 v[16:31], v[132:135], v[228:231], v[16:31]
  v_mfma_f32_32x32x16_bf16 v[32:47], v[132:135], v[232:235], v[32:47]
  v_mfma_f32_32x32x16_bf16 v[48:63], v[132:135], v[236:239], v[48:63]
  s_cmp_lg_u32 s30, 0
  s_cbranch_scc1 G1_QS15
  s_waitcnt vmcnt(6)
  s_barrier
  s_add_u32 m0, s55, 114688
  s_nop 0
  buffer_load_dwordx4 v240, s[44:47], s53 offen lds
  s_add_u32 m0, s55, 122880
  s_nop 0
  buffer_load_dwordx4 v240, s[48:51], s53 offen lds
  s_add_u32 s53, s53, s17
  s_mov_b32 s59, 28672
  buffer_load_dwordx4 v[176:179], v244, s[40:43], s59 offen
  s_mov_b32 s59, 29696
  buffer_load_dwordx4 v[180:183], v244, s[40:43], s59 offen
  s_mov_b32 s59, 30720
  buffer_load_dwordx4 v[184:187], v244, s[40:43], s59 offen
  s_mov_b32 s59, 31744
  buffer_load_dwordx4 v[188:191], v244, s[40:43], s59 offen
  s_branch G1_QR15
G1_QS15:
  s_waitcnt vmcnt(6)
  s_barrier
G1_QR15:
  ds_read_b64_tr_b16 v[224:225], v252 offset:6144
  ds_read_b64_tr_b16 v[226:227], v252 offset:6656
  ds_read_b64_tr_b16 v[228:229], v253 offset:6144
  ds_read_b64_tr_b16 v[230:231], v253 offset:6656
  ds_read_b64_tr_b16 v[232:233], v252 offset:14336
  ds_read_b64_tr_b16 v[234:235], v252 offset:14848
  ds_read_b64_tr_b16 v[236:237], v253 offset:14336
  ds_read_b64_tr_b16 v[238:239], v253 offset:14848
  s_waitcnt lgkmcnt(8)
  v_mfma_f32_32x32x16_bf16 v[0:15], v[136:139], v[208:211], v[0:15]
  v_mfma_f32_32x32x16_bf16 v[16:31], v[136:139], v[212:215], v[16:31]
  v_mfma_f32_32x32x16_bf16 v[32:47], v[136:139], v[216:219], v[32:47]
  v_mfma_f32_32x32x16_bf16 v[48:63], v[136:139], v[220:223], v[48:63]
  ds_read_b64_tr_b16 v[208:209], v252 offset:16384
  ds_read_b64_tr_b16 v[210:211], v252 offset:16896
  ds_read_b64_tr_b16 v[212:213], v253 offset:16384
  ds_read_b64_tr_b16 v[214:215], v253 offset:16896
  ds_read_b64_tr_b16 v[216:217], v252 offset:24576
  ds_read_b64_tr_b16 v[218:219], v252 offset:25088
  ds_read_b64_tr_b16 v[220:221], v253 offset:24576
  ds_read_b64_tr_b16 v[222:223], v253 offset:25088
  s_waitcnt lgkmcnt(8)
  v_mfma_f32_32x32x16_bf16 v[0:15], v[140:143], v[224:227], v[0:15]
  v_mfma_f32_32x32x16_bf16 v[16:31], v[140:143], v[228:231], v[16:31]
  v_mfma_f32_32x32x16_bf16 v[32:47], v[140:143], v[232:235], v[32:47]
  v_mfma_f32_32x32x16_bf16 v[48:63], v[140:143], v[236:239], v[48:63]
  ds_read_b64_tr_b16 v[224:225], v252 offset:18432
  ds_read_b64_tr_b16 v[226:227], v252 offset:18944
  ds_read_b64_tr_b16 v[228:229], v253 offset:18432
  ds_read_b64_tr_b16 v[230:231], v253 offset:18944
  ds_read_b64_tr_b16 v[232:233], v252 offset:26624
  ds_read_b64_tr_b16 v[234:235], v252 offset:27136
  ds_read_b64_tr_b16 v[236:237], v253 offset:26624
  ds_read_b64_tr_b16 v[238:239], v253 offset:27136
  s_waitcnt lgkmcnt(8)
  v_mfma_f32_32x32x16_bf16 v[0:15], v[144:147], v[208:211], v[0:15]
  v_mfma_f32_32x32x16_bf16 v[16:31], v[144:147], v[212:215], v[16:31]
  v_mfma_f32_32x32x16_bf16 v[32:47], v[144:147], v[216:219], v[32:47]
  v_mfma_f32_32x32x16_bf16 v[48:63], v[144:147], v[220:223], v[48:63]
  ds_read_b64_tr_b16 v[208:209], v252 offset:20480
  ds_read_b64_tr_b16 v[210:211], v252 offset:20992
  ds_read_b64_tr_b16 v[212:213], v253 offset:20480
  ds_read_b64_tr_b16 v[214:215], v253 offset:20992
  ds_read_b64_tr_b16 v[216:217], v252 offset:28672
  ds_read_b64_tr_b16 v[218:219], v252 offset:29184
  ds_read_b64_tr_b16 v[220:221], v253 offset:28672
  ds_read_b64_tr_b16 v[222:223], v253 offset:29184
  s_waitcnt lgkmcnt(8)
  v_mfma_f32_32x32x16_bf16 v[0:15], v[148:151], v[224:227], v[0:15]
  v_mfma_f32_32x32x16_bf16 v[16:31], v[148:151], v[228:231], v[16:31]
  v_mfma_f32_32x32x16_bf16 v[32:47], v[148:151], v[232:235], v[32:47]
  v_mfma_f32_32x32x16_bf16 v[48:63], v[148:151], v[236:239], v[48:63]
  s_cmp_lg_u32 s30, 0
  s_cbranch_scc1 G1_QS16
  s_waitcnt vmcnt(6)
  s_barrier
  s_add_u32 m0, s55, 131072
  s_nop 0
  buffer_load_dwordx4 v240, s[44:47], s53 offen lds
  s_add_u32 m0, s55, 139264
  s_nop 0
  buffer_load_dwordx4 v240, s[48:51], s53 offen lds
  s_add_u32 s53, s53, s17
  s_mov_b32 s59, 32768
  buffer_load_dwordx4 v[192:195], v244, s[40:43], s59 offen
  s_mov_b32 s59, 33792
  buffer_load_dwordx4 v[196:199], v244, s[40:43], s59 offen
  s_mov_b32 s59, 34816
  buffer_load_dwordx4 v[200:203], v244, s[40:43], s59 offen
  s_mov_b32 s59, 35840
  buffer_load_dwordx4 v[204:207], v244, s[40:43], s59 offen
  s_branch G1_QR16
G1_QS16:
  s_waitcnt vmcnt(4)
  s_barrier
G1_QR16:
  ds_read_b64_tr_b16 v[224:225], v252 offset:22528
  ds_read_b64_tr_b16 v[226:227], v252 offset:23040
  ds_read_b64_tr_b16 v[228:229], v253 offset:22528
  ds_read_b64_tr_b16 v[230:231], v253 offset:23040
  ds_read_b64_tr_b16 v[232:233], v252 offset:30720
  ds_read_b64_tr_b16 v[234:235], v252 offset:31232
  ds_read_b64_tr_b16 v[236:237], v253 offset:30720
  ds_read_b64_tr_b16 v[238:239], v253 offset:31232
  s_waitcnt lgkmcnt(8)
  v_mfma_f32_32x32x16_bf16 v[0:15], v[152:155], v[208:211], v[0:15]
  v_mfma_f32_32x32x16_bf16 v[16:31], v[152:155], v[212:215], v[16:31]
  v_mfma_f32_32x32x16_bf16 v[32:47], v[152:155], v[216:219], v[32:47]
  v_mfma_f32_32x32x16_bf16 v[48:63], v[152:155], v[220:223], v[48:63]
  ds_read_b64_tr_b16 v[208:209], v252 offset:32768
  ds_read_b64_tr_b16 v[210:211], v252 offset:33280
  ds_read_b64_tr_b16 v[212:213], v253 offset:32768
  ds_read_b64_tr_b16 v[214:215], v253 offset:33280
  ds_read_b64_tr_b16 v[216:217], v252 offset:40960
  ds_read_b64_tr_b16 v[218:219], v252 offset:41472
  ds_read_b64_tr_b16 v[220:221], v253 offset:40960
  ds_read_b64_tr_b16 v[222:223], v253 offset:41472
  s_waitcnt lgkmcnt(8)
  v_mfma_f32_32x32x16_bf16 v[0:15], v[156:159], v[224:227], v[0:15]
  v_mfma_f32_32x32x16_bf16 v[16:31], v[156:159], v[228:231], v[16:31]
  v_mfma_f32_32x32x16_bf16 v[32:47], v[156:159], v[232:235], v[32:47]
  v_mfma_f32_32x32x16_bf16 v[48:63], v[156:159], v[236:239], v[48:63]
  ds_read_b64_tr_b16 v[224:225], v252 offset:34816
  ds_read_b64_tr_b16 v[226:227], v252 offset:35328
  ds_read_b64_tr_b16 v[228:229], v253 offset:34816
  ds_read_b64_tr_b16 v[230:231], v253 offset:35328
  ds_read_b64_tr_b16 v[232:233], v252 offset:43008
  ds_read_b64_tr_b16 v[234:235], v252 offset:43520
  ds_read_b64_tr_b16 v[236:237], v253 offset:43008
  ds_read_b64_tr_b16 v[238:239], v253 offset:43520
  s_waitcnt lgkmcnt(8)
  v_mfma_f32_32x32x16_bf16 v[0:15], v[160:163], v[208:211], v[0:15]
  v_mfma_f32_32x32x16_bf16 v[16:31], v[160:163], v[212:215], v[16:31]
  v_mfma_f32_32x32x16_bf16 v[32:47], v[160:163], v[216:219], v[32:47]
  v_mfma_f32_32x32x16_bf16 v[48:63], v[160:163], v[220:223], v[48:63]
  ds_read_b64_tr_b16 v[208:209], v252 offset:36864
  ds_read_b64_tr_b16 v[210:211], v252 offset:37376
  ds_read_b64_tr_b16 v[212:213], v253 offset:36864
  ds_read_b64_tr_b16 v[214:215], v253 offset:37376
  ds_read_b64_tr_b16 v[216:217], v252 offset:45056
  ds_read_b64_tr_b16 v[218:219], v252 offset:45568
  ds_read_b64_tr_b16 v[220:221], v253 offset:45056
  ds_read_b64_tr_b16 v[222:223], v253 offset:45568
  s_waitcnt lgkmcnt(8)
  v_mfma_f32_32x32x16_bf16 v[0:15], v[164:167], v[224:227], v[0:15]
  v_mfma_f32_32x32x16_bf16 v[16:31], v[164:167], v[228:231], v[16:31]
  v_mfma_f32_32x32x16_bf16 v[32:47], v[164:167], v[232:235], v[32:47]
  v_mfma_f32_32x32x16_bf16 v[48:63], v[164:167], v[236:239], v[48:63]
  s_cmp_lg_u32 s30, 0
  s_cbranch_scc1 G1_QS17
  s_waitcnt vmcnt(6)
  s_barrier
  s_branch G1_QR17
G1_QS17:
  s_waitcnt vmcnt(2)
  s_barrier
G1_QR17:
  ds_read_b64_tr_b16 v[224:225], v252 offset:38912
  ds_read_b64_tr_b16 v[226:227], v252 offset:39424
  ds_read_b64_tr_b16 v[228:229], v253 offset:38912
  ds_read_b64_tr_b16 v[230:231], v253 offset:39424
  ds_read_b64_tr_b16 v[232:233], v252 offset:47104
  ds_read_b64_tr_b16 v[234:235], v252 offset:47616
  ds_read_b64_tr_b16 v[236:237], v253 offset:47104
  ds_read_b64_tr_b16 v[238:239], v253 offset:47616
  s_waitcnt lgkmcnt(8)
  v_mfma_f32_32x32x16_bf16 v[0:15], v[168:171], v[208:211], v[0:15]
  v_mfma_f32_32x32x16_bf16 v[16:31], v[168:171], v[212:215], v[16:31]
  v_mfma_f32_32x32x16_bf16 v[32:47], v[168:171], v[216:219], v[32:47]
  v_mfma_f32_32x32x16_bf16 v[48:63], v[168:171], v[220:223], v[48:63]
  ds_read_b64_tr_b16 v[208:209], v252 offset:49152
  ds_read_b64_tr_b16 v[210:211], v252 offset:49664
  ds_read_b64_tr_b16 v[212:213], v253 offset:49152
  ds_read_b64_tr_b16 v[214:215], v253 offset:49664
  ds_read_b64_tr_b16 v[216:217], v252 offset:57344
  ds_read_b64_tr_b16 v[218:219], v252 offset:57856
  ds_read_b64_tr_b16 v[220:221], v253 offset:57344
  ds_read_b64_tr_b16 v[222:223], v253 offset:57856
  s_waitcnt lgkmcnt(8)
  v_mfma_f32_32x32x16_bf16 v[0:15], v[172:175], v[224:227], v[0:15]
  v_mfma_f32_32x32x16_bf16 v[16:31], v[172:175], v[228:231], v[16:31]
  v_mfma_f32_32x32x16_bf16 v[32:47], v[172:175], v[232:235], v[32:47]
  v_mfma_f32_32x32x16_bf16 v[48:63], v[172:175], v[236:239], v[48:63]
  ds_read_b64_tr_b16 v[224:225], v252 offset:51200
  ds_read_b64_tr_b16 v[226:227], v252 offset:51712
  ds_read_b64_tr_b16 v[228:229], v253 offset:51200
  ds_read_b64_tr_b16 v[230:231], v253 offset:51712
  ds_read_b64_tr_b16 v[232:233], v252 offset:59392
  ds_read_b64_tr_b16 v[234:235], v252 offset:59904
  ds_read_b64_tr_b16 v[236:237], v253 offset:59392
  ds_read_b64_tr_b16 v[238:239], v253 offset:59904
  s_waitcnt lgkmcnt(8)
  v_mfma_f32_32x32x16_bf16 v[0:15], v[176:179], v[208:211], v[0:15]
  v_mfma_f32_32x32x16_bf16 v[16:31], v[176:179], v[212:215], v[16:31]
  v_mfma_f32_32x32x16_bf16 v[32:47], v[176:179], v[216:219], v[32:47]
  v_mfma_f32_32x32x16_bf16 v[48:63], v[176:179], v[220:223], v[48:63]
  ds_read_b64_tr_b16 v[208:209], v252 offset:53248
  ds_read_b64_tr_b16 v[210:211], v252 offset:53760
  ds_read_b64_tr_b16 v[212:213], v253 offset:53248
  ds_read_b64_tr_b16 v[214:215], v253 offset:53760
  ds_read_b64_tr_b16 v[216:217], v252 offset:61440
  ds_read_b64_tr_b16 v[218:219], v252 offset:61952
  ds_read_b64_tr_b16 v[220:221], v253 offset:61440
  ds_read_b64_tr_b16 v[222:223], v253 offset:61952
  s_waitcnt lgkmcnt(8)
  v_mfma_f32_32x32x16_bf16 v[0:15], v[180:183], v[224:227], v[0:15]
  v_mfma_f32_32x32x16_bf16 v[16:31], v[180:183], v[228:231], v[16:31]
  v_mfma_f32_32x32x16_bf16 v[32:47], v[180:183], v[232:235], v[32:47]
  v_mfma_f32_32x32x16_bf16 v[48:63], v[180:183], v[236:239], v[48:63]
  s_cmp_lg_u32 s30, 0
  s_cbranch_scc1 G1_QS18
  s_waitcnt vmcnt(0)
  s_barrier
  s_branch G1_QR18
G1_QS18:
  s_waitcnt vmcnt(0)
  s_barrier
G1_QR18:
  ds_read_b64_tr_b16 v[224:225], v252 offset:55296
  ds_read_b64_tr_b16 v[226:227], v252 offset:55808
  ds_read_b64_tr_b16 v[228:229], v253 offset:55296
  ds_read_b64_tr_b16 v[230:231], v253 offset:55808
  ds_read_b64_tr_b16 v[232:233], v252 offset:63488
  ds_read_b64_tr_b16 v[234:235], v252 offset:64000
  ds_read_b64_tr_b16 v[236:237], v253 offset:63488
  ds_read_b64_tr_b16 v[238:239], v253 offset:64000
  s_waitcnt lgkmcnt(8)
  v_mfma_f32_32x32x16_bf16 v[0:15], v[184:187], v[208:211], v[0:15]
  v_mfma_f32_32x32x16_bf16 v[16:31], v[184:187], v[212:215], v[16:31]
  v_mfma_f32_32x32x16_bf16 v[32:47], v[184:187], v[216:219], v[32:47]
  v_mfma_f32_32x32x16_bf16 v[48:63], v[184:187], v[220:223], v[48:63]
  ds_read_b64_tr_b16 v[208:209], v254 offset:0
  ds_read_b64_tr_b16 v[210:211], v254 offset:512
  ds_read_b64_tr_b16 v[212:213], v255 offset:0
  ds_read_b64_tr_b16 v[214:215], v255 offset:512
  ds_read_b64_tr_b16 v[216:217], v254 offset:8192
  ds_read_b64_tr_b16 v[218:219], v254 offset:8704
  ds_read_b64_tr_b16 v[220:221], v255 offset:8192
  ds_read_b64_tr_b16 v[222:223], v255 offset:8704
  s_waitcnt lgkmcnt(8)
  v_mfma_f32_32x32x16_bf16 v[0:15], v[188:191], v[224:227], v[0:15]
  v_mfma_f32_32x32x16_bf16 v[16:31], v[188:191], v[228:231], v[16:31]
  v_mfma_f32_32x32x16_bf16 v[32:47], v[188:191], v[232:235], v[32:47]
  v_mfma_f32_32x32x16_bf16 v[48:63], v[188:191], v[236:239], v[48:63]
  ds_read_b64_tr_b16 v[224:225], v254 offset:2048
  ds_read_b64_tr_b16 v[226:227], v254 offset:2560
  ds_read_b64_tr_b16 v[228:229], v255 offset:2048
  ds_read_b64_tr_b16 v[230:231], v255 offset:2560
  ds_read_b64_tr_b16 v[232:233], v254 offset:10240
  ds_read_b64_tr_b16 v[234:235], v254 offset:10752
  ds_read_b64_tr_b16 v[236:237], v255 offset:10240
  ds_read_b64_tr_b16 v[238:239], v255 offset:10752
  s_waitcnt lgkmcnt(8)
  v_mfma_f32_32x32x16_bf16 v[0:15], v[192:195], v[208:211], v[0:15]
  v_mfma_f32_32x32x16_bf16 v[16:31], v[192:195], v[212:215], v[16:31]
  v_mfma_f32_32x32x16_bf16 v[32:47], v[192:195], v[216:219], v[32:47]
  v_mfma_f32_32x32x16_bf16 v[48:63], v[192:195], v[220:223], v[48:63]
  ds_read_b64_tr_b16 v[208:209], v254 offset:4096
  ds_read_b64_tr_b16 v[210:211], v254 offset:4608
  ds_read_b64_tr_b16 v[212:213], v255 offset:4096
  ds_read_b64_tr_b16 v[214:215], v255 offset:4608
  ds_read_b64_tr_b16 v[216:217], v254 offset:12288
  ds_read_b64_tr_b16 v[218:219], v254 offset:12800
  ds_read_b64_tr_b16 v[220:221], v255 offset:12288
  ds_read_b64_tr_b16 v[222:223], v255 offset:12800
  s_waitcnt lgkmcnt(8)
  v_mfma_f32_32x32x16_bf16 v[0:15], v[196:199], v[224:227], v[0:15]
  v_mfma_f32_32x32x16_bf16 v[16:31], v[196:199], v[228:231], v[16:31]
  v_mfma_f32_32x32x16_bf16 v[32:47], v[196:199], v[232:235], v[32:47]
  v_mfma_f32_32x32x16_bf16 v[48:63], v[196:199], v[236:239], v[48:63]
  ds_read_b64_tr_b16 v[224:225], v254 offset:6144
  ds_read_b64_tr_b16 v[226:227], v254 offset:6656
  ds_read_b64_tr_b16 v[228:229], v255 offset:6144
  ds_read_b64_tr_b16 v[230:231], v255 offset:6656
  ds_read_b64_tr_b16 v[232:233], v254 offset:14336
  ds_read_b64_tr_b16 v[234:235], v254 offset:14848
  ds_read_b64_tr_b16 v[236:237], v255 offset:14336
  ds_read_b64_tr_b16 v[238:239], v255 offset:14848
  s_waitcnt lgkmcnt(8)
  v_mfma_f32_32x32x16_bf16 v[0:15], v[200:203], v[208:211], v[0:15]
  v_mfma_f32_32x32x16_bf16 v[16:31], v[200:203], v[212:215], v[16:31]
  v_mfma_f32_32x32x16_bf16 v[32:47], v[200:203], v[216:219], v[32:47]
  v_mfma_f32_32x32x16_bf16 v[48:63], v[200:203], v[220:223], v[48:63]
  s_waitcnt lgkmcnt(0)
  v_mfma_f32_32x32x16_bf16 v[0:15], v[204:207], v[224:227], v[0:15]
  v_mfma_f32_32x32x16_bf16 v[16:31], v[204:207], v[228:231], v[16:31]
  v_mfma_f32_32x32x16_bf16 v[32:47], v[204:207], v[232:235], v[32:47]
  v_mfma_f32_32x32x16_bf16 v[48:63], v[204:207], v[236:239], v[48:63]
  s_barrier
  s_nop 15
  s_mov_b32 s30, 1
  v_bfe_u32 v249, v246, 1, 2
  v_xor_b32 v250, v249, v247
  v_lshlrev_b32 v250, 4, v250
  v_lshl_add_u32 v250, v246, 6, v250
  v_add_u32 v250, s57, v250
  v_or_b32 v251, 2, v247
  v_xor_b32 v251, v249, v251
  v_lshlrev_b32 v251, 4, v251
  v_lshl_add_u32 v251, v246, 6, v251
  v_add_u32 v251, s57, v251

  v_cvt_pk_bf16_f32 v208, v0, v1
  v_cvt_pk_bf16_f32 v209, v2, v3
  ds_write_b64 v250, v[208:209] offset:0
  v_cvt_pk_bf16_f32 v210, v4, v5
  v_cvt_pk_bf16_f32 v211, v6, v7
  ds_write_b64 v250, v[210:211] offset:8
  v_cvt_pk_bf16_f32 v212, v8, v9
  v_cvt_pk_bf16_f32 v213, v10, v11
  ds_write_b64 v251, v[212:213] offset:0
  v_cvt_pk_bf16_f32 v214, v12, v13
  v_cvt_pk_bf16_f32 v215, v14, v15
  ds_write_b64 v251, v[214:215] offset:8
  v_cvt_pk_bf16_f32 v216, v16, v17
  v_cvt_pk_bf16_f32 v217, v18, v19
  ds_write_b64 v250, v[216:217] offset:2048
  v_cvt_pk_bf16_f32 v218, v20, v21
  v_cvt_pk_bf16_f32 v219, v22, v23
  ds_write_b64 v250, v[218:219] offset:2056
  v_cvt_pk_bf16_f32 v220, v24, v25
  v_cvt_pk_bf16_f32 v221, v26, v27
  ds_write_b64 v251, v[220:221] offset:2048
  v_cvt_pk_bf16_f32 v222, v28, v29
  v_cvt_pk_bf16_f32 v223, v30, v31
  ds_write_b64 v251, v[222:223] offset:2056
  v_cvt_pk_bf16_f32 v208, v32, v33
  v_cvt_pk_bf16_f32 v209, v34, v35
  ds_write_b64 v250, v[208:209] offset:4096
  v_cvt_pk_bf16_f32 v210, v36, v37
  v_cvt_pk_bf16_f32 v211, v38, v39
  ds_write_b64 v250, v[210:211] offset:4104
  v_cvt_pk_bf16_f32 v212, v40, v41
  v_cvt_pk_bf16_f32 v213, v42, v43
  ds_write_b64 v251, v[212:213] offset:4096
  v_cvt_pk_bf16_f32 v214, v44, v45
  v_cvt_pk_bf16_f32 v215, v46, v47
  ds_write_b64 v251, v[214:215] offset:4104
  v_cvt_pk_bf16_f32 v216, v48, v49
  v_cvt_pk_bf16_f32 v217, v50, v51
  ds_write_b64 v250, v[216:217] offset:6144
  v_cvt_pk_bf16_f32 v218, v52, v53
  v_cvt_pk_bf16_f32 v219, v54, v55
  ds_write_b64 v250, v[218:219] offset:6152
  v_cvt_pk_bf16_f32 v220, v56, v57
  v_cvt_pk_bf16_f32 v221, v58, v59
  ds_write_b64 v251, v[220:221] offset:6144
  v_cvt_pk_bf16_f32 v222, v60, v61
  v_cvt_pk_bf16_f32 v223, v62, v63
  ds_write_b64 v251, v[222:223] offset:6152
  v_lshrrev_b32 v248, 2, v245
  v_and_b32 v249, 3, v245
  v_bfe_u32 v250, v245, 3, 2
  v_xor_b32 v250, v250, v249
  v_lshlrev_b32 v250, 4, v250
  v_lshl_add_u32 v250, v248, 6, v250
  v_add_u32 v250, s57, v250
  s_lshl_b32 s59, s56, 5
  s_add_u32 s59, s59, s12
  s_lshl_b32 s59, s59, 1
  s_add_u32 s59, s59, 12582912
  s_lshl_b32 s25, s24, 17
  s_add_u32 s59, s59, s25
  v_lshl_add_u32 v249, v249, 4, s59
  s_movk_i32 s21, 3641
  s_movk_i32 s25, 126
  s_cmp_eq_u32 s23, 4
  s_cselect_b32 s25, 72, s25
  s_waitcnt lgkmcnt(0)

  ds_read_b128 v[208:211], v250 offset:0
  ds_read_b128 v[212:215], v250 offset:1024
  ds_read_b128 v[216:219], v250 offset:2048
  ds_read_b128 v[220:223], v250 offset:3072
  v_add_u32 v224, 0, v248
  v_mul_u32_u24 v225, s21, v224
  v_lshrrev_b32 v225, 16, v225
  v_mul_u32_u24 v226, 14, v225
  v_add_u32 v226, v226, v224
  v_lshl_add_u32 v226, v226, 12, v249
  v_cmp_gt_u32 vcc, s25, v224
  s_waitcnt lgkmcnt(3)
  s_mov_b64 exec, vcc
  buffer_store_dwordx4 v[208:211], v226, s[60:63], 0 offen
  s_mov_b64 exec, -1

  v_add_u32 v228, 16, v248
  v_mul_u32_u24 v229, s21, v228
  v_lshrrev_b32 v229, 16, v229
  v_mul_u32_u24 v230, 14, v229
  v_add_u32 v230, v230, v228
  v_lshl_add_u32 v230, v230, 12, v249
  v_cmp_gt_u32 vcc, s25, v228
  s_waitcnt lgkmcnt(2)
  s_mov_b64 exec, vcc
  buffer_store_dwordx4 v[212:215], v230, s[60:63], 0 offen
  s_mov_b64 exec, -1

  v_add_u32 v232, 32, v248
  v_mul_u32_u24 v233, s21, v232
  v_lshrrev_b32 v233, 16, v233
  v_mul_u32_u24 v234, 14, v233
  v_add_u32 v234, v234, v232
  v_lshl_add_u32 v234, v234, 12, v249
  v_cmp_gt_u32 vcc, s25, v232
  s_waitcnt lgkmcnt(1)
  s_mov_b64 exec, vcc
  buffer_store_dwordx4 v[216:219], v234, s[60:63], 0 offen
  s_mov_b64 exec, -1

  v_add_u32 v236, 48, v248
  v_mul_u32_u24 v237, s21, v236
  v_lshrrev_b32 v237, 16, v237
  v_mul_u32_u24 v238, 14, v237
  v_add_u32 v238, v238, v236
  v_lshl_add_u32 v238, v238, 12, v249
  v_cmp_gt_u32 vcc, s25, v236
  s_waitcnt lgkmcnt(0)
  s_mov_b64 exec, vcc
  buffer_store_dwordx4 v[220:223], v238, s[60:63], 0 offen
  s_mov_b64 exec, -1

  ds_read_b128 v[208:211], v250 offset:4096
  ds_read_b128 v[212:215], v250 offset:5120
  ds_read_b128 v[216:219], v250 offset:6144
  ds_read_b128 v[220:223], v250 offset:7168
  v_add_u32 v224, 64, v248
  v_mul_u32_u24 v225, s21, v224
  v_lshrrev_b32 v225, 16, v225
  v_mul_u32_u24 v226, 14, v225
  v_add_u32 v226, v226, v224
  v_lshl_add_u32 v226, v226, 12, v249
  v_cmp_gt_u32 vcc, s25, v224
  s_waitcnt lgkmcnt(3)
  s_mov_b64 exec, vcc
  buffer_store_dwordx4 v[208:211], v226, s[60:63], 0 offen
  s_mov_b64 exec, -1

  v_add_u32 v228, 80, v248
  v_mul_u32_u24 v229, s21, v228
  v_lshrrev_b32 v229, 16, v229
  v_mul_u32_u24 v230, 14, v229
  v_add_u32 v230, v230, v228
  v_lshl_add_u32 v230, v230, 12, v249
  v_cmp_gt_u32 vcc, s25, v228
  s_waitcnt lgkmcnt(2)
  s_mov_b64 exec, vcc
  buffer_store_dwordx4 v[212:215], v230, s[60:63], 0 offen
  s_mov_b64 exec, -1

  v_add_u32 v232, 96, v248
  v_mul_u32_u24 v233, s21, v232
  v_lshrrev_b32 v233, 16, v233
  v_mul_u32_u24 v234, 14, v233
  v_add_u32 v234, v234, v232
  v_lshl_add_u32 v234, v234, 12, v249
  v_cmp_gt_u32 vcc, s25, v232
  s_waitcnt lgkmcnt(1)
  s_mov_b64 exec, vcc
  buffer_store_dwordx4 v[216:219], v234, s[60:63], 0 offen
  s_mov_b64 exec, -1

  v_add_u32 v236, 112, v248
  v_mul_u32_u24 v237, s21, v236
  v_lshrrev_b32 v237, 16, v237
  v_mul_u32_u24 v238, 14, v237
  v_add_u32 v238, v238, v236
  v_lshl_add_u32 v238, v238, 12, v249
  v_cmp_gt_u32 vcc, s25, v236
  s_waitcnt lgkmcnt(0)
  s_mov_b64 exec, vcc
  buffer_store_dwordx4 v[220:223], v238, s[60:63], 0 offen
  s_mov_b64 exec, -1

G1_QNEXT:
  s_add_u32 s13, s13, 1
  s_cmp_ge_u32 s13, s19
  s_cbranch_scc1 G1_QDONE
  s_barrier
  s_branch G1_QT
G1_QDONE:

  s_cmp_lg_u32 s14, 7
  s_cbranch_scc1 G1_END
  s_load_dwordx2 s[4:5], s[0:1], 48
  s_load_dwordx2 s[6:7], s[0:1], 16
  s_load_dwordx2 s[8:9], s[0:1], 0
  s_lshr_b32 s59, s12, 5
  s_add_u32 s59, s59, s56
  v_lshlrev_b32 v248, 7, v245
  s_waitcnt lgkmcnt(0)

  s_mov_b32 s44, s6
  s_and_b32 s45, s7, 0xffff
  s_mov_b32 s46, 663552
  s_mov_b32 s47, 0x00020000
  s_mul_i32 s58, s59, 16384
  buffer_load_dword v64, v248, s[44:47], s58 offen
  s_add_u32 s58, s58, 8192
  buffer_load_dword v65, v248, s[44:47], s58 offen
  s_add_u32 s58, s58, 8192
  s_waitcnt vmcnt(0)
  s_mov_b32 s44, s8
  s_and_b32 s45, s9, 0xffff
  s_mov_b32 s46, 2359296
  s_mov_b32 s47, 0x00020000
  s_mul_i32 s58, s59, 40960
  buffer_load_dword v64, v248, s[44:47], s58 offen
  s_add_u32 s58, s58, 8192
  buffer_load_dword v65, v248, s[44:47], s58 offen
  s_add_u32 s58, s58, 8192
  buffer_load_dword v66, v248, s[44:47], s58 offen
  s_add_u32 s58, s58, 8192
  buffer_load_dword v67, v248, s[44:47], s58 offen
  s_add_u32 s58, s58, 8192
  buffer_load_dword v68, v248, s[44:47], s58 offen
  s_add_u32 s58, s58, 8192
  s_waitcnt vmcnt(0)
  s_branch G1_END
G1_FFN:
  s_sub_u32 s13, s14, 8

  s_mul_i32 s24, s13, 3
  s_mov_b32 s13, s24
  s_add_u32 s19, s24, 3
  s_mov_b32 s31, s13
  s_movk_i32 s16, 9216

  s_mov_b32 s44, s6
  s_and_b32 s45, s7, 0xffff
  s_mov_b32 s46, 5308416
  s_mov_b32 s47, 0x00020000
  s_mov_b32 s48, s8
  s_and_b32 s49, s9, 0xffff
  s_mov_b32 s50, 5308416
  s_mov_b32 s51, 0x00020000
  s_lshl_b32 s15, s31, 6
  s_lshl_b32 s17, s16, 6
  s_lshl_b32 s59, s56, 3
  v_lshrrev_b32 v248, 3, v245
  v_add_u32 v248, s59, v248
  v_and_b32 v249, 7, v245
  v_bfe_u32 v250, v245, 4, 1
  v_lshlrev_b32 v250, 2, v250
  v_xor_b32 v249, v249, v250
  v_lshlrev_b32 v249, 4, v249
  s_lshl_b32 s59, s15, 1
  v_add_u32 v249, s59, v249
  v_mul_lo_u32 v250, v248, s16
  v_add_u32 v240, v250, v249
  s_mov_b32 s53, 0
  s_nop 4

  s_add_u32 m0, s55, 0
  s_nop 0
  buffer_load_dwordx4 v240, s[44:47], s53 offen lds
  s_add_u32 m0, s55, 8192
  s_nop 0
  buffer_load_dwordx4 v240, s[48:51], s53 offen lds
  s_add_u32 s53, s53, s17
  s_mov_b32 s59, 0
  buffer_load_dwordx4 v[64:67], v244, s[40:43], s59 offen
  s_mov_b32 s59, 1024
  buffer_load_dwordx4 v[68:71], v244, s[40:43], s59 offen
  s_mov_b32 s59, 2048
  buffer_load_dwordx4 v[72:75], v244, s[40:43], s59 offen
  s_mov_b32 s59, 3072
  buffer_load_dwordx4 v[76:79], v244, s[40:43], s59 offen
  s_add_u32 m0, s55, 16384
  s_nop 0
  buffer_load_dwordx4 v240, s[44:47], s53 offen lds
  s_add_u32 m0, s55, 24576
  s_nop 0
  buffer_load_dwordx4 v240, s[48:51], s53 offen lds
  s_add_u32 s53, s53, s17
  s_mov_b32 s59, 4096
  buffer_load_dwordx4 v[80:83], v244, s[40:43], s59 offen
  s_mov_b32 s59, 5120
  buffer_load_dwordx4 v[84:87], v244, s[40:43], s59 offen
  s_mov_b32 s59, 6144
  buffer_load_dwordx4 v[88:91], v244, s[40:43], s59 offen
  s_mov_b32 s59, 7168
  buffer_load_dwordx4 v[92:95], v244, s[40:43], s59 offen
  s_waitcnt vmcnt(6)
  s_barrier
  s_add_u32 m0, s55, 32768
  s_nop 0
  buffer_load_dwordx4 v240, s[44:47], s53 offen lds
  s_add_u32 m0, s55, 40960
  s_nop 0
  buffer_load_dwordx4 v240, s[48:51], s53 offen lds
  s_add_u32 s53, s53, s17
  s_mov_b32 s59, 8192
  buffer_load_dwordx4 v[96:99], v244, s[40:43], s59 offen
  s_mov_b32 s59, 9216
  buffer_load_dwordx4 v[100:103], v244, s[40:43], s59 offen
  s_mov_b32 s59, 10240
  buffer_load_dwordx4 v[104:107], v244, s[40:43], s59 offen
  s_mov_b32 s59, 11264
  buffer_load_dwordx4 v[108:111], v244, s[40:43], s59 offen
  ds_read_b64_tr_b16 v[208:209], v242 offset:0
  ds_read_b64_tr_b16 v[210:211], v242 offset:512
  ds_read_b64_tr_b16 v[212:213], v243 offset:0
  ds_read_b64_tr_b16 v[214:215], v243 offset:512
  ds_read_b64_tr_b16 v[216:217], v242 offset:8192
  ds_read_b64_tr_b16 v[218:219], v242 offset:8704
  ds_read_b64_tr_b16 v[220:221], v243 offset:8192
  ds_read_b64_tr_b16 v[222:223], v243 offset:8704
  ds_read_b64_tr_b16 v[224:225], v242 offset:2048
  ds_read_b64_tr_b16 v[226:227], v242 offset:2560
  ds_read_b64_tr_b16 v[228:229], v243 offset:2048
  ds_read_b64_tr_b16 v[230:231], v243 offset:2560
  ds_read_b64_tr_b16 v[232:233], v242 offset:10240
  ds_read_b64_tr_b16 v[234:235], v242 offset:10752
  ds_read_b64_tr_b16 v[236:237], v243 offset:10240
  ds_read_b64_tr_b16 v[238:239], v243 offset:10752
  s_waitcnt lgkmcnt(8)
  v_mfma_f32_32x32x16_bf16 v[0:15], v[208:211], v[64:67], 0
  v_mfma_f32_32x32x16_bf16 v[16:31], v[212:215], v[64:67], 0
  v_mfma_f32_32x32x16_bf16 v[32:47], v[216:219], v[64:67], 0
  v_mfma_f32_32x32x16_bf16 v[48:63], v[220:223], v[64:67], 0
  ds_read_b64_tr_b16 v[208:209], v242 offset:4096
  ds_read_b64_tr_b16 v[210:211], v242 offset:4608
  ds_read_b64_tr_b16 v[212:213], v243 offset:4096
  ds_read_b64_tr_b16 v[214:215], v243 offset:4608
  ds_read_b64_tr_b16 v[216:217], v242 offset:12288
  ds_read_b64_tr_b16 v[218:219], v242 offset:12800
  ds_read_b64_tr_b16 v[220:221], v243 offset:12288
  ds_read_b64_tr_b16 v[222:223], v243 offset:12800
  s_waitcnt lgkmcnt(8)
  v_mfma_f32_32x32x16_bf16 v[0:15], v[224:227], v[68:71], v[0:15]
  v_mfma_f32_32x32x16_bf16 v[16:31], v[228:231], v[68:71], v[16:31]
  v_mfma_f32_32x32x16_bf16 v[32:47], v[232:235], v[68:71], v[32:47]
  v_mfma_f32_32x32x16_bf16 v[48:63], v[236:239], v[68:71], v[48:63]
  s_waitcnt vmcnt(6)
  s_barrier
  s_add_u32 m0, s55, 49152
  s_nop 0
  buffer_load_dwordx4 v240, s[44:47], s53 offen lds
  s_add_u32 m0, s55, 57344
  s_nop 0
  buffer_load_dwordx4 v240, s[48:51], s53 offen lds
  s_add_u32 s53, s53, s17
  s_mov_b32 s59, 12288
  buffer_load_dwordx4 v[112:115], v244, s[40:43], s59 offen
  s_mov_b32 s59, 13312
  buffer_load_dwordx4 v[116:119], v244, s[40:43], s59 offen
  s_mov_b32 s59, 14336
  buffer_load_dwordx4 v[120:123], v244, s[40:43], s59 offen
  s_mov_b32 s59, 15360
  buffer_load_dwordx4 v[124:127], v244, s[40:43], s59 offen
  ds_read_b64_tr_b16 v[224:225], v242 offset:6144
  ds_read_b64_tr_b16 v[226:227], v242 offset:6656
  ds_read_b64_tr_b16 v[228:229], v243 offset:6144
  ds_read_b64_tr_b16 v[230:231], v243 offset:6656
  ds_read_b64_tr_b16 v[232:233], v242 offset:14336
  ds_read_b64_tr_b16 v[234:235], v242 offset:14848
  ds_read_b64_tr_b16 v[236:237], v243 offset:14336
  ds_read_b64_tr_b16 v[238:239], v243 offset:14848
  s_waitcnt lgkmcnt(8)
  v_mfma_f32_32x32x16_bf16 v[0:15], v[208:211], v[72:75], v[0:15]
  v_mfma_f32_32x32x16_bf16 v[16:31], v[212:215], v[72:75], v[16:31]
  v_mfma_f32_32x32x16_bf16 v[32:47], v[216:219], v[72:75], v[32:47]
  v_mfma_f32_32x32x16_bf16 v[48:63], v[220:223], v[72:75], v[48:63]
  ds_read_b64_tr_b16 v[208:209], v242 offset:16384
  ds_read_b64_tr_b16 v[210:211], v242 offset:16896
  ds_read_b64_tr_b16 v[212:213], v243 offset:16384
  ds_read_b64_tr_b16 v[214:215], v243 offset:16896
  ds_read_b64_tr_b16 v[216:217], v242 offset:24576
  ds_read_b64_tr_b16 v[218:219], v242 offset:25088
  ds_read_b64_tr_b16 v[220:221], v243 offset:24576
  ds_read_b64_tr_b16 v[222:223], v243 offset:25088
  s_waitcnt lgkmcnt(8)
  v_mfma_f32_32x32x16_bf16 v[0:15], v[224:227], v[76:79], v[0:15]
  v_mfma_f32_32x32x16_bf16 v[16:31], v[228:231], v[76:79], v[16:31]
  v_mfma_f32_32x32x16_bf16 v[32:47], v[232:235], v[76:79], v[32:47]
  v_mfma_f32_32x32x16_bf16 v[48:63], v[236:239], v[76:79], v[48:63]
  ds_read_b64_tr_b16 v[224:225], v242 offset:18432
  ds_read_b64_tr_b16 v[226:227], v242 offset:18944
  ds_read_b64_tr_b16 v[228:229], v243 offset:18432
  ds_read_b64_tr_b16 v[230:231], v243 offset:18944
  ds_read_b64_tr_b16 v[232:233], v242 offset:26624
  ds_read_b64_tr_b16 v[234:235], v242 offset:27136
  ds_read_b64_tr_b16 v[236:237], v243 offset:26624
  ds_read_b64_tr_b16 v[238:239], v243 offset:27136
  s_waitcnt lgkmcnt(8)
  v_mfma_f32_32x32x16_bf16 v[0:15], v[208:211], v[80:83], v[0:15]
  v_mfma_f32_32x32x16_bf16 v[16:31], v[212:215], v[80:83], v[16:31]
  v_mfma_f32_32x32x16_bf16 v[32:47], v[216:219], v[80:83], v[32:47]
  v_mfma_f32_32x32x16_bf16 v[48:63], v[220:223], v[80:83], v[48:63]
  ds_read_b64_tr_b16 v[208:209], v242 offset:20480
  ds_read_b64_tr_b16 v[210:211], v242 offset:20992
  ds_read_b64_tr_b16 v[212:213], v243 offset:20480
  ds_read_b64_tr_b16 v[214:215], v243 offset:20992
  ds_read_b64_tr_b16 v[216:217], v242 offset:28672
  ds_read_b64_tr_b16 v[218:219], v242 offset:29184
  ds_read_b64_tr_b16 v[220:221], v243 offset:28672
  ds_read_b64_tr_b16 v[222:223], v243 offset:29184
  s_waitcnt lgkmcnt(8)
  v_mfma_f32_32x32x16_bf16 v[0:15], v[224:227], v[84:87], v[0:15]
  v_mfma_f32_32x32x16_bf16 v[16:31], v[228:231], v[84:87], v[16:31]
  v_mfma_f32_32x32x16_bf16 v[32:47], v[232:235], v[84:87], v[32:47]
  v_mfma_f32_32x32x16_bf16 v[48:63], v[236:239], v[84:87], v[48:63]
  s_waitcnt vmcnt(6)
  s_barrier
  s_add_u32 m0, s55, 65536
  s_nop 0
  buffer_load_dwordx4 v240, s[44:47], s53 offen lds
  s_add_u32 m0, s55, 73728
  s_nop 0
  buffer_load_dwordx4 v240, s[48:51], s53 offen lds
  s_add_u32 s53, s53, s17
  s_mov_b32 s59, 16384
  buffer_load_dwordx4 v[128:131], v244, s[40:43], s59 offen
  s_mov_b32 s59, 17408
  buffer_load_dwordx4 v[132:135], v244, s[40:43], s59 offen
  s_mov_b32 s59, 18432
  buffer_load_dwordx4 v[136:139], v244, s[40:43], s59 offen
  s_mov_b32 s59, 19456
  buffer_load_dwordx4 v[140:143], v244, s[40:43], s59 offen
  ds_read_b64_tr_b16 v[224:225], v242 offset:22528
  ds_read_b64_tr_b16 v[226:227], v242 offset:23040
  ds_read_b64_tr_b16 v[228:229], v243 offset:22528
  ds_read_b64_tr_b16 v[230:231], v243 offset:23040
  ds_read_b64_tr_b16 v[232:233], v242 offset:30720
  ds_read_b64_tr_b16 v[234:235], v242 offset:31232
  ds_read_b64_tr_b16 v[236:237], v243 offset:30720
  ds_read_b64_tr_b16 v[238:239], v243 offset:31232
  s_waitcnt lgkmcnt(8)
  v_mfma_f32_32x32x16_bf16 v[0:15], v[208:211], v[88:91], v[0:15]
  v_mfma_f32_32x32x16_bf16 v[16:31], v[212:215], v[88:91], v[16:31]
  v_mfma_f32_32x32x16_bf16 v[32:47], v[216:219], v[88:91], v[32:47]
  v_mfma_f32_32x32x16_bf16 v[48:63], v[220:223], v[88:91], v[48:63]
  ds_read_b64_tr_b16 v[208:209], v242 offset:32768
  ds_read_b64_tr_b16 v[210:211], v242 offset:33280
  ds_read_b64_tr_b16 v[212:213], v243 offset:32768
  ds_read_b64_tr_b16 v[214:215], v243 offset:33280
  ds_read_b64_tr_b16 v[216:217], v242 offset:40960
  ds_read_b64_tr_b16 v[218:219], v242 offset:41472
  ds_read_b64_tr_b16 v[220:221], v243 offset:40960
  ds_read_b64_tr_b16 v[222:223], v243 offset:41472
  s_waitcnt lgkmcnt(8)
  v_mfma_f32_32x32x16_bf16 v[0:15], v[224:227], v[92:95], v[0:15]
  v_mfma_f32_32x32x16_bf16 v[16:31], v[228:231], v[92:95], v[16:31]
  v_mfma_f32_32x32x16_bf16 v[32:47], v[232:235], v[92:95], v[32:47]
  v_mfma_f32_32x32x16_bf16 v[48:63], v[236:239], v[92:95], v[48:63]
  ds_read_b64_tr_b16 v[224:225], v242 offset:34816
  ds_read_b64_tr_b16 v[226:227], v242 offset:35328
  ds_read_b64_tr_b16 v[228:229], v243 offset:34816
  ds_read_b64_tr_b16 v[230:231], v243 offset:35328
  ds_read_b64_tr_b16 v[232:233], v242 offset:43008
  ds_read_b64_tr_b16 v[234:235], v242 offset:43520
  ds_read_b64_tr_b16 v[236:237], v243 offset:43008
  ds_read_b64_tr_b16 v[238:239], v243 offset:43520
  s_waitcnt lgkmcnt(8)
  v_mfma_f32_32x32x16_bf16 v[0:15], v[208:211], v[96:99], v[0:15]
  v_mfma_f32_32x32x16_bf16 v[16:31], v[212:215], v[96:99], v[16:31]
  v_mfma_f32_32x32x16_bf16 v[32:47], v[216:219], v[96:99], v[32:47]
  v_mfma_f32_32x32x16_bf16 v[48:63], v[220:223], v[96:99], v[48:63]
  ds_read_b64_tr_b16 v[208:209], v242 offset:36864
  ds_read_b64_tr_b16 v[210:211], v242 offset:37376
  ds_read_b64_tr_b16 v[212:213], v243 offset:36864
  ds_read_b64_tr_b16 v[214:215], v243 offset:37376
  ds_read_b64_tr_b16 v[216:217], v242 offset:45056
  ds_read_b64_tr_b16 v[218:219], v242 offset:45568
  ds_read_b64_tr_b16 v[220:221], v243 offset:45056
  ds_read_b64_tr_b16 v[222:223], v243 offset:45568
  s_waitcnt lgkmcnt(8)
  v_mfma_f32_32x32x16_bf16 v[0:15], v[224:227], v[100:103], v[0:15]
  v_mfma_f32_32x32x16_bf16 v[16:31], v[228:231], v[100:103], v[16:31]
  v_mfma_f32_32x32x16_bf16 v[32:47], v[232:235], v[100:103], v[32:47]
  v_mfma_f32_32x32x16_bf16 v[48:63], v[236:239], v[100:103], v[48:63]
  s_waitcnt vmcnt(6)
  s_barrier
  s_add_u32 m0, s55, 81920
  s_nop 0
  buffer_load_dwordx4 v240, s[44:47], s53 offen lds
  s_add_u32 m0, s55, 90112
  s_nop 0
  buffer_load_dwordx4 v240, s[48:51], s53 offen lds
  s_add_u32 s53, s53, s17
  s_mov_b32 s59, 20480
  buffer_load_dwordx4 v[144:147], v244, s[40:43], s59 offen
  s_mov_b32 s59, 21504
  buffer_load_dwordx4 v[148:151], v244, s[40:43], s59 offen
  s_mov_b32 s59, 22528
  buffer_load_dwordx4 v[152:155], v244, s[40:43], s59 offen
  s_mov_b32 s59, 23552
  buffer_load_dwordx4 v[156:159], v244, s[40:43], s59 offen
  ds_read_b64_tr_b16 v[224:225], v242 offset:38912
  ds_read_b64_tr_b16 v[226:227], v242 offset:39424
  ds_read_b64_tr_b16 v[228:229], v243 offset:38912
  ds_read_b64_tr_b16 v[230:231], v243 offset:39424
  ds_read_b64_tr_b16 v[232:233], v242 offset:47104
  ds_read_b64_tr_b16 v[234:235], v242 offset:47616
  ds_read_b64_tr_b16 v[236:237], v243 offset:47104
  ds_read_b64_tr_b16 v[238:239], v243 offset:47616
  s_waitcnt lgkmcnt(8)
  v_mfma_f32_32x32x16_bf16 v[0:15], v[208:211], v[104:107], v[0:15]
  v_mfma_f32_32x32x16_bf16 v[16:31], v[212:215], v[104:107], v[16:31]
  v_mfma_f32_32x32x16_bf16 v[32:47], v[216:219], v[104:107], v[32:47]
  v_mfma_f32_32x32x16_bf16 v[48:63], v[220:223], v[104:107], v[48:63]
  ds_read_b64_tr_b16 v[208:209], v242 offset:49152
  ds_read_b64_tr_b16 v[210:211], v242 offset:49664
  ds_read_b64_tr_b16 v[212:213], v243 offset:49152
  ds_read_b64_tr_b16 v[214:215], v243 offset:49664
  ds_read_b64_tr_b16 v[216:217], v242 offset:57344
  ds_read_b64_tr_b16 v[218:219], v242 offset:57856
  ds_read_b64_tr_b16 v[220:221], v243 offset:57344
  ds_read_b64_tr_b16 v[222:223], v243 offset:57856
  s_waitcnt lgkmcnt(8)
  v_mfma_f32_32x32x16_bf16 v[0:15], v[224:227], v[108:111], v[0:15]
  v_mfma_f32_32x32x16_bf16 v[16:31], v[228:231], v[108:111], v[16:31]
  v_mfma_f32_32x32x16_bf16 v[32:47], v[232:235], v[108:111], v[32:47]
  v_mfma_f32_32x32x16_bf16 v[48:63], v[236:239], v[108:111], v[48:63]
  ds_read_b64_tr_b16 v[224:225], v242 offset:51200
  ds_read_b64_tr_b16 v[226:227], v242 offset:51712
  ds_read_b64_tr_b16 v[228:229], v243 offset:51200
  ds_read_b64_tr_b16 v[230:231], v243 offset:51712
  ds_read_b64_tr_b16 v[232:233], v242 offset:59392
  ds_read_b64_tr_b16 v[234:235], v242 offset:59904
  ds_read_b64_tr_b16 v[236:237], v243 offset:59392
  ds_read_b64_tr_b16 v[238:239], v243 offset:59904
  s_waitcnt lgkmcnt(8)
  v_mfma_f32_32x32x16_bf16 v[0:15], v[208:211], v[112:115], v[0:15]
  v_mfma_f32_32x32x16_bf16 v[16:31], v[212:215], v[112:115], v[16:31]
  v_mfma_f32_32x32x16_bf16 v[32:47], v[216:219], v[112:115], v[32:47]
  v_mfma_f32_32x32x16_bf16 v[48:63], v[220:223], v[112:115], v[48:63]
  ds_read_b64_tr_b16 v[208:209], v242 offset:53248
  ds_read_b64_tr_b16 v[210:211], v242 offset:53760
  ds_read_b64_tr_b16 v[212:213], v243 offset:53248
  ds_read_b64_tr_b16 v[214:215], v243 offset:53760
  ds_read_b64_tr_b16 v[216:217], v242 offset:61440
  ds_read_b64_tr_b16 v[218:219], v242 offset:61952
  ds_read_b64_tr_b16 v[220:221], v243 offset:61440
  ds_read_b64_tr_b16 v[222:223], v243 offset:61952
  s_waitcnt lgkmcnt(8)
  v_mfma_f32_32x32x16_bf16 v[0:15], v[224:227], v[116:119], v[0:15]
  v_mfma_f32_32x32x16_bf16 v[16:31], v[228:231], v[116:119], v[16:31]
  v_mfma_f32_32x32x16_bf16 v[32:47], v[232:235], v[116:119], v[32:47]
  v_mfma_f32_32x32x16_bf16 v[48:63], v[236:239], v[116:119], v[48:63]
  s_waitcnt vmcnt(6)
  s_barrier
  s_add_u32 m0, s55, 98304
  s_nop 0
  buffer_load_dwordx4 v240, s[44:47], s53 offen lds
  s_add_u32 m0, s55, 106496
  s_nop 0
  buffer_load_dwordx4 v240, s[48:51], s53 offen lds
  s_add_u32 s53, s53, s17
  s_mov_b32 s59, 24576
  buffer_load_dwordx4 v[160:163], v244, s[40:43], s59 offen
  s_mov_b32 s59, 25600
  buffer_load_dwordx4 v[164:167], v244, s[40:43], s59 offen
  s_mov_b32 s59, 26624
  buffer_load_dwordx4 v[168:171], v244, s[40:43], s59 offen
  s_mov_b32 s59, 27648
  buffer_load_dwordx4 v[172:175], v244, s[40:43], s59 offen
  ds_read_b64_tr_b16 v[224:225], v242 offset:55296
  ds_read_b64_tr_b16 v[226:227], v242 offset:55808
  ds_read_b64_tr_b16 v[228:229], v243 offset:55296
  ds_read_b64_tr_b16 v[230:231], v243 offset:55808
  ds_read_b64_tr_b16 v[232:233], v242 offset:63488
  ds_read_b64_tr_b16 v[234:235], v242 offset:64000
  ds_read_b64_tr_b16 v[236:237], v243 offset:63488
  ds_read_b64_tr_b16 v[238:239], v243 offset:64000
  s_waitcnt lgkmcnt(8)
  v_mfma_f32_32x32x16_bf16 v[0:15], v[208:211], v[120:123], v[0:15]
  v_mfma_f32_32x32x16_bf16 v[16:31], v[212:215], v[120:123], v[16:31]
  v_mfma_f32_32x32x16_bf16 v[32:47], v[216:219], v[120:123], v[32:47]
  v_mfma_f32_32x32x16_bf16 v[48:63], v[220:223], v[120:123], v[48:63]
  ds_read_b64_tr_b16 v[208:209], v252 offset:0
  ds_read_b64_tr_b16 v[210:211], v252 offset:512
  ds_read_b64_tr_b16 v[212:213], v253 offset:0
  ds_read_b64_tr_b16 v[214:215], v253 offset:512
  ds_read_b64_tr_b16 v[216:217], v252 offset:8192
  ds_read_b64_tr_b16 v[218:219], v252 offset:8704
  ds_read_b64_tr_b16 v[220:221], v253 offset:8192
  ds_read_b64_tr_b16 v[222:223], v253 offset:8704
  s_waitcnt lgkmcnt(8)
  v_mfma_f32_32x32x16_bf16 v[0:15], v[224:227], v[124:127], v[0:15]
  v_mfma_f32_32x32x16_bf16 v[16:31], v[228:231], v[124:127], v[16:31]
  v_mfma_f32_32x32x16_bf16 v[32:47], v[232:235], v[124:127], v[32:47]
  v_mfma_f32_32x32x16_bf16 v[48:63], v[236:239], v[124:127], v[48:63]
  ds_read_b64_tr_b16 v[224:225], v252 offset:2048
  ds_read_b64_tr_b16 v[226:227], v252 offset:2560
  ds_read_b64_tr_b16 v[228:229], v253 offset:2048
  ds_read_b64_tr_b16 v[230:231], v253 offset:2560
  ds_read_b64_tr_b16 v[232:233], v252 offset:10240
  ds_read_b64_tr_b16 v[234:235], v252 offset:10752
  ds_read_b64_tr_b16 v[236:237], v253 offset:10240
  ds_read_b64_tr_b16 v[238:239], v253 offset:10752
  s_waitcnt lgkmcnt(8)
  v_mfma_f32_32x32x16_bf16 v[0:15], v[208:211], v[128:131], v[0:15]
  v_mfma_f32_32x32x16_bf16 v[16:31], v[212:215], v[128:131], v[16:31]
  v_mfma_f32_32x32x16_bf16 v[32:47], v[216:219], v[128:131], v[32:47]
  v_mfma_f32_32x32x16_bf16 v[48:63], v[220:223], v[128:131], v[48:63]
  ds_read_b64_tr_b16 v[208:209], v252 offset:4096
  ds_read_b64_tr_b16 v[210:211], v252 offset:4608
  ds_read_b64_tr_b16 v[212:213], v253 offset:4096
  ds_read_b64_tr_b16 v[214:215], v253 offset:4608
  ds_read_b64_tr_b16 v[216:217], v252 offset:12288
  ds_read_b64_tr_b16 v[218:219], v252 offset:12800
  ds_read_b64_tr_b16 v[220:221], v253 offset:12288
  ds_read_b64_tr_b16 v[222:223], v253 offset:12800
  s_waitcnt lgkmcnt(8)
  v_mfma_f32_32x32x16_bf16 v[0:15], v[224:227], v[132:135], v[0:15]
  v_mfma_f32_32x32x16_bf16 v[16:31], v[228:231], v[132:135], v[16:31]
  v_mfma_f32_32x32x16_bf16 v[32:47], v[232:235], v[132:135], v[32:47]
  v_mfma_f32_32x32x16_bf16 v[48:63], v[236:239], v[132:135], v[48:63]
  s_waitcnt vmcnt(6)
  s_barrier
  s_add_u32 m0, s55, 114688
  s_nop 0
  buffer_load_dwordx4 v240, s[44:47], s53 offen lds
  s_add_u32 m0, s55, 122880
  s_nop 0
  buffer_load_dwordx4 v240, s[48:51], s53 offen lds
  s_add_u32 s53, s53, s17
  s_mov_b32 s59, 28672
  buffer_load_dwordx4 v[176:179], v244, s[40:43], s59 offen
  s_mov_b32 s59, 29696
  buffer_load_dwordx4 v[180:183], v244, s[40:43], s59 offen
  s_mov_b32 s59, 30720
  buffer_load_dwordx4 v[184:187], v244, s[40:43], s59 offen
  s_mov_b32 s59, 31744
  buffer_load_dwordx4 v[188:191], v244, s[40:43], s59 offen
  ds_read_b64_tr_b16 v[224:225], v252 offset:6144
  ds_read_b64_tr_b16 v[226:227], v252 offset:6656
  ds_read_b64_tr_b16 v[228:229], v253 offset:6144
  ds_read_b64_tr_b16 v[230:231], v253 offset:6656
  ds_read_b64_tr_b16 v[232:233], v252 offset:14336
  ds_read_b64_tr_b16 v[234:235], v252 offset:14848
  ds_read_b64_tr_b16 v[236:237], v253 offset:14336
  ds_read_b64_tr_b16 v[238:239], v253 offset:14848
  s_waitcnt lgkmcnt(8)
  v_mfma_f32_32x32x16_bf16 v[0:15], v[208:211], v[136:139], v[0:15]
  v_mfma_f32_32x32x16_bf16 v[16:31], v[212:215], v[136:139], v[16:31]
  v_mfma_f32_32x32x16_bf16 v[32:47], v[216:219], v[136:139], v[32:47]
  v_mfma_f32_32x32x16_bf16 v[48:63], v[220:223], v[136:139], v[48:63]
  ds_read_b64_tr_b16 v[208:209], v252 offset:16384
  ds_read_b64_tr_b16 v[210:211], v252 offset:16896
  ds_read_b64_tr_b16 v[212:213], v253 offset:16384
  ds_read_b64_tr_b16 v[214:215], v253 offset:16896
  ds_read_b64_tr_b16 v[216:217], v252 offset:24576
  ds_read_b64_tr_b16 v[218:219], v252 offset:25088
  ds_read_b64_tr_b16 v[220:221], v253 offset:24576
  ds_read_b64_tr_b16 v[222:223], v253 offset:25088
  s_waitcnt lgkmcnt(8)
  v_mfma_f32_32x32x16_bf16 v[0:15], v[224:227], v[140:143], v[0:15]
  v_mfma_f32_32x32x16_bf16 v[16:31], v[228:231], v[140:143], v[16:31]
  v_mfma_f32_32x32x16_bf16 v[32:47], v[232:235], v[140:143], v[32:47]
  v_mfma_f32_32x32x16_bf16 v[48:63], v[236:239], v[140:143], v[48:63]
  ds_read_b64_tr_b16 v[224:225], v252 offset:18432
  ds_read_b64_tr_b16 v[226:227], v252 offset:18944
  ds_read_b64_tr_b16 v[228:229], v253 offset:18432
  ds_read_b64_tr_b16 v[230:231], v253 offset:18944
  ds_read_b64_tr_b16 v[232:233], v252 offset:26624
  ds_read_b64_tr_b16 v[234:235], v252 offset:27136
  ds_read_b64_tr_b16 v[236:237], v253 offset:26624
  ds_read_b64_tr_b16 v[238:239], v253 offset:27136
  s_waitcnt lgkmcnt(8)
  v_mfma_f32_32x32x16_bf16 v[0:15], v[208:211], v[144:147], v[0:15]
  v_mfma_f32_32x32x16_bf16 v[16:31], v[212:215], v[144:147], v[16:31]
  v_mfma_f32_32x32x16_bf16 v[32:47], v[216:219], v[144:147], v[32:47]
  v_mfma_f32_32x32x16_bf16 v[48:63], v[220:223], v[144:147], v[48:63]
  ds_read_b64_tr_b16 v[208:209], v252 offset:20480
  ds_read_b64_tr_b16 v[210:211], v252 offset:20992
  ds_read_b64_tr_b16 v[212:213], v253 offset:20480
  ds_read_b64_tr_b16 v[214:215], v253 offset:20992
  ds_read_b64_tr_b16 v[216:217], v252 offset:28672
  ds_read_b64_tr_b16 v[218:219], v252 offset:29184
  ds_read_b64_tr_b16 v[220:221], v253 offset:28672
  ds_read_b64_tr_b16 v[222:223], v253 offset:29184
  s_waitcnt lgkmcnt(8)
  v_mfma_f32_32x32x16_bf16 v[0:15], v[224:227], v[148:151], v[0:15]
  v_mfma_f32_32x32x16_bf16 v[16:31], v[228:231], v[148:151], v[16:31]
  v_mfma_f32_32x32x16_bf16 v[32:47], v[232:235], v[148:151], v[32:47]
  v_mfma_f32_32x32x16_bf16 v[48:63], v[236:239], v[148:151], v[48:63]
  s_waitcnt vmcnt(6)
  s_barrier
  s_add_u32 m0, s55, 131072
  s_nop 0
  buffer_load_dwordx4 v240, s[44:47], s53 offen lds
  s_add_u32 m0, s55, 139264
  s_nop 0
  buffer_load_dwordx4 v240, s[48:51], s53 offen lds
  s_add_u32 s53, s53, s17
  s_mov_b32 s59, 32768
  buffer_load_dwordx4 v[192:195], v244, s[40:43], s59 offen
  s_mov_b32 s59, 33792
  buffer_load_dwordx4 v[196:199], v244, s[40:43], s59 offen
  s_mov_b32 s59, 34816
  buffer_load_dwordx4 v[200:203], v244, s[40:43], s59 offen
  s_mov_b32 s59, 35840
  buffer_load_dwordx4 v[204:207], v244, s[40:43], s59 offen
  ds_read_b64_tr_b16 v[224:225], v252 offset:22528
  ds_read_b64_tr_b16 v[226:227], v252 offset:23040
  ds_read_b64_tr_b16 v[228:229], v253 offset:22528
  ds_read_b64_tr_b16 v[230:231], v253 offset:23040
  ds_read_b64_tr_b16 v[232:233], v252 offset:30720
  ds_read_b64_tr_b16 v[234:235], v252 offset:31232
  ds_read_b64_tr_b16 v[236:237], v253 offset:30720
  ds_read_b64_tr_b16 v[238:239], v253 offset:31232
  s_waitcnt lgkmcnt(8)
  v_mfma_f32_32x32x16_bf16 v[0:15], v[208:211], v[152:155], v[0:15]
  v_mfma_f32_32x32x16_bf16 v[16:31], v[212:215], v[152:155], v[16:31]
  v_mfma_f32_32x32x16_bf16 v[32:47], v[216:219], v[152:155], v[32:47]
  v_mfma_f32_32x32x16_bf16 v[48:63], v[220:223], v[152:155], v[48:63]
  ds_read_b64_tr_b16 v[208:209], v252 offset:32768
  ds_read_b64_tr_b16 v[210:211], v252 offset:33280
  ds_read_b64_tr_b16 v[212:213], v253 offset:32768
  ds_read_b64_tr_b16 v[214:215], v253 offset:33280
  ds_read_b64_tr_b16 v[216:217], v252 offset:40960
  ds_read_b64_tr_b16 v[218:219], v252 offset:41472
  ds_read_b64_tr_b16 v[220:221], v253 offset:40960
  ds_read_b64_tr_b16 v[222:223], v253 offset:41472
  s_waitcnt lgkmcnt(8)
  v_mfma_f32_32x32x16_bf16 v[0:15], v[224:227], v[156:159], v[0:15]
  v_mfma_f32_32x32x16_bf16 v[16:31], v[228:231], v[156:159], v[16:31]
  v_mfma_f32_32x32x16_bf16 v[32:47], v[232:235], v[156:159], v[32:47]
  v_mfma_f32_32x32x16_bf16 v[48:63], v[236:239], v[156:159], v[48:63]
  ds_read_b64_tr_b16 v[224:225], v252 offset:34816
  ds_read_b64_tr_b16 v[226:227], v252 offset:35328
  ds_read_b64_tr_b16 v[228:229], v253 offset:34816
  ds_read_b64_tr_b16 v[230:231], v253 offset:35328
  ds_read_b64_tr_b16 v[232:233], v252 offset:43008
  ds_read_b64_tr_b16 v[234:235], v252 offset:43520
  ds_read_b64_tr_b16 v[236:237], v253 offset:43008
  ds_read_b64_tr_b16 v[238:239], v253 offset:43520
  s_waitcnt lgkmcnt(8)
  v_mfma_f32_32x32x16_bf16 v[0:15], v[208:211], v[160:163], v[0:15]
  v_mfma_f32_32x32x16_bf16 v[16:31], v[212:215], v[160:163], v[16:31]
  v_mfma_f32_32x32x16_bf16 v[32:47], v[216:219], v[160:163], v[32:47]
  v_mfma_f32_32x32x16_bf16 v[48:63], v[220:223], v[160:163], v[48:63]
  ds_read_b64_tr_b16 v[208:209], v252 offset:36864
  ds_read_b64_tr_b16 v[210:211], v252 offset:37376
  ds_read_b64_tr_b16 v[212:213], v253 offset:36864
  ds_read_b64_tr_b16 v[214:215], v253 offset:37376
  ds_read_b64_tr_b16 v[216:217], v252 offset:45056
  ds_read_b64_tr_b16 v[218:219], v252 offset:45568
  ds_read_b64_tr_b16 v[220:221], v253 offset:45056
  ds_read_b64_tr_b16 v[222:223], v253 offset:45568
  s_waitcnt lgkmcnt(8)
  v_mfma_f32_32x32x16_bf16 v[0:15], v[224:227], v[164:167], v[0:15]
  v_mfma_f32_32x32x16_bf16 v[16:31], v[228:231], v[164:167], v[16:31]
  v_mfma_f32_32x32x16_bf16 v[32:47], v[232:235], v[164:167], v[32:47]
  v_mfma_f32_32x32x16_bf16 v[48:63], v[236:239], v[164:167], v[48:63]
  s_waitcnt vmcnt(6)
  s_barrier
  s_add_u32 s31, s31, 1
  s_cmp_lt_u32 s31, s19
  s_cselect_b32 s31, s31, s24
  s_lshl_b32 s15, s31, 6

  s_lshl_b32 s17, s16, 6
  s_lshl_b32 s59, s56, 3
  v_lshrrev_b32 v248, 3, v245
  v_add_u32 v248, s59, v248
  v_and_b32 v249, 7, v245
  v_bfe_u32 v250, v245, 4, 1
  v_lshlrev_b32 v250, 2, v250
  v_xor_b32 v249, v249, v250
  v_lshlrev_b32 v249, 4, v249
  s_lshl_b32 s59, s15, 1
  v_add_u32 v249, s59, v249
  v_mul_lo_u32 v250, v248, s16
  v_add_u32 v240, v250, v249
  s_mov_b32 s53, 0
  s_nop 4

  s_add_u32 m0, s55, 0
  s_nop 0
  buffer_load_dwordx4 v240, s[44:47], s53 offen lds
  s_add_u32 m0, s55, 8192
  s_nop 0
  buffer_load_dwordx4 v240, s[48:51], s53 offen lds
  s_add_u32 s53, s53, s17
  ds_read_b64_tr_b16 v[224:225], v252 offset:38912
  ds_read_b64_tr_b16 v[226:227], v252 offset:39424
  ds_read_b64_tr_b16 v[228:229], v253 offset:38912
  ds_read_b64_tr_b16 v[230:231], v253 offset:39424
  ds_read_b64_tr_b16 v[232:233], v252 offset:47104
  ds_read_b64_tr_b16 v[234:235], v252 offset:47616
  ds_read_b64_tr_b16 v[236:237], v253 offset:47104
  ds_read_b64_tr_b16 v[238:239], v253 offset:47616
  s_waitcnt lgkmcnt(8)
  v_mfma_f32_32x32x16_bf16 v[0:15], v[208:211], v[168:171], v[0:15]
  v_mfma_f32_32x32x16_bf16 v[16:31], v[212:215], v[168:171], v[16:31]
  v_mfma_f32_32x32x16_bf16 v[32:47], v[216:219], v[168:171], v[32:47]
  v_mfma_f32_32x32x16_bf16 v[48:63], v[220:223], v[168:171], v[48:63]
  ds_read_b64_tr_b16 v[208:209], v252 offset:49152
  ds_read_b64_tr_b16 v[210:211], v252 offset:49664
  ds_read_b64_tr_b16 v[212:213], v253 offset:49152
  ds_read_b64_tr_b16 v[214:215], v253 offset:49664
  ds_read_b64_tr_b16 v[216:217], v252 offset:57344
  ds_read_b64_tr_b16 v[218:219], v252 offset:57856
  ds_read_b64_tr_b16 v[220:221], v253 offset:57344
  ds_read_b64_tr_b16 v[222:223], v253 offset:57856
  s_waitcnt lgkmcnt(8)
  v_mfma_f32_32x32x16_bf16 v[0:15], v[224:227], v[172:175], v[0:15]
  v_mfma_f32_32x32x16_bf16 v[16:31], v[228:231], v[172:175], v[16:31]
  v_mfma_f32_32x32x16_bf16 v[32:47], v[232:235], v[172:175], v[32:47]
  v_mfma_f32_32x32x16_bf16 v[48:63], v[236:239], v[172:175], v[48:63]
  ds_read_b64_tr_b16 v[224:225], v252 offset:51200
  ds_read_b64_tr_b16 v[226:227], v252 offset:51712
  ds_read_b64_tr_b16 v[228:229], v253 offset:51200
  ds_read_b64_tr_b16 v[230:231], v253 offset:51712
  ds_read_b64_tr_b16 v[232:233], v252 offset:59392
  ds_read_b64_tr_b16 v[234:235], v252 offset:59904
  ds_read_b64_tr_b16 v[236:237], v253 offset:59392
  ds_read_b64_tr_b16 v[238:239], v253 offset:59904
  s_waitcnt lgkmcnt(8)
  v_mfma_f32_32x32x16_bf16 v[0:15], v[208:211], v[176:179], v[0:15]
  v_mfma_f32_32x32x16_bf16 v[16:31], v[212:215], v[176:179], v[16:31]
  v_mfma_f32_32x32x16_bf16 v[32:47], v[216:219], v[176:179], v[32:47]
  v_mfma_f32_32x32x16_bf16 v[48:63], v[220:223], v[176:179], v[48:63]
  ds_read_b64_tr_b16 v[208:209], v252 offset:53248
  ds_read_b64_tr_b16 v[210:211], v252 offset:53760
  ds_read_b64_tr_b16 v[212:213], v253 offset:53248
  ds_read_b64_tr_b16 v[214:215], v253 offset:53760
  ds_read_b64_tr_b16 v[216:217], v252 offset:61440
  ds_read_b64_tr_b16 v[218:219], v252 offset:61952
  ds_read_b64_tr_b16 v[220:221], v253 offset:61440
  ds_read_b64_tr_b16 v[222:223], v253 offset:61952
  s_waitcnt lgkmcnt(8)
  v_mfma_f32_32x32x16_bf16 v[0:15], v[224:227], v[180:183], v[0:15]
  v_mfma_f32_32x32x16_bf16 v[16:31], v[228:231], v[180:183], v[16:31]
  v_mfma_f32_32x32x16_bf16 v[32:47], v[232:235], v[180:183], v[32:47]
  v_mfma_f32_32x32x16_bf16 v[48:63], v[236:239], v[180:183], v[48:63]
  s_waitcnt vmcnt(2)
  s_barrier
  s_add_u32 m0, s55, 16384
  s_nop 0
  buffer_load_dwordx4 v240, s[44:47], s53 offen lds
  s_add_u32 m0, s55, 24576
  s_nop 0
  buffer_load_dwordx4 v240, s[48:51], s53 offen lds
  s_add_u32 s53, s53, s17
  ds_read_b64_tr_b16 v[224:225], v252 offset:55296
  ds_read_b64_tr_b16 v[226:227], v252 offset:55808
  ds_read_b64_tr_b16 v[228:229], v253 offset:55296
  ds_read_b64_tr_b16 v[230:231], v253 offset:55808
  ds_read_b64_tr_b16 v[232:233], v252 offset:63488
  ds_read_b64_tr_b16 v[234:235], v252 offset:64000
  ds_read_b64_tr_b16 v[236:237], v253 offset:63488
  ds_read_b64_tr_b16 v[238:239], v253 offset:64000
  s_waitcnt lgkmcnt(8)
  v_mfma_f32_32x32x16_bf16 v[0:15], v[208:211], v[184:187], v[0:15]
  v_mfma_f32_32x32x16_bf16 v[16:31], v[212:215], v[184:187], v[16:31]
  v_mfma_f32_32x32x16_bf16 v[32:47], v[216:219], v[184:187], v[32:47]
  v_mfma_f32_32x32x16_bf16 v[48:63], v[220:223], v[184:187], v[48:63]
  ds_read_b64_tr_b16 v[208:209], v254 offset:0
  ds_read_b64_tr_b16 v[210:211], v254 offset:512
  ds_read_b64_tr_b16 v[212:213], v255 offset:0
  ds_read_b64_tr_b16 v[214:215], v255 offset:512
  ds_read_b64_tr_b16 v[216:217], v254 offset:8192
  ds_read_b64_tr_b16 v[218:219], v254 offset:8704
  ds_read_b64_tr_b16 v[220:221], v255 offset:8192
  ds_read_b64_tr_b16 v[222:223], v255 offset:8704
  s_waitcnt lgkmcnt(8)
  v_mfma_f32_32x32x16_bf16 v[0:15], v[224:227], v[188:191], v[0:15]
  v_mfma_f32_32x32x16_bf16 v[16:31], v[228:231], v[188:191], v[16:31]
  v_mfma_f32_32x32x16_bf16 v[32:47], v[232:235], v[188:191], v[32:47]
  v_mfma_f32_32x32x16_bf16 v[48:63], v[236:239], v[188:191], v[48:63]
  ds_read_b64_tr_b16 v[224:225], v254 offset:2048
  ds_read_b64_tr_b16 v[226:227], v254 offset:2560
  ds_read_b64_tr_b16 v[228:229], v255 offset:2048
  ds_read_b64_tr_b16 v[230:231], v255 offset:2560
  ds_read_b64_tr_b16 v[232:233], v254 offset:10240
  ds_read_b64_tr_b16 v[234:235], v254 offset:10752
  ds_read_b64_tr_b16 v[236:237], v255 offset:10240
  ds_read_b64_tr_b16 v[238:239], v255 offset:10752
  s_waitcnt lgkmcnt(8)
  v_mfma_f32_32x32x16_bf16 v[0:15], v[208:211], v[192:195], v[0:15]
  v_mfma_f32_32x32x16_bf16 v[16:31], v[212:215], v[192:195], v[16:31]
  v_mfma_f32_32x32x16_bf16 v[32:47], v[216:219], v[192:195], v[32:47]
  v_mfma_f32_32x32x16_bf16 v[48:63], v[220:223], v[192:195], v[48:63]
  ds_read_b64_tr_b16 v[208:209], v254 offset:4096
  ds_read_b64_tr_b16 v[210:211], v254 offset:4608
  ds_read_b64_tr_b16 v[212:213], v255 offset:4096
  ds_read_b64_tr_b16 v[214:215], v255 offset:4608
  ds_read_b64_tr_b16 v[216:217], v254 offset:12288
  ds_read_b64_tr_b16 v[218:219], v254 offset:12800
  ds_read_b64_tr_b16 v[220:221], v255 offset:12288
  ds_read_b64_tr_b16 v[222:223], v255 offset:12800
  s_waitcnt lgkmcnt(8)
  v_mfma_f32_32x32x16_bf16 v[0:15], v[224:227], v[196:199], v[0:15]
  v_mfma_f32_32x32x16_bf16 v[16:31], v[228:231], v[196:199], v[16:31]
  v_mfma_f32_32x32x16_bf16 v[32:47], v[232:235], v[196:199], v[32:47]
  v_mfma_f32_32x32x16_bf16 v[48:63], v[236:239], v[196:199], v[48:63]
  ds_read_b64_tr_b16 v[224:225], v254 offset:6144
  ds_read_b64_tr_b16 v[226:227], v254 offset:6656
  ds_read_b64_tr_b16 v[228:229], v255 offset:6144
  ds_read_b64_tr_b16 v[230:231], v255 offset:6656
  ds_read_b64_tr_b16 v[232:233], v254 offset:14336
  ds_read_b64_tr_b16 v[234:235], v254 offset:14848
  ds_read_b64_tr_b16 v[236:237], v255 offset:14336
  ds_read_b64_tr_b16 v[238:239], v255 offset:14848
  s_waitcnt lgkmcnt(8)
  v_mfma_f32_32x32x16_bf16 v[0:15], v[208:211], v[200:203], v[0:15]
  v_mfma_f32_32x32x16_bf16 v[16:31], v[212:215], v[200:203], v[16:31]
  v_mfma_f32_32x32x16_bf16 v[32:47], v[216:219], v[200:203], v[32:47]
  v_mfma_f32_32x32x16_bf16 v[48:63], v[220:223], v[200:203], v[48:63]
  s_waitcnt lgkmcnt(0)
  v_mfma_f32_32x32x16_bf16 v[0:15], v[224:227], v[204:207], v[0:15]
  v_mfma_f32_32x32x16_bf16 v[16:31], v[228:231], v[204:207], v[16:31]
  v_mfma_f32_32x32x16_bf16 v[32:47], v[232:235], v[204:207], v[32:47]
  v_mfma_f32_32x32x16_bf16 v[48:63], v[236:239], v[204:207], v[48:63]
  s_barrier
  s_nop 15
  s_lshr_b32 s59, s12, 5
  s_add_u32 s59, s59, s56
  s_mul_i32 s59, s59, 331776
  s_lshl_b32 s18, s13, 12
  s_add_u32 s59, s59, s18
  s_add_u32 s59, s59, 16777216
  v_lshl_add_u32 v251, v246, 4, s59
  v_lshl_add_u32 v251, v247, 3, v251
  s_mov_b32 s20, 0xbfb8aa3b
  s_mov_b32 s21, s20
  s_mov_b32 s26, 1.0
  s_mov_b32 s27, 1.0

  v_pk_mul_f32 v[208:209], v[0:1], s[20:21]
  v_pk_mul_f32 v[210:211], v[2:3], s[20:21]
  v_exp_f32 v208, v208
  v_exp_f32 v209, v209
  v_exp_f32 v210, v210
  v_exp_f32 v211, v211
  v_pk_mul_f32 v[212:213], v[0:1], v[32:33]
  v_pk_mul_f32 v[214:215], v[2:3], v[34:35]
  v_pk_add_f32 v[208:209], v[208:209], s[26:27]
  v_pk_add_f32 v[210:211], v[210:211], s[26:27]
  v_rcp_f32 v208, v208
  v_rcp_f32 v209, v209
  v_rcp_f32 v210, v210
  v_rcp_f32 v211, v211
  s_nop 0
  v_pk_mul_f32 v[212:213], v[212:213], v[208:209]
  v_pk_mul_f32 v[214:215], v[214:215], v[210:211]
  v_cvt_pk_bf16_f32 v216, v212, v213
  v_cvt_pk_bf16_f32 v217, v214, v215
  buffer_store_dwordx2 v[216:217], v251, s[60:63], 0 offen offset:0
  v_pk_mul_f32 v[218:219], v[4:5], s[20:21]
  v_pk_mul_f32 v[220:221], v[6:7], s[20:21]
  v_exp_f32 v218, v218
  v_exp_f32 v219, v219
  v_exp_f32 v220, v220
  v_exp_f32 v221, v221
  v_pk_mul_f32 v[222:223], v[4:5], v[36:37]
  v_pk_mul_f32 v[224:225], v[6:7], v[38:39]
  v_pk_add_f32 v[218:219], v[218:219], s[26:27]
  v_pk_add_f32 v[220:221], v[220:221], s[26:27]
  v_rcp_f32 v218, v218
  v_rcp_f32 v219, v219
  v_rcp_f32 v220, v220
  v_rcp_f32 v221, v221
  s_nop 0
  v_pk_mul_f32 v[222:223], v[222:223], v[218:219]
  v_pk_mul_f32 v[224:225], v[224:225], v[220:221]
  v_cvt_pk_bf16_f32 v226, v222, v223
  v_cvt_pk_bf16_f32 v227, v224, v225
  buffer_store_dwordx2 v[226:227], v251, s[60:63], 0 offen offset:512
  v_pk_mul_f32 v[228:229], v[8:9], s[20:21]
  v_pk_mul_f32 v[230:231], v[10:11], s[20:21]
  v_exp_f32 v228, v228
  v_exp_f32 v229, v229
  v_exp_f32 v230, v230
  v_exp_f32 v231, v231
  v_pk_mul_f32 v[232:233], v[8:9], v[40:41]
  v_pk_mul_f32 v[234:235], v[10:11], v[42:43]
  v_pk_add_f32 v[228:229], v[228:229], s[26:27]
  v_pk_add_f32 v[230:231], v[230:231], s[26:27]
  v_rcp_f32 v228, v228
  v_rcp_f32 v229, v229
  v_rcp_f32 v230, v230
  v_rcp_f32 v231, v231
  s_nop 0
  v_pk_mul_f32 v[232:233], v[232:233], v[228:229]
  v_pk_mul_f32 v[234:235], v[234:235], v[230:231]
  v_cvt_pk_bf16_f32 v236, v232, v233
  v_cvt_pk_bf16_f32 v237, v234, v235
  buffer_store_dwordx2 v[236:237], v251, s[60:63], 0 offen offset:1024
  v_pk_mul_f32 v[208:209], v[12:13], s[20:21]
  v_pk_mul_f32 v[210:211], v[14:15], s[20:21]
  v_exp_f32 v208, v208
  v_exp_f32 v209, v209
  v_exp_f32 v210, v210
  v_exp_f32 v211, v211
  v_pk_mul_f32 v[212:213], v[12:13], v[44:45]
  v_pk_mul_f32 v[214:215], v[14:15], v[46:47]
  v_pk_add_f32 v[208:209], v[208:209], s[26:27]
  v_pk_add_f32 v[210:211], v[210:211], s[26:27]
  v_rcp_f32 v208, v208
  v_rcp_f32 v209, v209
  v_rcp_f32 v210, v210
  v_rcp_f32 v211, v211
  s_nop 0
  v_pk_mul_f32 v[212:213], v[212:213], v[208:209]
  v_pk_mul_f32 v[214:215], v[214:215], v[210:211]
  v_cvt_pk_bf16_f32 v216, v212, v213
  v_cvt_pk_bf16_f32 v217, v214, v215
  buffer_store_dwordx2 v[216:217], v251, s[60:63], 0 offen offset:1536
  v_pk_mul_f32 v[218:219], v[16:17], s[20:21]
  v_pk_mul_f32 v[220:221], v[18:19], s[20:21]
  v_exp_f32 v218, v218
  v_exp_f32 v219, v219
  v_exp_f32 v220, v220
  v_exp_f32 v221, v221
  v_pk_mul_f32 v[222:223], v[16:17], v[48:49]
  v_pk_mul_f32 v[224:225], v[18:19], v[50:51]
  v_pk_add_f32 v[218:219], v[218:219], s[26:27]
  v_pk_add_f32 v[220:221], v[220:221], s[26:27]
  v_rcp_f32 v218, v218
  v_rcp_f32 v219, v219
  v_rcp_f32 v220, v220
  v_rcp_f32 v221, v221
  s_nop 0
  v_pk_mul_f32 v[222:223], v[222:223], v[218:219]
  v_pk_mul_f32 v[224:225], v[224:225], v[220:221]
  v_cvt_pk_bf16_f32 v226, v222, v223
  v_cvt_pk_bf16_f32 v227, v224, v225
  buffer_store_dwordx2 v[226:227], v251, s[60:63], 0 offen offset:2048
  v_pk_mul_f32 v[228:229], v[20:21], s[20:21]
  v_pk_mul_f32 v[230:231], v[22:23], s[20:21]
  v_exp_f32 v228, v228
  v_exp_f32 v229, v229
  v_exp_f32 v230, v230
  v_exp_f32 v231, v231
  v_pk_mul_f32 v[232:233], v[20:21], v[52:53]
  v_pk_mul_f32 v[234:235], v[22:23], v[54:55]
  v_pk_add_f32 v[228:229], v[228:229], s[26:27]
  v_pk_add_f32 v[230:231], v[230:231], s[26:27]
  v_rcp_f32 v228, v228
  v_rcp_f32 v229, v229
  v_rcp_f32 v230, v230
  v_rcp_f32 v231, v231
  s_nop 0
  v_pk_mul_f32 v[232:233], v[232:233], v[228:229]
  v_pk_mul_f32 v[234:235], v[234:235], v[230:231]
  v_cvt_pk_bf16_f32 v236, v232, v233
  v_cvt_pk_bf16_f32 v237, v234, v235
  buffer_store_dwordx2 v[236:237], v251, s[60:63], 0 offen offset:2560
  v_pk_mul_f32 v[208:209], v[24:25], s[20:21]
  v_pk_mul_f32 v[210:211], v[26:27], s[20:21]
  v_exp_f32 v208, v208
  v_exp_f32 v209, v209
  v_exp_f32 v210, v210
  v_exp_f32 v211, v211
  v_pk_mul_f32 v[212:213], v[24:25], v[56:57]
  v_pk_mul_f32 v[214:215], v[26:27], v[58:59]
  v_pk_add_f32 v[208:209], v[208:209], s[26:27]
  v_pk_add_f32 v[210:211], v[210:211], s[26:27]
  v_rcp_f32 v208, v208
  v_rcp_f32 v209, v209
  v_rcp_f32 v210, v210
  v_rcp_f32 v211, v211
  s_nop 0
  v_pk_mul_f32 v[212:213], v[212:213], v[208:209]
  v_pk_mul_f32 v[214:215], v[214:215], v[210:211]
  v_cvt_pk_bf16_f32 v216, v212, v213
  v_cvt_pk_bf16_f32 v217, v214, v215
  buffer_store_dwordx2 v[216:217], v251, s[60:63], 0 offen offset:3072
  v_pk_mul_f32 v[218:219], v[28:29], s[20:21]
  v_pk_mul_f32 v[220:221], v[30:31], s[20:21]
  v_exp_f32 v218, v218
  v_exp_f32 v219, v219
  v_exp_f32 v220, v220
  v_exp_f32 v221, v221
  v_pk_mul_f32 v[222:223], v[28:29], v[60:61]
  v_pk_mul_f32 v[224:225], v[30:31], v[62:63]
  v_pk_add_f32 v[218:219], v[218:219], s[26:27]
  v_pk_add_f32 v[220:221], v[220:221], s[26:27]
  v_rcp_f32 v218, v218
  v_rcp_f32 v219, v219
  v_rcp_f32 v220, v220
  v_rcp_f32 v221, v221
  s_nop 0
  v_pk_mul_f32 v[222:223], v[222:223], v[218:219]
  v_pk_mul_f32 v[224:225], v[224:225], v[220:221]
  v_cvt_pk_bf16_f32 v226, v222, v223
  v_cvt_pk_bf16_f32 v227, v224, v225
  buffer_store_dwordx2 v[226:227], v251, s[60:63], 0 offen offset:3584
  s_add_u32 s13, s13, 1
  s_cmp_lt_u32 s13, s19
  s_cselect_b32 s13, s13, s24
  s_waitcnt vmcnt(10)
  s_barrier
  s_add_u32 m0, s55, 32768
  s_nop 0
  buffer_load_dwordx4 v240, s[44:47], s53 offen lds
  s_add_u32 m0, s55, 40960
  s_nop 0
  buffer_load_dwordx4 v240, s[48:51], s53 offen lds
  s_add_u32 s53, s53, s17
  s_add_u32 m0, s55, 49152
  s_nop 0
  buffer_load_dwordx4 v240, s[44:47], s53 offen lds
  s_add_u32 m0, s55, 57344
  s_nop 0
  buffer_load_dwordx4 v240, s[48:51], s53 offen lds
  s_add_u32 s53, s53, s17
  ds_read_b64_tr_b16 v[208:209], v242 offset:0
  ds_read_b64_tr_b16 v[210:211], v242 offset:512
  ds_read_b64_tr_b16 v[212:213], v243 offset:0
  ds_read_b64_tr_b16 v[214:215], v243 offset:512
  ds_read_b64_tr_b16 v[216:217], v242 offset:8192
  ds_read_b64_tr_b16 v[218:219], v242 offset:8704
  ds_read_b64_tr_b16 v[220:221], v243 offset:8192
  ds_read_b64_tr_b16 v[222:223], v243 offset:8704
  ds_read_b64_tr_b16 v[224:225], v242 offset:2048
  ds_read_b64_tr_b16 v[226:227], v242 offset:2560
  ds_read_b64_tr_b16 v[228:229], v243 offset:2048
  ds_read_b64_tr_b16 v[230:231], v243 offset:2560
  ds_read_b64_tr_b16 v[232:233], v242 offset:10240
  ds_read_b64_tr_b16 v[234:235], v242 offset:10752
  ds_read_b64_tr_b16 v[236:237], v243 offset:10240
  ds_read_b64_tr_b16 v[238:239], v243 offset:10752
  s_waitcnt lgkmcnt(8)
  v_mfma_f32_32x32x16_bf16 v[0:15], v[208:211], v[64:67], 0
  v_mfma_f32_32x32x16_bf16 v[16:31], v[212:215], v[64:67], 0
  v_mfma_f32_32x32x16_bf16 v[32:47], v[216:219], v[64:67], 0
  v_mfma_f32_32x32x16_bf16 v[48:63], v[220:223], v[64:67], 0
  ds_read_b64_tr_b16 v[208:209], v242 offset:4096
  ds_read_b64_tr_b16 v[210:211], v242 offset:4608
  ds_read_b64_tr_b16 v[212:213], v243 offset:4096
  ds_read_b64_tr_b16 v[214:215], v243 offset:4608
  ds_read_b64_tr_b16 v[216:217], v242 offset:12288
  ds_read_b64_tr_b16 v[218:219], v242 offset:12800
  ds_read_b64_tr_b16 v[220:221], v243 offset:12288
  ds_read_b64_tr_b16 v[222:223], v243 offset:12800
  s_waitcnt lgkmcnt(8)
  v_mfma_f32_32x32x16_bf16 v[0:15], v[224:227], v[68:71], v[0:15]
  v_mfma_f32_32x32x16_bf16 v[16:31], v[228:231], v[68:71], v[16:31]
  v_mfma_f32_32x32x16_bf16 v[32:47], v[232:235], v[68:71], v[32:47]
  v_mfma_f32_32x32x16_bf16 v[48:63], v[236:239], v[68:71], v[48:63]
  s_waitcnt vmcnt(12)
  s_barrier
  s_add_u32 m0, s55, 65536
  s_nop 0
  buffer_load_dwordx4 v240, s[44:47], s53 offen lds
  s_add_u32 m0, s55, 73728
  s_nop 0
  buffer_load_dwordx4 v240, s[48:51], s53 offen lds
  s_add_u32 s53, s53, s17
  s_add_u32 m0, s55, 81920
  s_nop 0
  buffer_load_dwordx4 v240, s[44:47], s53 offen lds
  s_add_u32 m0, s55, 90112
  s_nop 0
  buffer_load_dwordx4 v240, s[48:51], s53 offen lds
  s_add_u32 s53, s53, s17
  ds_read_b64_tr_b16 v[224:225], v242 offset:6144
  ds_read_b64_tr_b16 v[226:227], v242 offset:6656
  ds_read_b64_tr_b16 v[228:229], v243 offset:6144
  ds_read_b64_tr_b16 v[230:231], v243 offset:6656
  ds_read_b64_tr_b16 v[232:233], v242 offset:14336
  ds_read_b64_tr_b16 v[234:235], v242 offset:14848
  ds_read_b64_tr_b16 v[236:237], v243 offset:14336
  ds_read_b64_tr_b16 v[238:239], v243 offset:14848
  s_waitcnt lgkmcnt(8)
  v_mfma_f32_32x32x16_bf16 v[0:15], v[208:211], v[72:75], v[0:15]
  v_mfma_f32_32x32x16_bf16 v[16:31], v[212:215], v[72:75], v[16:31]
  v_mfma_f32_32x32x16_bf16 v[32:47], v[216:219], v[72:75], v[32:47]
  v_mfma_f32_32x32x16_bf16 v[48:63], v[220:223], v[72:75], v[48:63]
  ds_read_b64_tr_b16 v[208:209], v242 offset:16384
  ds_read_b64_tr_b16 v[210:211], v242 offset:16896
  ds_read_b64_tr_b16 v[212:213], v243 offset:16384
  ds_read_b64_tr_b16 v[214:215], v243 offset:16896
  ds_read_b64_tr_b16 v[216:217], v242 offset:24576
  ds_read_b64_tr_b16 v[218:219], v242 offset:25088
  ds_read_b64_tr_b16 v[220:221], v243 offset:24576
  ds_read_b64_tr_b16 v[222:223], v243 offset:25088
  s_waitcnt lgkmcnt(8)
  v_mfma_f32_32x32x16_bf16 v[0:15], v[224:227], v[76:79], v[0:15]
  v_mfma_f32_32x32x16_bf16 v[16:31], v[228:231], v[76:79], v[16:31]
  v_mfma_f32_32x32x16_bf16 v[32:47], v[232:235], v[76:79], v[32:47]
  v_mfma_f32_32x32x16_bf16 v[48:63], v[236:239], v[76:79], v[48:63]
  ds_read_b64_tr_b16 v[224:225], v242 offset:18432
  ds_read_b64_tr_b16 v[226:227], v242 offset:18944
  ds_read_b64_tr_b16 v[228:229], v243 offset:18432
  ds_read_b64_tr_b16 v[230:231], v243 offset:18944
  ds_read_b64_tr_b16 v[232:233], v242 offset:26624
  ds_read_b64_tr_b16 v[234:235], v242 offset:27136
  ds_read_b64_tr_b16 v[236:237], v243 offset:26624
  ds_read_b64_tr_b16 v[238:239], v243 offset:27136
  s_waitcnt lgkmcnt(8)
  v_mfma_f32_32x32x16_bf16 v[0:15], v[208:211], v[80:83], v[0:15]
  v_mfma_f32_32x32x16_bf16 v[16:31], v[212:215], v[80:83], v[16:31]
  v_mfma_f32_32x32x16_bf16 v[32:47], v[216:219], v[80:83], v[32:47]
  v_mfma_f32_32x32x16_bf16 v[48:63], v[220:223], v[80:83], v[48:63]
  ds_read_b64_tr_b16 v[208:209], v242 offset:20480
  ds_read_b64_tr_b16 v[210:211], v242 offset:20992
  ds_read_b64_tr_b16 v[212:213], v243 offset:20480
  ds_read_b64_tr_b16 v[214:215], v243 offset:20992
  ds_read_b64_tr_b16 v[216:217], v242 offset:28672
  ds_read_b64_tr_b16 v[218:219], v242 offset:29184
  ds_read_b64_tr_b16 v[220:221], v243 offset:28672
  ds_read_b64_tr_b16 v[222:223], v243 offset:29184
  s_waitcnt lgkmcnt(8)
  v_mfma_f32_32x32x16_bf16 v[0:15], v[224:227], v[84:87], v[0:15]
  v_mfma_f32_32x32x16_bf16 v[16:31], v[228:231], v[84:87], v[16:31]
  v_mfma_f32_32x32x16_bf16 v[32:47], v[232:235], v[84:87], v[32:47]
  v_mfma_f32_32x32x16_bf16 v[48:63], v[236:239], v[84:87], v[48:63]
  s_waitcnt vmcnt(6)
  s_barrier
  s_add_u32 m0, s55, 98304
  s_nop 0
  buffer_load_dwordx4 v240, s[44:47], s53 offen lds
  s_add_u32 m0, s55, 106496
  s_nop 0
  buffer_load_dwordx4 v240, s[48:51], s53 offen lds
  s_add_u32 s53, s53, s17
  s_add_u32 m0, s55, 114688
  s_nop 0
  buffer_load_dwordx4 v240, s[44:47], s53 offen lds
  s_add_u32 m0, s55, 122880
  s_nop 0
  buffer_load_dwordx4 v240, s[48:51], s53 offen lds
  s_add_u32 s53, s53, s17
  ds_read_b64_tr_b16 v[224:225], v242 offset:22528
  ds_read_b64_tr_b16 v[226:227], v242 offset:23040
  ds_read_b64_tr_b16 v[228:229], v243 offset:22528
  ds_read_b64_tr_b16 v[230:231], v243 offset:23040
  ds_read_b64_tr_b16 v[232:233], v242 offset:30720
  ds_read_b64_tr_b16 v[234:235], v242 offset:31232
  ds_read_b64_tr_b16 v[236:237], v243 offset:30720
  ds_read_b64_tr_b16 v[238:239], v243 offset:31232
  s_waitcnt lgkmcnt(8)
  v_mfma_f32_32x32x16_bf16 v[0:15], v[208:211], v[88:91], v[0:15]
  v_mfma_f32_32x32x16_bf16 v[16:31], v[212:215], v[88:91], v[16:31]
  v_mfma_f32_32x32x16_bf16 v[32:47], v[216:219], v[88:91], v[32:47]
  v_mfma_f32_32x32x16_bf16 v[48:63], v[220:223], v[88:91], v[48:63]
  ds_read_b64_tr_b16 v[208:209], v242 offset:32768
  ds_read_b64_tr_b16 v[210:211], v242 offset:33280
  ds_read_b64_tr_b16 v[212:213], v243 offset:32768
  ds_read_b64_tr_b16 v[214:215], v243 offset:33280
  ds_read_b64_tr_b16 v[216:217], v242 offset:40960
  ds_read_b64_tr_b16 v[218:219], v242 offset:41472
  ds_read_b64_tr_b16 v[220:221], v243 offset:40960
  ds_read_b64_tr_b16 v[222:223], v243 offset:41472
  s_waitcnt lgkmcnt(8)
  v_mfma_f32_32x32x16_bf16 v[0:15], v[224:227], v[92:95], v[0:15]
  v_mfma_f32_32x32x16_bf16 v[16:31], v[228:231], v[92:95], v[16:31]
  v_mfma_f32_32x32x16_bf16 v[32:47], v[232:235], v[92:95], v[32:47]
  v_mfma_f32_32x32x16_bf16 v[48:63], v[236:239], v[92:95], v[48:63]
  ds_read_b64_tr_b16 v[224:225], v242 offset:34816
  ds_read_b64_tr_b16 v[226:227], v242 offset:35328
  ds_read_b64_tr_b16 v[228:229], v243 offset:34816
  ds_read_b64_tr_b16 v[230:231], v243 offset:35328
  ds_read_b64_tr_b16 v[232:233], v242 offset:43008
  ds_read_b64_tr_b16 v[234:235], v242 offset:43520
  ds_read_b64_tr_b16 v[236:237], v243 offset:43008
  ds_read_b64_tr_b16 v[238:239], v243 offset:43520
  s_waitcnt lgkmcnt(8)
  v_mfma_f32_32x32x16_bf16 v[0:15], v[208:211], v[96:99], v[0:15]
  v_mfma_f32_32x32x16_bf16 v[16:31], v[212:215], v[96:99], v[16:31]
  v_mfma_f32_32x32x16_bf16 v[32:47], v[216:219], v[96:99], v[32:47]
  v_mfma_f32_32x32x16_bf16 v[48:63], v[220:223], v[96:99], v[48:63]
  ds_read_b64_tr_b16 v[208:209], v242 offset:36864
  ds_read_b64_tr_b16 v[210:211], v242 offset:37376
  ds_read_b64_tr_b16 v[212:213], v243 offset:36864
  ds_read_b64_tr_b16 v[214:215], v243 offset:37376
  ds_read_b64_tr_b16 v[216:217], v242 offset:45056
  ds_read_b64_tr_b16 v[218:219], v242 offset:45568
  ds_read_b64_tr_b16 v[220:221], v243 offset:45056
  ds_read_b64_tr_b16 v[222:223], v243 offset:45568
  s_waitcnt lgkmcnt(8)
  v_mfma_f32_32x32x16_bf16 v[0:15], v[224:227], v[100:103], v[0:15]
  v_mfma_f32_32x32x16_bf16 v[16:31], v[228:231], v[100:103], v[16:31]
  v_mfma_f32_32x32x16_bf16 v[32:47], v[232:235], v[100:103], v[32:47]
  v_mfma_f32_32x32x16_bf16 v[48:63], v[236:239], v[100:103], v[48:63]
  s_waitcnt vmcnt(8)
  s_barrier
  s_add_u32 m0, s55, 131072
  s_nop 0
  buffer_load_dwordx4 v240, s[44:47], s53 offen lds
  s_add_u32 m0, s55, 139264
  s_nop 0
  buffer_load_dwordx4 v240, s[48:51], s53 offen lds
  s_add_u32 s53, s53, s17
  s_add_u32 s31, s31, 1
  s_cmp_lt_u32 s31, s19
  s_cselect_b32 s31, s31, s24
  s_lshl_b32 s15, s31, 6

  s_lshl_b32 s17, s16, 6
  s_lshl_b32 s59, s56, 3
  v_lshrrev_b32 v248, 3, v245
  v_add_u32 v248, s59, v248
  v_and_b32 v249, 7, v245
  v_bfe_u32 v250, v245, 4, 1
  v_lshlrev_b32 v250, 2, v250
  v_xor_b32 v249, v249, v250
  v_lshlrev_b32 v249, 4, v249
  s_lshl_b32 s59, s15, 1
  v_add_u32 v249, s59, v249
  v_mul_lo_u32 v250, v248, s16
  v_add_u32 v240, v250, v249
  s_mov_b32 s53, 0
  s_nop 4

  s_add_u32 m0, s55, 0
  s_nop 0
  buffer_load_dwordx4 v240, s[44:47], s53 offen lds
  s_add_u32 m0, s55, 8192
  s_nop 0
  buffer_load_dwordx4 v240, s[48:51], s53 offen lds
  s_add_u32 s53, s53, s17
  ds_read_b64_tr_b16 v[224:225], v242 offset:38912
  ds_read_b64_tr_b16 v[226:227], v242 offset:39424
  ds_read_b64_tr_b16 v[228:229], v243 offset:38912
  ds_read_b64_tr_b16 v[230:231], v243 offset:39424
  ds_read_b64_tr_b16 v[232:233], v242 offset:47104
  ds_read_b64_tr_b16 v[234:235], v242 offset:47616
  ds_read_b64_tr_b16 v[236:237], v243 offset:47104
  ds_read_b64_tr_b16 v[238:239], v243 offset:47616
  s_waitcnt lgkmcnt(8)
  v_mfma_f32_32x32x16_bf16 v[0:15], v[208:211], v[104:107], v[0:15]
  v_mfma_f32_32x32x16_bf16 v[16:31], v[212:215], v[104:107], v[16:31]
  v_mfma_f32_32x32x16_bf16 v[32:47], v[216:219], v[104:107], v[32:47]
  v_mfma_f32_32x32x16_bf16 v[48:63], v[220:223], v[104:107], v[48:63]
  ds_read_b64_tr_b16 v[208:209], v242 offset:49152
  ds_read_b64_tr_b16 v[210:211], v242 offset:49664
  ds_read_b64_tr_b16 v[212:213], v243 offset:49152
  ds_read_b64_tr_b16 v[214:215], v243 offset:49664
  ds_read_b64_tr_b16 v[216:217], v242 offset:57344
  ds_read_b64_tr_b16 v[218:219], v242 offset:57856
  ds_read_b64_tr_b16 v[220:221], v243 offset:57344
  ds_read_b64_tr_b16 v[222:223], v243 offset:57856
  s_waitcnt lgkmcnt(8)
  v_mfma_f32_32x32x16_bf16 v[0:15], v[224:227], v[108:111], v[0:15]
  v_mfma_f32_32x32x16_bf16 v[16:31], v[228:231], v[108:111], v[16:31]
  v_mfma_f32_32x32x16_bf16 v[32:47], v[232:235], v[108:111], v[32:47]
  v_mfma_f32_32x32x16_bf16 v[48:63], v[236:239], v[108:111], v[48:63]
  ds_read_b64_tr_b16 v[224:225], v242 offset:51200
  ds_read_b64_tr_b16 v[226:227], v242 offset:51712
  ds_read_b64_tr_b16 v[228:229], v243 offset:51200
  ds_read_b64_tr_b16 v[230:231], v243 offset:51712
  ds_read_b64_tr_b16 v[232:233], v242 offset:59392
  ds_read_b64_tr_b16 v[234:235], v242 offset:59904
  ds_read_b64_tr_b16 v[236:237], v243 offset:59392
  ds_read_b64_tr_b16 v[238:239], v243 offset:59904
  s_waitcnt lgkmcnt(8)
  v_mfma_f32_32x32x16_bf16 v[0:15], v[208:211], v[112:115], v[0:15]
  v_mfma_f32_32x32x16_bf16 v[16:31], v[212:215], v[112:115], v[16:31]
  v_mfma_f32_32x32x16_bf16 v[32:47], v[216:219], v[112:115], v[32:47]
  v_mfma_f32_32x32x16_bf16 v[48:63], v[220:223], v[112:115], v[48:63]
  ds_read_b64_tr_b16 v[208:209], v242 offset:53248
  ds_read_b64_tr_b16 v[210:211], v242 offset:53760
  ds_read_b64_tr_b16 v[212:213], v243 offset:53248
  ds_read_b64_tr_b16 v[214:215], v243 offset:53760
  ds_read_b64_tr_b16 v[216:217], v242 offset:61440
  ds_read_b64_tr_b16 v[218:219], v242 offset:61952
  ds_read_b64_tr_b16 v[220:221], v243 offset:61440
  ds_read_b64_tr_b16 v[222:223], v243 offset:61952
  s_waitcnt lgkmcnt(8)
  v_mfma_f32_32x32x16_bf16 v[0:15], v[224:227], v[116:119], v[0:15]
  v_mfma_f32_32x32x16_bf16 v[16:31], v[228:231], v[116:119], v[16:31]
  v_mfma_f32_32x32x16_bf16 v[32:47], v[232:235], v[116:119], v[32:47]
  v_mfma_f32_32x32x16_bf16 v[48:63], v[236:239], v[116:119], v[48:63]
  s_waitcnt vmcnt(10)
  s_barrier
  s_add_u32 m0, s55, 16384
  s_nop 0
  buffer_load_dwordx4 v240, s[44:47], s53 offen lds
  s_add_u32 m0, s55, 24576
  s_nop 0
  buffer_load_dwordx4 v240, s[48:51], s53 offen lds
  s_add_u32 s53, s53, s17
  s_add_u32 m0, s55, 32768
  s_nop 0
  buffer_load_dwordx4 v240, s[44:47], s53 offen lds
  s_add_u32 m0, s55, 40960
  s_nop 0
  buffer_load_dwordx4 v240, s[48:51], s53 offen lds
  s_add_u32 s53, s53, s17
  ds_read_b64_tr_b16 v[224:225], v242 offset:55296
  ds_read_b64_tr_b16 v[226:227], v242 offset:55808
  ds_read_b64_tr_b16 v[228:229], v243 offset:55296
  ds_read_b64_tr_b16 v[230:231], v243 offset:55808
  ds_read_b64_tr_b16 v[232:233], v242 offset:63488
  ds_read_b64_tr_b16 v[234:235], v242 offset:64000
  ds_read_b64_tr_b16 v[236:237], v243 offset:63488
  ds_read_b64_tr_b16 v[238:239], v243 offset:64000
  s_waitcnt lgkmcnt(8)
  v_mfma_f32_32x32x16_bf16 v[0:15], v[208:211], v[120:123], v[0:15]
  v_mfma_f32_32x32x16_bf16 v[16:31], v[212:215], v[120:123], v[16:31]
  v_mfma_f32_32x32x16_bf16 v[32:47], v[216:219], v[120:123], v[32:47]
  v_mfma_f32_32x32x16_bf16 v[48:63], v[220:223], v[120:123], v[48:63]
  ds_read_b64_tr_b16 v[208:209], v252 offset:0
  ds_read_b64_tr_b16 v[210:211], v252 offset:512
  ds_read_b64_tr_b16 v[212:213], v253 offset:0
  ds_read_b64_tr_b16 v[214:215], v253 offset:512
  ds_read_b64_tr_b16 v[216:217], v252 offset:8192
  ds_read_b64_tr_b16 v[218:219], v252 offset:8704
  ds_read_b64_tr_b16 v[220:221], v253 offset:8192
  ds_read_b64_tr_b16 v[222:223], v253 offset:8704
  s_waitcnt lgkmcnt(8)
  v_mfma_f32_32x32x16_bf16 v[0:15], v[224:227], v[124:127], v[0:15]
  v_mfma_f32_32x32x16_bf16 v[16:31], v[228:231], v[124:127], v[16:31]
  v_mfma_f32_32x32x16_bf16 v[32:47], v[232:235], v[124:127], v[32:47]
  v_mfma_f32_32x32x16_bf16 v[48:63], v[236:239], v[124:127], v[48:63]
  ds_read_b64_tr_b16 v[224:225], v252 offset:2048
  ds_read_b64_tr_b16 v[226:227], v252 offset:2560
  ds_read_b64_tr_b16 v[228:229], v253 offset:2048
  ds_read_b64_tr_b16 v[230:231], v253 offset:2560
  ds_read_b64_tr_b16 v[232:233], v252 offset:10240
  ds_read_b64_tr_b16 v[234:235], v252 offset:10752
  ds_read_b64_tr_b16 v[236:237], v253 offset:10240
  ds_read_b64_tr_b16 v[238:239], v253 offset:10752
  s_waitcnt lgkmcnt(8)
  v_mfma_f32_32x32x16_bf16 v[0:15], v[208:211], v[128:131], v[0:15]
  v_mfma_f32_32x32x16_bf16 v[16:31], v[212:215], v[128:131], v[16:31]
  v_mfma_f32_32x32x16_bf16 v[32:47], v[216:219], v[128:131], v[32:47]
  v_mfma_f32_32x32x16_bf16 v[48:63], v[220:223], v[128:131], v[48:63]
  ds_read_b64_tr_b16 v[208:209], v252 offset:4096
  ds_read_b64_tr_b16 v[210:211], v252 offset:4608
  ds_read_b64_tr_b16 v[212:213], v253 offset:4096
  ds_read_b64_tr_b16 v[214:215], v253 offset:4608
  ds_read_b64_tr_b16 v[216:217], v252 offset:12288
  ds_read_b64_tr_b16 v[218:219], v252 offset:12800
  ds_read_b64_tr_b16 v[220:221], v253 offset:12288
  ds_read_b64_tr_b16 v[222:223], v253 offset:12800
  s_waitcnt lgkmcnt(8)
  v_mfma_f32_32x32x16_bf16 v[0:15], v[224:227], v[132:135], v[0:15]
  v_mfma_f32_32x32x16_bf16 v[16:31], v[228:231], v[132:135], v[16:31]
  v_mfma_f32_32x32x16_bf16 v[32:47], v[232:235], v[132:135], v[32:47]
  v_mfma_f32_32x32x16_bf16 v[48:63], v[236:239], v[132:135], v[48:63]
  s_waitcnt vmcnt(12)
  s_barrier
  s_add_u32 m0, s55, 49152
  s_nop 0
  buffer_load_dwordx4 v240, s[44:47], s53 offen lds
  s_add_u32 m0, s55, 57344
  s_nop 0
  buffer_load_dwordx4 v240, s[48:51], s53 offen lds
  s_add_u32 s53, s53, s17
  ds_read_b64_tr_b16 v[224:225], v252 offset:6144
  ds_read_b64_tr_b16 v[226:227], v252 offset:6656
  ds_read_b64_tr_b16 v[228:229], v253 offset:6144
  ds_read_b64_tr_b16 v[230:231], v253 offset:6656
  ds_read_b64_tr_b16 v[232:233], v252 offset:14336
  ds_read_b64_tr_b16 v[234:235], v252 offset:14848
  ds_read_b64_tr_b16 v[236:237], v253 offset:14336
  ds_read_b64_tr_b16 v[238:239], v253 offset:14848
  s_waitcnt lgkmcnt(8)
  v_mfma_f32_32x32x16_bf16 v[0:15], v[208:211], v[136:139], v[0:15]
  v_mfma_f32_32x32x16_bf16 v[16:31], v[212:215], v[136:139], v[16:31]
  v_mfma_f32_32x32x16_bf16 v[32:47], v[216:219], v[136:139], v[32:47]
  v_mfma_f32_32x32x16_bf16 v[48:63], v[220:223], v[136:139], v[48:63]
  ds_read_b64_tr_b16 v[208:209], v252 offset:16384
  ds_read_b64_tr_b16 v[210:211], v252 offset:16896
  ds_read_b64_tr_b16 v[212:213], v253 offset:16384
  ds_read_b64_tr_b16 v[214:215], v253 offset:16896
  ds_read_b64_tr_b16 v[216:217], v252 offset:24576
  ds_read_b64_tr_b16 v[218:219], v252 offset:25088
  ds_read_b64_tr_b16 v[220:221], v253 offset:24576
  ds_read_b64_tr_b16 v[222:223], v253 offset:25088
  s_waitcnt lgkmcnt(8)
  v_mfma_f32_32x32x16_bf16 v[0:15], v[224:227], v[140:143], v[0:15]
  v_mfma_f32_32x32x16_bf16 v[16:31], v[228:231], v[140:143], v[16:31]
  v_mfma_f32_32x32x16_bf16 v[32:47], v[232:235], v[140:143], v[32:47]
  v_mfma_f32_32x32x16_bf16 v[48:63], v[236:239], v[140:143], v[48:63]
  ds_read_b64_tr_b16 v[224:225], v252 offset:18432
  ds_read_b64_tr_b16 v[226:227], v252 offset:18944
  ds_read_b64_tr_b16 v[228:229], v253 offset:18432
  ds_read_b64_tr_b16 v[230:231], v253 offset:18944
  ds_read_b64_tr_b16 v[232:233], v252 offset:26624
  ds_read_b64_tr_b16 v[234:235], v252 offset:27136
  ds_read_b64_tr_b16 v[236:237], v253 offset:26624
  ds_read_b64_tr_b16 v[238:239], v253 offset:27136
  s_waitcnt lgkmcnt(8)
  v_mfma_f32_32x32x16_bf16 v[0:15], v[208:211], v[144:147], v[0:15]
  v_mfma_f32_32x32x16_bf16 v[16:31], v[212:215], v[144:147], v[16:31]
  v_mfma_f32_32x32x16_bf16 v[32:47], v[216:219], v[144:147], v[32:47]
  v_mfma_f32_32x32x16_bf16 v[48:63], v[220:223], v[144:147], v[48:63]
  ds_read_b64_tr_b16 v[208:209], v252 offset:20480
  ds_read_b64_tr_b16 v[210:211], v252 offset:20992
  ds_read_b64_tr_b16 v[212:213], v253 offset:20480
  ds_read_b64_tr_b16 v[214:215], v253 offset:20992
  ds_read_b64_tr_b16 v[216:217], v252 offset:28672
  ds_read_b64_tr_b16 v[218:219], v252 offset:29184
  ds_read_b64_tr_b16 v[220:221], v253 offset:28672
  ds_read_b64_tr_b16 v[222:223], v253 offset:29184
  s_waitcnt lgkmcnt(8)
  v_mfma_f32_32x32x16_bf16 v[0:15], v[224:227], v[148:151], v[0:15]
  v_mfma_f32_32x32x16_bf16 v[16:31], v[228:231], v[148:151], v[16:31]
  v_mfma_f32_32x32x16_bf16 v[32:47], v[232:235], v[148:151], v[32:47]
  v_mfma_f32_32x32x16_bf16 v[48:63], v[236:239], v[148:151], v[48:63]
  s_waitcnt vmcnt(12)
  s_barrier
  s_add_u32 m0, s55, 65536
  s_nop 0
  buffer_load_dwordx4 v240, s[44:47], s53 offen lds
  s_add_u32 m0, s55, 73728
  s_nop 0
  buffer_load_dwordx4 v240, s[48:51], s53 offen lds
  s_add_u32 s53, s53, s17
  ds_read_b64_tr_b16 v[224:225], v252 offset:22528
  ds_read_b64_tr_b16 v[226:227], v252 offset:23040
  ds_read_b64_tr_b16 v[228:229], v253 offset:22528
  ds_read_b64_tr_b16 v[230:231], v253 offset:23040
  ds_read_b64_tr_b16 v[232:233], v252 offset:30720
  ds_read_b64_tr_b16 v[234:235], v252 offset:31232
  ds_read_b64_tr_b16 v[236:237], v253 offset:30720
  ds_read_b64_tr_b16 v[238:239], v253 offset:31232
  s_waitcnt lgkmcnt(8)
  v_mfma_f32_32x32x16_bf16 v[0:15], v[208:211], v[152:155], v[0:15]
  v_mfma_f32_32x32x16_bf16 v[16:31], v[212:215], v[152:155], v[16:31]
  v_mfma_f32_32x32x16_bf16 v[32:47], v[216:219], v[152:155], v[32:47]
  v_mfma_f32_32x32x16_bf16 v[48:63], v[220:223], v[152:155], v[48:63]
  ds_read_b64_tr_b16 v[208:209], v252 offset:32768
  ds_read_b64_tr_b16 v[210:211], v252 offset:33280
  ds_read_b64_tr_b16 v[212:213], v253 offset:32768
  ds_read_b64_tr_b16 v[214:215], v253 offset:33280
  ds_read_b64_tr_b16 v[216:217], v252 offset:40960
  ds_read_b64_tr_b16 v[218:219], v252 offset:41472
  ds_read_b64_tr_b16 v[220:221], v253 offset:40960
  ds_read_b64_tr_b16 v[222:223], v253 offset:41472
  s_waitcnt lgkmcnt(8)
  v_mfma_f32_32x32x16_bf16 v[0:15], v[224:227], v[156:159], v[0:15]
  v_mfma_f32_32x32x16_bf16 v[16:31], v[228:231], v[156:159], v[16:31]
  v_mfma_f32_32x32x16_bf16 v[32:47], v[232:235], v[156:159], v[32:47]
  v_mfma_f32_32x32x16_bf16 v[48:63], v[236:239], v[156:159], v[48:63]
  ds_read_b64_tr_b16 v[224:225], v252 offset:34816
  ds_read_b64_tr_b16 v[226:227], v252 offset:35328
  ds_read_b64_tr_b16 v[228:229], v253 offset:34816
  ds_read_b64_tr_b16 v[230:231], v253 offset:35328
  ds_read_b64_tr_b16 v[232:233], v252 offset:43008
  ds_read_b64_tr_b16 v[234:235], v252 offset:43520
  ds_read_b64_tr_b16 v[236:237], v253 offset:43008
  ds_read_b64_tr_b16 v[238:239], v253 offset:43520
  s_waitcnt lgkmcnt(8)
  v_mfma_f32_32x32x16_bf16 v[0:15], v[208:211], v[160:163], v[0:15]
  v_mfma_f32_32x32x16_bf16 v[16:31], v[212:215], v[160:163], v[16:31]
  v_mfma_f32_32x32x16_bf16 v[32:47], v[216:219], v[160:163], v[32:47]
  v_mfma_f32_32x32x16_bf16 v[48:63], v[220:223], v[160:163], v[48:63]
  ds_read_b64_tr_b16 v[208:209], v252 offset:36864
  ds_read_b64_tr_b16 v[210:211], v252 offset:37376
  ds_read_b64_tr_b16 v[212:213], v253 offset:36864
  ds_read_b64_tr_b16 v[214:215], v253 offset:37376
  ds_read_b64_tr_b16 v[216:217], v252 offset:45056
  ds_read_b64_tr_b16 v[218:219], v252 offset:45568
  ds_read_b64_tr_b16 v[220:221], v253 offset:45056
  ds_read_b64_tr_b16 v[222:223], v253 offset:45568
  s_waitcnt lgkmcnt(8)
  v_mfma_f32_32x32x16_bf16 v[0:15], v[224:227], v[164:167], v[0:15]
  v_mfma_f32_32x32x16_bf16 v[16:31], v[228:231], v[164:167], v[16:31]
  v_mfma_f32_32x32x16_bf16 v[32:47], v[232:235], v[164:167], v[32:47]
  v_mfma_f32_32x32x16_bf16 v[48:63], v[236:239], v[164:167], v[48:63]
  s_waitcnt vmcnt(12)
  s_barrier
  s_add_u32 m0, s55, 81920
  s_nop 0
  buffer_load_dwordx4 v240, s[44:47], s53 offen lds
  s_add_u32 m0, s55, 90112
  s_nop 0
  buffer_load_dwordx4 v240, s[48:51], s53 offen lds
  s_add_u32 s53, s53, s17
  ds_read_b64_tr_b16 v[224:225], v252 offset:38912
  ds_read_b64_tr_b16 v[226:227], v252 offset:39424
  ds_read_b64_tr_b16 v[228:229], v253 offset:38912
  ds_read_b64_tr_b16 v[230:231], v253 offset:39424
  ds_read_b64_tr_b16 v[232:233], v252 offset:47104
  ds_read_b64_tr_b16 v[234:235], v252 offset:47616
  ds_read_b64_tr_b16 v[236:237], v253 offset:47104
  ds_read_b64_tr_b16 v[238:239], v253 offset:47616
  s_waitcnt lgkmcnt(8)
  v_mfma_f32_32x32x16_bf16 v[0:15], v[208:211], v[168:171], v[0:15]
  v_mfma_f32_32x32x16_bf16 v[16:31], v[212:215], v[168:171], v[16:31]
  v_mfma_f32_32x32x16_bf16 v[32:47], v[216:219], v[168:171], v[32:47]
  v_mfma_f32_32x32x16_bf16 v[48:63], v[220:223], v[168:171], v[48:63]
  ds_read_b64_tr_b16 v[208:209], v252 offset:49152
  ds_read_b64_tr_b16 v[210:211], v252 offset:49664
  ds_read_b64_tr_b16 v[212:213], v253 offset:49152
  ds_read_b64_tr_b16 v[214:215], v253 offset:49664
  ds_read_b64_tr_b16 v[216:217], v252 offset:57344
  ds_read_b64_tr_b16 v[218:219], v252 offset:57856
  ds_read_b64_tr_b16 v[220:221], v253 offset:57344
  ds_read_b64_tr_b16 v[222:223], v253 offset:57856
  s_waitcnt lgkmcnt(8)
  v_mfma_f32_32x32x16_bf16 v[0:15], v[224:227], v[172:175], v[0:15]
  v_mfma_f32_32x32x16_bf16 v[16:31], v[228:231], v[172:175], v[16:31]
  v_mfma_f32_32x32x16_bf16 v[32:47], v[232:235], v[172:175], v[32:47]
  v_mfma_f32_32x32x16_bf16 v[48:63], v[236:239], v[172:175], v[48:63]
  ds_read_b64_tr_b16 v[224:225], v252 offset:51200
  ds_read_b64_tr_b16 v[226:227], v252 offset:51712
  ds_read_b64_tr_b16 v[228:229], v253 offset:51200
  ds_read_b64_tr_b16 v[230:231], v253 offset:51712
  ds_read_b64_tr_b16 v[232:233], v252 offset:59392
  ds_read_b64_tr_b16 v[234:235], v252 offset:59904
  ds_read_b64_tr_b16 v[236:237], v253 offset:59392
  ds_read_b64_tr_b16 v[238:239], v253 offset:59904
  s_waitcnt lgkmcnt(8)
  v_mfma_f32_32x32x16_bf16 v[0:15], v[208:211], v[176:179], v[0:15]
  v_mfma_f32_32x32x16_bf16 v[16:31], v[212:215], v[176:179], v[16:31]
  v_mfma_f32_32x32x16_bf16 v[32:47], v[216:219], v[176:179], v[32:47]
  v_mfma_f32_32x32x16_bf16 v[48:63], v[220:223], v[176:179], v[48:63]
  ds_read_b64_tr_b16 v[208:209], v252 offset:53248
  ds_read_b64_tr_b16 v[210:211], v252 offset:53760
  ds_read_b64_tr_b16 v[212:213], v253 offset:53248
  ds_read_b64_tr_b16 v[214:215], v253 offset:53760
  ds_read_b64_tr_b16 v[216:217], v252 offset:61440
  ds_read_b64_tr_b16 v[218:219], v252 offset:61952
  ds_read_b64_tr_b16 v[220:221], v253 offset:61440
  ds_read_b64_tr_b16 v[222:223], v253 offset:61952
  s_waitcnt lgkmcnt(8)
  v_mfma_f32_32x32x16_bf16 v[0:15], v[224:227], v[180:183], v[0:15]
  v_mfma_f32_32x32x16_bf16 v[16:31], v[228:231], v[180:183], v[16:31]
  v_mfma_f32_32x32x16_bf16 v[32:47], v[232:235], v[180:183], v[32:47]
  v_mfma_f32_32x32x16_bf16 v[48:63], v[236:239], v[180:183], v[48:63]
  s_waitcnt vmcnt(12)
  s_barrier
  s_add_u32 m0, s55, 98304
  s_nop 0
  buffer_load_dwordx4 v240, s[44:47], s53 offen lds
  s_add_u32 m0, s55, 106496
  s_nop 0
  buffer_load_dwordx4 v240, s[48:51], s53 offen lds
  s_add_u32 s53, s53, s17
  ds_read_b64_tr_b16 v[224:225], v252 offset:55296
  ds_read_b64_tr_b16 v[226:227], v252 offset:55808
  ds_read_b64_tr_b16 v[228:229], v253 offset:55296
  ds_read_b64_tr_b16 v[230:231], v253 offset:55808
  ds_read_b64_tr_b16 v[232:233], v252 offset:63488
  ds_read_b64_tr_b16 v[234:235], v252 offset:64000
  ds_read_b64_tr_b16 v[236:237], v253 offset:63488
  ds_read_b64_tr_b16 v[238:239], v253 offset:64000
  s_waitcnt lgkmcnt(8)
  v_mfma_f32_32x32x16_bf16 v[0:15], v[208:211], v[184:187], v[0:15]
  v_mfma_f32_32x32x16_bf16 v[16:31], v[212:215], v[184:187], v[16:31]
  v_mfma_f32_32x32x16_bf16 v[32:47], v[216:219], v[184:187], v[32:47]
  v_mfma_f32_32x32x16_bf16 v[48:63], v[220:223], v[184:187], v[48:63]
  ds_read_b64_tr_b16 v[208:209], v254 offset:0
  ds_read_b64_tr_b16 v[210:211], v254 offset:512
  ds_read_b64_tr_b16 v[212:213], v255 offset:0
  ds_read_b64_tr_b16 v[214:215], v255 offset:512
  ds_read_b64_tr_b16 v[216:217], v254 offset:8192
  ds_read_b64_tr_b16 v[218:219], v254 offset:8704
  ds_read_b64_tr_b16 v[220:221], v255 offset:8192
  ds_read_b64_tr_b16 v[222:223], v255 offset:8704
  s_waitcnt lgkmcnt(8)
  v_mfma_f32_32x32x16_bf16 v[0:15], v[224:227], v[188:191], v[0:15]
  v_mfma_f32_32x32x16_bf16 v[16:31], v[228:231], v[188:191], v[16:31]
  v_mfma_f32_32x32x16_bf16 v[32:47], v[232:235], v[188:191], v[32:47]
  v_mfma_f32_32x32x16_bf16 v[48:63], v[236:239], v[188:191], v[48:63]
  ds_read_b64_tr_b16 v[224:225], v254 offset:2048
  ds_read_b64_tr_b16 v[226:227], v254 offset:2560
  ds_read_b64_tr_b16 v[228:229], v255 offset:2048
  ds_read_b64_tr_b16 v[230:231], v255 offset:2560
  ds_read_b64_tr_b16 v[232:233], v254 offset:10240
  ds_read_b64_tr_b16 v[234:235], v254 offset:10752
  ds_read_b64_tr_b16 v[236:237], v255 offset:10240
  ds_read_b64_tr_b16 v[238:239], v255 offset:10752
  s_waitcnt lgkmcnt(8)
  v_mfma_f32_32x32x16_bf16 v[0:15], v[208:211], v[192:195], v[0:15]
  v_mfma_f32_32x32x16_bf16 v[16:31], v[212:215], v[192:195], v[16:31]
  v_mfma_f32_32x32x16_bf16 v[32:47], v[216:219], v[192:195], v[32:47]
  v_mfma_f32_32x32x16_bf16 v[48:63], v[220:223], v[192:195], v[48:63]
  ds_read_b64_tr_b16 v[208:209], v254 offset:4096
  ds_read_b64_tr_b16 v[210:211], v254 offset:4608
  ds_read_b64_tr_b16 v[212:213], v255 offset:4096
  ds_read_b64_tr_b16 v[214:215], v255 offset:4608
  ds_read_b64_tr_b16 v[216:217], v254 offset:12288
  ds_read_b64_tr_b16 v[218:219], v254 offset:12800
  ds_read_b64_tr_b16 v[220:221], v255 offset:12288
  ds_read_b64_tr_b16 v[222:223], v255 offset:12800
  s_waitcnt lgkmcnt(8)
  v_mfma_f32_32x32x16_bf16 v[0:15], v[224:227], v[196:199], v[0:15]
  v_mfma_f32_32x32x16_bf16 v[16:31], v[228:231], v[196:199], v[16:31]
  v_mfma_f32_32x32x16_bf16 v[32:47], v[232:235], v[196:199], v[32:47]
  v_mfma_f32_32x32x16_bf16 v[48:63], v[236:239], v[196:199], v[48:63]
  ds_read_b64_tr_b16 v[224:225], v254 offset:6144
  ds_read_b64_tr_b16 v[226:227], v254 offset:6656
  ds_read_b64_tr_b16 v[228:229], v255 offset:6144
  ds_read_b64_tr_b16 v[230:231], v255 offset:6656
  ds_read_b64_tr_b16 v[232:233], v254 offset:14336
  ds_read_b64_tr_b16 v[234:235], v254 offset:14848
  ds_read_b64_tr_b16 v[236:237], v255 offset:14336
  ds_read_b64_tr_b16 v[238:239], v255 offset:14848
  s_waitcnt lgkmcnt(8)
  v_mfma_f32_32x32x16_bf16 v[0:15], v[208:211], v[200:203], v[0:15]
  v_mfma_f32_32x32x16_bf16 v[16:31], v[212:215], v[200:203], v[16:31]
  v_mfma_f32_32x32x16_bf16 v[32:47], v[216:219], v[200:203], v[32:47]
  v_mfma_f32_32x32x16_bf16 v[48:63], v[220:223], v[200:203], v[48:63]
  s_waitcnt lgkmcnt(0)
  v_mfma_f32_32x32x16_bf16 v[0:15], v[224:227], v[204:207], v[0:15]
  v_mfma_f32_32x32x16_bf16 v[16:31], v[228:231], v[204:207], v[16:31]
  v_mfma_f32_32x32x16_bf16 v[32:47], v[232:235], v[204:207], v[32:47]
  v_mfma_f32_32x32x16_bf16 v[48:63], v[236:239], v[204:207], v[48:63]
  s_barrier
  s_nop 15
  s_lshr_b32 s59, s12, 5
  s_add_u32 s59, s59, s56
  s_mul_i32 s59, s59, 331776
  s_lshl_b32 s18, s13, 12
  s_add_u32 s59, s59, s18
  s_add_u32 s59, s59, 16777216
  v_lshl_add_u32 v251, v246, 4, s59
  v_lshl_add_u32 v251, v247, 3, v251
  s_mov_b32 s20, 0xbfb8aa3b
  s_mov_b32 s21, s20
  s_mov_b32 s26, 1.0
  s_mov_b32 s27, 1.0

  v_pk_mul_f32 v[208:209], v[0:1], s[20:21]
  v_pk_mul_f32 v[210:211], v[2:3], s[20:21]
  v_exp_f32 v208, v208
  v_exp_f32 v209, v209
  v_exp_f32 v210, v210
  v_exp_f32 v211, v211
  v_pk_mul_f32 v[212:213], v[0:1], v[32:33]
  v_pk_mul_f32 v[214:215], v[2:3], v[34:35]
  v_pk_add_f32 v[208:209], v[208:209], s[26:27]
  v_pk_add_f32 v[210:211], v[210:211], s[26:27]
  v_rcp_f32 v208, v208
  v_rcp_f32 v209, v209
  v_rcp_f32 v210, v210
  v_rcp_f32 v211, v211
  s_nop 0
  v_pk_mul_f32 v[212:213], v[212:213], v[208:209]
  v_pk_mul_f32 v[214:215], v[214:215], v[210:211]
  v_cvt_pk_bf16_f32 v216, v212, v213
  v_cvt_pk_bf16_f32 v217, v214, v215
  buffer_store_dwordx2 v[216:217], v251, s[60:63], 0 offen offset:0
  v_pk_mul_f32 v[218:219], v[4:5], s[20:21]
  v_pk_mul_f32 v[220:221], v[6:7], s[20:21]
  v_exp_f32 v218, v218
  v_exp_f32 v219, v219
  v_exp_f32 v220, v220
  v_exp_f32 v221, v221
  v_pk_mul_f32 v[222:223], v[4:5], v[36:37]
  v_pk_mul_f32 v[224:225], v[6:7], v[38:39]
  v_pk_add_f32 v[218:219], v[218:219], s[26:27]
  v_pk_add_f32 v[220:221], v[220:221], s[26:27]
  v_rcp_f32 v218, v218
  v_rcp_f32 v219, v219
  v_rcp_f32 v220, v220
  v_rcp_f32 v221, v221
  s_nop 0
  v_pk_mul_f32 v[222:223], v[222:223], v[218:219]
  v_pk_mul_f32 v[224:225], v[224:225], v[220:221]
  v_cvt_pk_bf16_f32 v226, v222, v223
  v_cvt_pk_bf16_f32 v227, v224, v225
  buffer_store_dwordx2 v[226:227], v251, s[60:63], 0 offen offset:512
  v_pk_mul_f32 v[228:229], v[8:9], s[20:21]
  v_pk_mul_f32 v[230:231], v[10:11], s[20:21]
  v_exp_f32 v228, v228
  v_exp_f32 v229, v229
  v_exp_f32 v230, v230
  v_exp_f32 v231, v231
  v_pk_mul_f32 v[232:233], v[8:9], v[40:41]
  v_pk_mul_f32 v[234:235], v[10:11], v[42:43]
  v_pk_add_f32 v[228:229], v[228:229], s[26:27]
  v_pk_add_f32 v[230:231], v[230:231], s[26:27]
  v_rcp_f32 v228, v228
  v_rcp_f32 v229, v229
  v_rcp_f32 v230, v230
  v_rcp_f32 v231, v231
  s_nop 0
  v_pk_mul_f32 v[232:233], v[232:233], v[228:229]
  v_pk_mul_f32 v[234:235], v[234:235], v[230:231]
  v_cvt_pk_bf16_f32 v236, v232, v233
  v_cvt_pk_bf16_f32 v237, v234, v235
  buffer_store_dwordx2 v[236:237], v251, s[60:63], 0 offen offset:1024
  v_pk_mul_f32 v[208:209], v[12:13], s[20:21]
  v_pk_mul_f32 v[210:211], v[14:15], s[20:21]
  v_exp_f32 v208, v208
  v_exp_f32 v209, v209
  v_exp_f32 v210, v210
  v_exp_f32 v211, v211
  v_pk_mul_f32 v[212:213], v[12:13], v[44:45]
  v_pk_mul_f32 v[214:215], v[14:15], v[46:47]
  v_pk_add_f32 v[208:209], v[208:209], s[26:27]
  v_pk_add_f32 v[210:211], v[210:211], s[26:27]
  v_rcp_f32 v208, v208
  v_rcp_f32 v209, v209
  v_rcp_f32 v210, v210
  v_rcp_f32 v211, v211
  s_nop 0
  v_pk_mul_f32 v[212:213], v[212:213], v[208:209]
  v_pk_mul_f32 v[214:215], v[214:215], v[210:211]
  v_cvt_pk_bf16_f32 v216, v212, v213
  v_cvt_pk_bf16_f32 v217, v214, v215
  buffer_store_dwordx2 v[216:217], v251, s[60:63], 0 offen offset:1536
  v_pk_mul_f32 v[218:219], v[16:17], s[20:21]
  v_pk_mul_f32 v[220:221], v[18:19], s[20:21]
  v_exp_f32 v218, v218
  v_exp_f32 v219, v219
  v_exp_f32 v220, v220
  v_exp_f32 v221, v221
  v_pk_mul_f32 v[222:223], v[16:17], v[48:49]
  v_pk_mul_f32 v[224:225], v[18:19], v[50:51]
  v_pk_add_f32 v[218:219], v[218:219], s[26:27]
  v_pk_add_f32 v[220:221], v[220:221], s[26:27]
  v_rcp_f32 v218, v218
  v_rcp_f32 v219, v219
  v_rcp_f32 v220, v220
  v_rcp_f32 v221, v221
  s_nop 0
  v_pk_mul_f32 v[222:223], v[222:223], v[218:219]
  v_pk_mul_f32 v[224:225], v[224:225], v[220:221]
  v_cvt_pk_bf16_f32 v226, v222, v223
  v_cvt_pk_bf16_f32 v227, v224, v225
  buffer_store_dwordx2 v[226:227], v251, s[60:63], 0 offen offset:2048
  v_pk_mul_f32 v[228:229], v[20:21], s[20:21]
  v_pk_mul_f32 v[230:231], v[22:23], s[20:21]
  v_exp_f32 v228, v228
  v_exp_f32 v229, v229
  v_exp_f32 v230, v230
  v_exp_f32 v231, v231
  v_pk_mul_f32 v[232:233], v[20:21], v[52:53]
  v_pk_mul_f32 v[234:235], v[22:23], v[54:55]
  v_pk_add_f32 v[228:229], v[228:229], s[26:27]
  v_pk_add_f32 v[230:231], v[230:231], s[26:27]
  v_rcp_f32 v228, v228
  v_rcp_f32 v229, v229
  v_rcp_f32 v230, v230
  v_rcp_f32 v231, v231
  s_nop 0
  v_pk_mul_f32 v[232:233], v[232:233], v[228:229]
  v_pk_mul_f32 v[234:235], v[234:235], v[230:231]
  v_cvt_pk_bf16_f32 v236, v232, v233
  v_cvt_pk_bf16_f32 v237, v234, v235
  buffer_store_dwordx2 v[236:237], v251, s[60:63], 0 offen offset:2560
  v_pk_mul_f32 v[208:209], v[24:25], s[20:21]
  v_pk_mul_f32 v[210:211], v[26:27], s[20:21]
  v_exp_f32 v208, v208
  v_exp_f32 v209, v209
  v_exp_f32 v210, v210
  v_exp_f32 v211, v211
  v_pk_mul_f32 v[212:213], v[24:25], v[56:57]
  v_pk_mul_f32 v[214:215], v[26:27], v[58:59]
  v_pk_add_f32 v[208:209], v[208:209], s[26:27]
  v_pk_add_f32 v[210:211], v[210:211], s[26:27]
  v_rcp_f32 v208, v208
  v_rcp_f32 v209, v209
  v_rcp_f32 v210, v210
  v_rcp_f32 v211, v211
  s_nop 0
  v_pk_mul_f32 v[212:213], v[212:213], v[208:209]
  v_pk_mul_f32 v[214:215], v[214:215], v[210:211]
  v_cvt_pk_bf16_f32 v216, v212, v213
  v_cvt_pk_bf16_f32 v217, v214, v215
  buffer_store_dwordx2 v[216:217], v251, s[60:63], 0 offen offset:3072
  v_pk_mul_f32 v[218:219], v[28:29], s[20:21]
  v_pk_mul_f32 v[220:221], v[30:31], s[20:21]
  v_exp_f32 v218, v218
  v_exp_f32 v219, v219
  v_exp_f32 v220, v220
  v_exp_f32 v221, v221
  v_pk_mul_f32 v[222:223], v[28:29], v[60:61]
  v_pk_mul_f32 v[224:225], v[30:31], v[62:63]
  v_pk_add_f32 v[218:219], v[218:219], s[26:27]
  v_pk_add_f32 v[220:221], v[220:221], s[26:27]
  v_rcp_f32 v218, v218
  v_rcp_f32 v219, v219
  v_rcp_f32 v220, v220
  v_rcp_f32 v221, v221
  s_nop 0
  v_pk_mul_f32 v[222:223], v[222:223], v[218:219]
  v_pk_mul_f32 v[224:225], v[224:225], v[220:221]
  v_cvt_pk_bf16_f32 v226, v222, v223
  v_cvt_pk_bf16_f32 v227, v224, v225
  buffer_store_dwordx2 v[226:227], v251, s[60:63], 0 offen offset:3584
  s_add_u32 s13, s13, 1
  s_cmp_lt_u32 s13, s19
  s_cselect_b32 s13, s13, s24
  s_waitcnt vmcnt(20)
  s_barrier
  s_add_u32 m0, s55, 114688
  s_nop 0
  buffer_load_dwordx4 v240, s[44:47], s53 offen lds
  s_add_u32 m0, s55, 122880
  s_nop 0
  buffer_load_dwordx4 v240, s[48:51], s53 offen lds
  s_add_u32 s53, s53, s17
  ds_read_b64_tr_b16 v[208:209], v242 offset:0
  ds_read_b64_tr_b16 v[210:211], v242 offset:512
  ds_read_b64_tr_b16 v[212:213], v243 offset:0
  ds_read_b64_tr_b16 v[214:215], v243 offset:512
  ds_read_b64_tr_b16 v[216:217], v242 offset:8192
  ds_read_b64_tr_b16 v[218:219], v242 offset:8704
  ds_read_b64_tr_b16 v[220:221], v243 offset:8192
  ds_read_b64_tr_b16 v[222:223], v243 offset:8704
  ds_read_b64_tr_b16 v[224:225], v242 offset:2048
  ds_read_b64_tr_b16 v[226:227], v242 offset:2560
  ds_read_b64_tr_b16 v[228:229], v243 offset:2048
  ds_read_b64_tr_b16 v[230:231], v243 offset:2560
  ds_read_b64_tr_b16 v[232:233], v242 offset:10240
  ds_read_b64_tr_b16 v[234:235], v242 offset:10752
  ds_read_b64_tr_b16 v[236:237], v243 offset:10240
  ds_read_b64_tr_b16 v[238:239], v243 offset:10752
  s_waitcnt lgkmcnt(8)
  v_mfma_f32_32x32x16_bf16 v[0:15], v[208:211], v[64:67], 0
  v_mfma_f32_32x32x16_bf16 v[16:31], v[212:215], v[64:67], 0
  v_mfma_f32_32x32x16_bf16 v[32:47], v[216:219], v[64:67], 0
  v_mfma_f32_32x32x16_bf16 v[48:63], v[220:223], v[64:67], 0
  ds_read_b64_tr_b16 v[208:209], v242 offset:4096
  ds_read_b64_tr_b16 v[210:211], v242 offset:4608
  ds_read_b64_tr_b16 v[212:213], v243 offset:4096
  ds_read_b64_tr_b16 v[214:215], v243 offset:4608
  ds_read_b64_tr_b16 v[216:217], v242 offset:12288
  ds_read_b64_tr_b16 v[218:219], v242 offset:12800
  ds_read_b64_tr_b16 v[220:221], v243 offset:12288
  ds_read_b64_tr_b16 v[222:223], v243 offset:12800
  s_waitcnt lgkmcnt(8)
  v_mfma_f32_32x32x16_bf16 v[0:15], v[224:227], v[68:71], v[0:15]
  v_mfma_f32_32x32x16_bf16 v[16:31], v[228:231], v[68:71], v[16:31]
  v_mfma_f32_32x32x16_bf16 v[32:47], v[232:235], v[68:71], v[32:47]
  v_mfma_f32_32x32x16_bf16 v[48:63], v[236:239], v[68:71], v[48:63]
  s_waitcnt vmcnt(20)
  s_barrier
  s_add_u32 m0, s55, 131072
  s_nop 0
  buffer_load_dwordx4 v240, s[44:47], s53 offen lds
  s_add_u32 m0, s55, 139264
  s_nop 0
  buffer_load_dwordx4 v240, s[48:51], s53 offen lds
  s_add_u32 s53, s53, s17
  ds_read_b64_tr_b16 v[224:225], v242 offset:6144
  ds_read_b64_tr_b16 v[226:227], v242 offset:6656
  ds_read_b64_tr_b16 v[228:229], v243 offset:6144
  ds_read_b64_tr_b16 v[230:231], v243 offset:6656
  ds_read_b64_tr_b16 v[232:233], v242 offset:14336
  ds_read_b64_tr_b16 v[234:235], v242 offset:14848
  ds_read_b64_tr_b16 v[236:237], v243 offset:14336
  ds_read_b64_tr_b16 v[238:239], v243 offset:14848
  s_waitcnt lgkmcnt(8)
  v_mfma_f32_32x32x16_bf16 v[0:15], v[208:211], v[72:75], v[0:15]
  v_mfma_f32_32x32x16_bf16 v[16:31], v[212:215], v[72:75], v[16:31]
  v_mfma_f32_32x32x16_bf16 v[32:47], v[216:219], v[72:75], v[32:47]
  v_mfma_f32_32x32x16_bf16 v[48:63], v[220:223], v[72:75], v[48:63]
  ds_read_b64_tr_b16 v[208:209], v242 offset:16384
  ds_read_b64_tr_b16 v[210:211], v242 offset:16896
  ds_read_b64_tr_b16 v[212:213], v243 offset:16384
  ds_read_b64_tr_b16 v[214:215], v243 offset:16896
  ds_read_b64_tr_b16 v[216:217], v242 offset:24576
  ds_read_b64_tr_b16 v[218:219], v242 offset:25088
  ds_read_b64_tr_b16 v[220:221], v243 offset:24576
  ds_read_b64_tr_b16 v[222:223], v243 offset:25088
  s_waitcnt lgkmcnt(8)
  v_mfma_f32_32x32x16_bf16 v[0:15], v[224:227], v[76:79], v[0:15]
  v_mfma_f32_32x32x16_bf16 v[16:31], v[228:231], v[76:79], v[16:31]
  v_mfma_f32_32x32x16_bf16 v[32:47], v[232:235], v[76:79], v[32:47]
  v_mfma_f32_32x32x16_bf16 v[48:63], v[236:239], v[76:79], v[48:63]
  ds_read_b64_tr_b16 v[224:225], v242 offset:18432
  ds_read_b64_tr_b16 v[226:227], v242 offset:18944
  ds_read_b64_tr_b16 v[228:229], v243 offset:18432
  ds_read_b64_tr_b16 v[230:231], v243 offset:18944
  ds_read_b64_tr_b16 v[232:233], v242 offset:26624
  ds_read_b64_tr_b16 v[234:235], v242 offset:27136
  ds_read_b64_tr_b16 v[236:237], v243 offset:26624
  ds_read_b64_tr_b16 v[238:239], v243 offset:27136
  s_waitcnt lgkmcnt(8)
  v_mfma_f32_32x32x16_bf16 v[0:15], v[208:211], v[80:83], v[0:15]
  v_mfma_f32_32x32x16_bf16 v[16:31], v[212:215], v[80:83], v[16:31]
  v_mfma_f32_32x32x16_bf16 v[32:47], v[216:219], v[80:83], v[32:47]
  v_mfma_f32_32x32x16_bf16 v[48:63], v[220:223], v[80:83], v[48:63]
  ds_read_b64_tr_b16 v[208:209], v242 offset:20480
  ds_read_b64_tr_b16 v[210:211], v242 offset:20992
  ds_read_b64_tr_b16 v[212:213], v243 offset:20480
  ds_read_b64_tr_b16 v[214:215], v243 offset:20992
  ds_read_b64_tr_b16 v[216:217], v242 offset:28672
  ds_read_b64_tr_b16 v[218:219], v242 offset:29184
  ds_read_b64_tr_b16 v[220:221], v243 offset:28672
  ds_read_b64_tr_b16 v[222:223], v243 offset:29184
  s_waitcnt lgkmcnt(8)
  v_mfma_f32_32x32x16_bf16 v[0:15], v[224:227], v[84:87], v[0:15]
  v_mfma_f32_32x32x16_bf16 v[16:31], v[228:231], v[84:87], v[16:31]
  v_mfma_f32_32x32x16_bf16 v[32:47], v[232:235], v[84:87], v[32:47]
  v_mfma_f32_32x32x16_bf16 v[48:63], v[236:239], v[84:87], v[48:63]
  s_waitcnt vmcnt(20)
  s_barrier
  ds_read_b64_tr_b16 v[224:225], v242 offset:22528
  ds_read_b64_tr_b16 v[226:227], v242 offset:23040
  ds_read_b64_tr_b16 v[228:229], v243 offset:22528
  ds_read_b64_tr_b16 v[230:231], v243 offset:23040
  ds_read_b64_tr_b16 v[232:233], v242 offset:30720
  ds_read_b64_tr_b16 v[234:235], v242 offset:31232
  ds_read_b64_tr_b16 v[236:237], v243 offset:30720
  ds_read_b64_tr_b16 v[238:239], v243 offset:31232
  s_waitcnt lgkmcnt(8)
  v_mfma_f32_32x32x16_bf16 v[0:15], v[208:211], v[88:91], v[0:15]
  v_mfma_f32_32x32x16_bf16 v[16:31], v[212:215], v[88:91], v[16:31]
  v_mfma_f32_32x32x16_bf16 v[32:47], v[216:219], v[88:91], v[32:47]
  v_mfma_f32_32x32x16_bf16 v[48:63], v[220:223], v[88:91], v[48:63]
  ds_read_b64_tr_b16 v[208:209], v242 offset:32768
  ds_read_b64_tr_b16 v[210:211], v242 offset:33280
  ds_read_b64_tr_b16 v[212:213], v243 offset:32768
  ds_read_b64_tr_b16 v[214:215], v243 offset:33280
  ds_read_b64_tr_b16 v[216:217], v242 offset:40960
  ds_read_b64_tr_b16 v[218:219], v242 offset:41472
  ds_read_b64_tr_b16 v[220:221], v243 offset:40960
  ds_read_b64_tr_b16 v[222:223], v243 offset:41472
  s_waitcnt lgkmcnt(8)
  v_mfma_f32_32x32x16_bf16 v[0:15], v[224:227], v[92:95], v[0:15]
  v_mfma_f32_32x32x16_bf16 v[16:31], v[228:231], v[92:95], v[16:31]
  v_mfma_f32_32x32x16_bf16 v[32:47], v[232:235], v[92:95], v[32:47]
  v_mfma_f32_32x32x16_bf16 v[48:63], v[236:239], v[92:95], v[48:63]
  ds_read_b64_tr_b16 v[224:225], v242 offset:34816
  ds_read_b64_tr_b16 v[226:227], v242 offset:35328
  ds_read_b64_tr_b16 v[228:229], v243 offset:34816
  ds_read_b64_tr_b16 v[230:231], v243 offset:35328
  ds_read_b64_tr_b16 v[232:233], v242 offset:43008
  ds_read_b64_tr_b16 v[234:235], v242 offset:43520
  ds_read_b64_tr_b16 v[236:237], v243 offset:43008
  ds_read_b64_tr_b16 v[238:239], v243 offset:43520
  s_waitcnt lgkmcnt(8)
  v_mfma_f32_32x32x16_bf16 v[0:15], v[208:211], v[96:99], v[0:15]
  v_mfma_f32_32x32x16_bf16 v[16:31], v[212:215], v[96:99], v[16:31]
  v_mfma_f32_32x32x16_bf16 v[32:47], v[216:219], v[96:99], v[32:47]
  v_mfma_f32_32x32x16_bf16 v[48:63], v[220:223], v[96:99], v[48:63]
  ds_read_b64_tr_b16 v[208:209], v242 offset:36864
  ds_read_b64_tr_b16 v[210:211], v242 offset:37376
  ds_read_b64_tr_b16 v[212:213], v243 offset:36864
  ds_read_b64_tr_b16 v[214:215], v243 offset:37376
  ds_read_b64_tr_b16 v[216:217], v242 offset:45056
  ds_read_b64_tr_b16 v[218:219], v242 offset:45568
  ds_read_b64_tr_b16 v[220:221], v243 offset:45056
  ds_read_b64_tr_b16 v[222:223], v243 offset:45568
  s_waitcnt lgkmcnt(8)
  v_mfma_f32_32x32x16_bf16 v[0:15], v[224:227], v[100:103], v[0:15]
  v_mfma_f32_32x32x16_bf16 v[16:31], v[228:231], v[100:103], v[16:31]
  v_mfma_f32_32x32x16_bf16 v[32:47], v[232:235], v[100:103], v[32:47]
  v_mfma_f32_32x32x16_bf16 v[48:63], v[236:239], v[100:103], v[48:63]
  s_waitcnt vmcnt(18)
  s_barrier
  ds_read_b64_tr_b16 v[224:225], v242 offset:38912
  ds_read_b64_tr_b16 v[226:227], v242 offset:39424
  ds_read_b64_tr_b16 v[228:229], v243 offset:38912
  ds_read_b64_tr_b16 v[230:231], v243 offset:39424
  ds_read_b64_tr_b16 v[232:233], v242 offset:47104
  ds_read_b64_tr_b16 v[234:235], v242 offset:47616
  ds_read_b64_tr_b16 v[236:237], v243 offset:47104
  ds_read_b64_tr_b16 v[238:239], v243 offset:47616
  s_waitcnt lgkmcnt(8)
  v_mfma_f32_32x32x16_bf16 v[0:15], v[208:211], v[104:107], v[0:15]
  v_mfma_f32_32x32x16_bf16 v[16:31], v[212:215], v[104:107], v[16:31]
  v_mfma_f32_32x32x16_bf16 v[32:47], v[216:219], v[104:107], v[32:47]
  v_mfma_f32_32x32x16_bf16 v[48:63], v[220:223], v[104:107], v[48:63]
  ds_read_b64_tr_b16 v[208:209], v242 offset:49152
  ds_read_b64_tr_b16 v[210:211], v242 offset:49664
  ds_read_b64_tr_b16 v[212:213], v243 offset:49152
  ds_read_b64_tr_b16 v[214:215], v243 offset:49664
  ds_read_b64_tr_b16 v[216:217], v242 offset:57344
  ds_read_b64_tr_b16 v[218:219], v242 offset:57856
  ds_read_b64_tr_b16 v[220:221], v243 offset:57344
  ds_read_b64_tr_b16 v[222:223], v243 offset:57856
  s_waitcnt lgkmcnt(8)
  v_mfma_f32_32x32x16_bf16 v[0:15], v[224:227], v[108:111], v[0:15]
  v_mfma_f32_32x32x16_bf16 v[16:31], v[228:231], v[108:111], v[16:31]
  v_mfma_f32_32x32x16_bf16 v[32:47], v[232:235], v[108:111], v[32:47]
  v_mfma_f32_32x32x16_bf16 v[48:63], v[236:239], v[108:111], v[48:63]
  ds_read_b64_tr_b16 v[224:225], v242 offset:51200
  ds_read_b64_tr_b16 v[226:227], v242 offset:51712
  ds_read_b64_tr_b16 v[228:229], v243 offset:51200
  ds_read_b64_tr_b16 v[230:231], v243 offset:51712
  ds_read_b64_tr_b16 v[232:233], v242 offset:59392
  ds_read_b64_tr_b16 v[234:235], v242 offset:59904
  ds_read_b64_tr_b16 v[236:237], v243 offset:59392
  ds_read_b64_tr_b16 v[238:239], v243 offset:59904
  s_waitcnt lgkmcnt(8)
  v_mfma_f32_32x32x16_bf16 v[0:15], v[208:211], v[112:115], v[0:15]
  v_mfma_f32_32x32x16_bf16 v[16:31], v[212:215], v[112:115], v[16:31]
  v_mfma_f32_32x32x16_bf16 v[32:47], v[216:219], v[112:115], v[32:47]
  v_mfma_f32_32x32x16_bf16 v[48:63], v[220:223], v[112:115], v[48:63]
  ds_read_b64_tr_b16 v[208:209], v242 offset:53248
  ds_read_b64_tr_b16 v[210:211], v242 offset:53760
  ds_read_b64_tr_b16 v[212:213], v243 offset:53248
  ds_read_b64_tr_b16 v[214:215], v243 offset:53760
  ds_read_b64_tr_b16 v[216:217], v242 offset:61440
  ds_read_b64_tr_b16 v[218:219], v242 offset:61952
  ds_read_b64_tr_b16 v[220:221], v243 offset:61440
  ds_read_b64_tr_b16 v[222:223], v243 offset:61952
  s_waitcnt lgkmcnt(8)
  v_mfma_f32_32x32x16_bf16 v[0:15], v[224:227], v[116:119], v[0:15]
  v_mfma_f32_32x32x16_bf16 v[16:31], v[228:231], v[116:119], v[16:31]
  v_mfma_f32_32x32x16_bf16 v[32:47], v[232:235], v[116:119], v[32:47]
  v_mfma_f32_32x32x16_bf16 v[48:63], v[236:239], v[116:119], v[48:63]
  s_waitcnt vmcnt(16)
  s_barrier
  ds_read_b64_tr_b16 v[224:225], v242 offset:55296
  ds_read_b64_tr_b16 v[226:227], v242 offset:55808
  ds_read_b64_tr_b16 v[228:229], v243 offset:55296
  ds_read_b64_tr_b16 v[230:231], v243 offset:55808
  ds_read_b64_tr_b16 v[232:233], v242 offset:63488
  ds_read_b64_tr_b16 v[234:235], v242 offset:64000
  ds_read_b64_tr_b16 v[236:237], v243 offset:63488
  ds_read_b64_tr_b16 v[238:239], v243 offset:64000
  s_waitcnt lgkmcnt(8)
  v_mfma_f32_32x32x16_bf16 v[0:15], v[208:211], v[120:123], v[0:15]
  v_mfma_f32_32x32x16_bf16 v[16:31], v[212:215], v[120:123], v[16:31]
  v_mfma_f32_32x32x16_bf16 v[32:47], v[216:219], v[120:123], v[32:47]
  v_mfma_f32_32x32x16_bf16 v[48:63], v[220:223], v[120:123], v[48:63]
  ds_read_b64_tr_b16 v[208:209], v252 offset:0
  ds_read_b64_tr_b16 v[210:211], v252 offset:512
  ds_read_b64_tr_b16 v[212:213], v253 offset:0
  ds_read_b64_tr_b16 v[214:215], v253 offset:512
  ds_read_b64_tr_b16 v[216:217], v252 offset:8192
  ds_read_b64_tr_b16 v[218:219], v252 offset:8704
  ds_read_b64_tr_b16 v[220:221], v253 offset:8192
  ds_read_b64_tr_b16 v[222:223], v253 offset:8704
  s_waitcnt lgkmcnt(8)
  v_mfma_f32_32x32x16_bf16 v[0:15], v[224:227], v[124:127], v[0:15]
  v_mfma_f32_32x32x16_bf16 v[16:31], v[228:231], v[124:127], v[16:31]
  v_mfma_f32_32x32x16_bf16 v[32:47], v[232:235], v[124:127], v[32:47]
  v_mfma_f32_32x32x16_bf16 v[48:63], v[236:239], v[124:127], v[48:63]
  ds_read_b64_tr_b16 v[224:225], v252 offset:2048
  ds_read_b64_tr_b16 v[226:227], v252 offset:2560
  ds_read_b64_tr_b16 v[228:229], v253 offset:2048
  ds_read_b64_tr_b16 v[230:231], v253 offset:2560
  ds_read_b64_tr_b16 v[232:233], v252 offset:10240
  ds_read_b64_tr_b16 v[234:235], v252 offset:10752
  ds_read_b64_tr_b16 v[236:237], v253 offset:10240
  ds_read_b64_tr_b16 v[238:239], v253 offset:10752
  s_waitcnt lgkmcnt(8)
  v_mfma_f32_32x32x16_bf16 v[0:15], v[208:211], v[128:131], v[0:15]
  v_mfma_f32_32x32x16_bf16 v[16:31], v[212:215], v[128:131], v[16:31]
  v_mfma_f32_32x32x16_bf16 v[32:47], v[216:219], v[128:131], v[32:47]
  v_mfma_f32_32x32x16_bf16 v[48:63], v[220:223], v[128:131], v[48:63]
  ds_read_b64_tr_b16 v[208:209], v252 offset:4096
  ds_read_b64_tr_b16 v[210:211], v252 offset:4608
  ds_read_b64_tr_b16 v[212:213], v253 offset:4096
  ds_read_b64_tr_b16 v[214:215], v253 offset:4608
  ds_read_b64_tr_b16 v[216:217], v252 offset:12288
  ds_read_b64_tr_b16 v[218:219], v252 offset:12800
  ds_read_b64_tr_b16 v[220:221], v253 offset:12288
  ds_read_b64_tr_b16 v[222:223], v253 offset:12800
  s_waitcnt lgkmcnt(8)
  v_mfma_f32_32x32x16_bf16 v[0:15], v[224:227], v[132:135], v[0:15]
  v_mfma_f32_32x32x16_bf16 v[16:31], v[228:231], v[132:135], v[16:31]
  v_mfma_f32_32x32x16_bf16 v[32:47], v[232:235], v[132:135], v[32:47]
  v_mfma_f32_32x32x16_bf16 v[48:63], v[236:239], v[132:135], v[48:63]
  s_waitcnt vmcnt(14)
  s_barrier
  ds_read_b64_tr_b16 v[224:225], v252 offset:6144
  ds_read_b64_tr_b16 v[226:227], v252 offset:6656
  ds_read_b64_tr_b16 v[228:229], v253 offset:6144
  ds_read_b64_tr_b16 v[230:231], v253 offset:6656
  ds_read_b64_tr_b16 v[232:233], v252 offset:14336
  ds_read_b64_tr_b16 v[234:235], v252 offset:14848
  ds_read_b64_tr_b16 v[236:237], v253 offset:14336
  ds_read_b64_tr_b16 v[238:239], v253 offset:14848
  s_waitcnt lgkmcnt(8)
  v_mfma_f32_32x32x16_bf16 v[0:15], v[208:211], v[136:139], v[0:15]
  v_mfma_f32_32x32x16_bf16 v[16:31], v[212:215], v[136:139], v[16:31]
  v_mfma_f32_32x32x16_bf16 v[32:47], v[216:219], v[136:139], v[32:47]
  v_mfma_f32_32x32x16_bf16 v[48:63], v[220:223], v[136:139], v[48:63]
  ds_read_b64_tr_b16 v[208:209], v252 offset:16384
  ds_read_b64_tr_b16 v[210:211], v252 offset:16896
  ds_read_b64_tr_b16 v[212:213], v253 offset:16384
  ds_read_b64_tr_b16 v[214:215], v253 offset:16896
  ds_read_b64_tr_b16 v[216:217], v252 offset:24576
  ds_read_b64_tr_b16 v[218:219], v252 offset:25088
  ds_read_b64_tr_b16 v[220:221], v253 offset:24576
  ds_read_b64_tr_b16 v[222:223], v253 offset:25088
  s_waitcnt lgkmcnt(8)
  v_mfma_f32_32x32x16_bf16 v[0:15], v[224:227], v[140:143], v[0:15]
  v_mfma_f32_32x32x16_bf16 v[16:31], v[228:231], v[140:143], v[16:31]
  v_mfma_f32_32x32x16_bf16 v[32:47], v[232:235], v[140:143], v[32:47]
  v_mfma_f32_32x32x16_bf16 v[48:63], v[236:239], v[140:143], v[48:63]
  ds_read_b64_tr_b16 v[224:225], v252 offset:18432
  ds_read_b64_tr_b16 v[226:227], v252 offset:18944
  ds_read_b64_tr_b16 v[228:229], v253 offset:18432
  ds_read_b64_tr_b16 v[230:231], v253 offset:18944
  ds_read_b64_tr_b16 v[232:233], v252 offset:26624
  ds_read_b64_tr_b16 v[234:235], v252 offset:27136
  ds_read_b64_tr_b16 v[236:237], v253 offset:26624
  ds_read_b64_tr_b16 v[238:239], v253 offset:27136
  s_waitcnt lgkmcnt(8)
  v_mfma_f32_32x32x16_bf16 v[0:15], v[208:211], v[144:147], v[0:15]
  v_mfma_f32_32x32x16_bf16 v[16:31], v[212:215], v[144:147], v[16:31]
  v_mfma_f32_32x32x16_bf16 v[32:47], v[216:219], v[144:147], v[32:47]
  v_mfma_f32_32x32x16_bf16 v[48:63], v[220:223], v[144:147], v[48:63]
  ds_read_b64_tr_b16 v[208:209], v252 offset:20480
  ds_read_b64_tr_b16 v[210:211], v252 offset:20992
  ds_read_b64_tr_b16 v[212:213], v253 offset:20480
  ds_read_b64_tr_b16 v[214:215], v253 offset:20992
  ds_read_b64_tr_b16 v[216:217], v252 offset:28672
  ds_read_b64_tr_b16 v[218:219], v252 offset:29184
  ds_read_b64_tr_b16 v[220:221], v253 offset:28672
  ds_read_b64_tr_b16 v[222:223], v253 offset:29184
  s_waitcnt lgkmcnt(8)
  v_mfma_f32_32x32x16_bf16 v[0:15], v[224:227], v[148:151], v[0:15]
  v_mfma_f32_32x32x16_bf16 v[16:31], v[228:231], v[148:151], v[16:31]
  v_mfma_f32_32x32x16_bf16 v[32:47], v[232:235], v[148:151], v[32:47]
  v_mfma_f32_32x32x16_bf16 v[48:63], v[236:239], v[148:151], v[48:63]
  s_waitcnt vmcnt(12)
  s_barrier
  ds_read_b64_tr_b16 v[224:225], v252 offset:22528
  ds_read_b64_tr_b16 v[226:227], v252 offset:23040
  ds_read_b64_tr_b16 v[228:229], v253 offset:22528
  ds_read_b64_tr_b16 v[230:231], v253 offset:23040
  ds_read_b64_tr_b16 v[232:233], v252 offset:30720
  ds_read_b64_tr_b16 v[234:235], v252 offset:31232
  ds_read_b64_tr_b16 v[236:237], v253 offset:30720
  ds_read_b64_tr_b16 v[238:239], v253 offset:31232
  s_waitcnt lgkmcnt(8)
  v_mfma_f32_32x32x16_bf16 v[0:15], v[208:211], v[152:155], v[0:15]
  v_mfma_f32_32x32x16_bf16 v[16:31], v[212:215], v[152:155], v[16:31]
  v_mfma_f32_32x32x16_bf16 v[32:47], v[216:219], v[152:155], v[32:47]
  v_mfma_f32_32x32x16_bf16 v[48:63], v[220:223], v[152:155], v[48:63]
  ds_read_b64_tr_b16 v[208:209], v252 offset:32768
  ds_read_b64_tr_b16 v[210:211], v252 offset:33280
  ds_read_b64_tr_b16 v[212:213], v253 offset:32768
  ds_read_b64_tr_b16 v[214:215], v253 offset:33280
  ds_read_b64_tr_b16 v[216:217], v252 offset:40960
  ds_read_b64_tr_b16 v[218:219], v252 offset:41472
  ds_read_b64_tr_b16 v[220:221], v253 offset:40960
  ds_read_b64_tr_b16 v[222:223], v253 offset:41472
  s_waitcnt lgkmcnt(8)
  v_mfma_f32_32x32x16_bf16 v[0:15], v[224:227], v[156:159], v[0:15]
  v_mfma_f32_32x32x16_bf16 v[16:31], v[228:231], v[156:159], v[16:31]
  v_mfma_f32_32x32x16_bf16 v[32:47], v[232:235], v[156:159], v[32:47]
  v_mfma_f32_32x32x16_bf16 v[48:63], v[236:239], v[156:159], v[48:63]
  ds_read_b64_tr_b16 v[224:225], v252 offset:34816
  ds_read_b64_tr_b16 v[226:227], v252 offset:35328
  ds_read_b64_tr_b16 v[228:229], v253 offset:34816
  ds_read_b64_tr_b16 v[230:231], v253 offset:35328
  ds_read_b64_tr_b16 v[232:233], v252 offset:43008
  ds_read_b64_tr_b16 v[234:235], v252 offset:43520
  ds_read_b64_tr_b16 v[236:237], v253 offset:43008
  ds_read_b64_tr_b16 v[238:239], v253 offset:43520
  s_waitcnt lgkmcnt(8)
  v_mfma_f32_32x32x16_bf16 v[0:15], v[208:211], v[160:163], v[0:15]
  v_mfma_f32_32x32x16_bf16 v[16:31], v[212:215], v[160:163], v[16:31]
  v_mfma_f32_32x32x16_bf16 v[32:47], v[216:219], v[160:163], v[32:47]
  v_mfma_f32_32x32x16_bf16 v[48:63], v[220:223], v[160:163], v[48:63]
  ds_read_b64_tr_b16 v[208:209], v252 offset:36864
  ds_read_b64_tr_b16 v[210:211], v252 offset:37376
  ds_read_b64_tr_b16 v[212:213], v253 offset:36864
  ds_read_b64_tr_b16 v[214:215], v253 offset:37376
  ds_read_b64_tr_b16 v[216:217], v252 offset:45056
  ds_read_b64_tr_b16 v[218:219], v252 offset:45568
  ds_read_b64_tr_b16 v[220:221], v253 offset:45056
  ds_read_b64_tr_b16 v[222:223], v253 offset:45568
  s_waitcnt lgkmcnt(8)
  v_mfma_f32_32x32x16_bf16 v[0:15], v[224:227], v[164:167], v[0:15]
  v_mfma_f32_32x32x16_bf16 v[16:31], v[228:231], v[164:167], v[16:31]
  v_mfma_f32_32x32x16_bf16 v[32:47], v[232:235], v[164:167], v[32:47]
  v_mfma_f32_32x32x16_bf16 v[48:63], v[236:239], v[164:167], v[48:63]
  s_waitcnt vmcnt(2)
  s_barrier
  ds_read_b64_tr_b16 v[224:225], v252 offset:38912
  ds_read_b64_tr_b16 v[226:227], v252 offset:39424
  ds_read_b64_tr_b16 v[228:229], v253 offset:38912
  ds_read_b64_tr_b16 v[230:231], v253 offset:39424
  ds_read_b64_tr_b16 v[232:233], v252 offset:47104
  ds_read_b64_tr_b16 v[234:235], v252 offset:47616
  ds_read_b64_tr_b16 v[236:237], v253 offset:47104
  ds_read_b64_tr_b16 v[238:239], v253 offset:47616
  s_waitcnt lgkmcnt(8)
  v_mfma_f32_32x32x16_bf16 v[0:15], v[208:211], v[168:171], v[0:15]
  v_mfma_f32_32x32x16_bf16 v[16:31], v[212:215], v[168:171], v[16:31]
  v_mfma_f32_32x32x16_bf16 v[32:47], v[216:219], v[168:171], v[32:47]
  v_mfma_f32_32x32x16_bf16 v[48:63], v[220:223], v[168:171], v[48:63]
  ds_read_b64_tr_b16 v[208:209], v252 offset:49152
  ds_read_b64_tr_b16 v[210:211], v252 offset:49664
  ds_read_b64_tr_b16 v[212:213], v253 offset:49152
  ds_read_b64_tr_b16 v[214:215], v253 offset:49664
  ds_read_b64_tr_b16 v[216:217], v252 offset:57344
  ds_read_b64_tr_b16 v[218:219], v252 offset:57856
  ds_read_b64_tr_b16 v[220:221], v253 offset:57344
  ds_read_b64_tr_b16 v[222:223], v253 offset:57856
  s_waitcnt lgkmcnt(8)
  v_mfma_f32_32x32x16_bf16 v[0:15], v[224:227], v[172:175], v[0:15]
  v_mfma_f32_32x32x16_bf16 v[16:31], v[228:231], v[172:175], v[16:31]
  v_mfma_f32_32x32x16_bf16 v[32:47], v[232:235], v[172:175], v[32:47]
  v_mfma_f32_32x32x16_bf16 v[48:63], v[236:239], v[172:175], v[48:63]
  ds_read_b64_tr_b16 v[224:225], v252 offset:51200
  ds_read_b64_tr_b16 v[226:227], v252 offset:51712
  ds_read_b64_tr_b16 v[228:229], v253 offset:51200
  ds_read_b64_tr_b16 v[230:231], v253 offset:51712
  ds_read_b64_tr_b16 v[232:233], v252 offset:59392
  ds_read_b64_tr_b16 v[234:235], v252 offset:59904
  ds_read_b64_tr_b16 v[236:237], v253 offset:59392
  ds_read_b64_tr_b16 v[238:239], v253 offset:59904
  s_waitcnt lgkmcnt(8)
  v_mfma_f32_32x32x16_bf16 v[0:15], v[208:211], v[176:179], v[0:15]
  v_mfma_f32_32x32x16_bf16 v[16:31], v[212:215], v[176:179], v[16:31]
  v_mfma_f32_32x32x16_bf16 v[32:47], v[216:219], v[176:179], v[32:47]
  v_mfma_f32_32x32x16_bf16 v[48:63], v[220:223], v[176:179], v[48:63]
  ds_read_b64_tr_b16 v[208:209], v252 offset:53248
  ds_read_b64_tr_b16 v[210:211], v252 offset:53760
  ds_read_b64_tr_b16 v[212:213], v253 offset:53248
  ds_read_b64_tr_b16 v[214:215], v253 offset:53760
  ds_read_b64_tr_b16 v[216:217], v252 offset:61440
  ds_read_b64_tr_b16 v[218:219], v252 offset:61952
  ds_read_b64_tr_b16 v[220:221], v253 offset:61440
  ds_read_b64_tr_b16 v[222:223], v253 offset:61952
  s_waitcnt lgkmcnt(8)
  v_mfma_f32_32x32x16_bf16 v[0:15], v[224:227], v[180:183], v[0:15]
  v_mfma_f32_32x32x16_bf16 v[16:31], v[228:231], v[180:183], v[16:31]
  v_mfma_f32_32x32x16_bf16 v[32:47], v[232:235], v[180:183], v[32:47]
  v_mfma_f32_32x32x16_bf16 v[48:63], v[236:239], v[180:183], v[48:63]
  s_waitcnt vmcnt(0)
  s_barrier
  ds_read_b64_tr_b16 v[224:225], v252 offset:55296
  ds_read_b64_tr_b16 v[226:227], v252 offset:55808
  ds_read_b64_tr_b16 v[228:229], v253 offset:55296
  ds_read_b64_tr_b16 v[230:231], v253 offset:55808
  ds_read_b64_tr_b16 v[232:233], v252 offset:63488
  ds_read_b64_tr_b16 v[234:235], v252 offset:64000
  ds_read_b64_tr_b16 v[236:237], v253 offset:63488
  ds_read_b64_tr_b16 v[238:239], v253 offset:64000
  s_waitcnt lgkmcnt(8)
  v_mfma_f32_32x32x16_bf16 v[0:15], v[208:211], v[184:187], v[0:15]
  v_mfma_f32_32x32x16_bf16 v[16:31], v[212:215], v[184:187], v[16:31]
  v_mfma_f32_32x32x16_bf16 v[32:47], v[216:219], v[184:187], v[32:47]
  v_mfma_f32_32x32x16_bf16 v[48:63], v[220:223], v[184:187], v[48:63]
  ds_read_b64_tr_b16 v[208:209], v254 offset:0
  ds_read_b64_tr_b16 v[210:211], v254 offset:512
  ds_read_b64_tr_b16 v[212:213], v255 offset:0
  ds_read_b64_tr_b16 v[214:215], v255 offset:512
  ds_read_b64_tr_b16 v[216:217], v254 offset:8192
  ds_read_b64_tr_b16 v[218:219], v254 offset:8704
  ds_read_b64_tr_b16 v[220:221], v255 offset:8192
  ds_read_b64_tr_b16 v[222:223], v255 offset:8704
  s_waitcnt lgkmcnt(8)
  v_mfma_f32_32x32x16_bf16 v[0:15], v[224:227], v[188:191], v[0:15]
  v_mfma_f32_32x32x16_bf16 v[16:31], v[228:231], v[188:191], v[16:31]
  v_mfma_f32_32x32x16_bf16 v[32:47], v[232:235], v[188:191], v[32:47]
  v_mfma_f32_32x32x16_bf16 v[48:63], v[236:239], v[188:191], v[48:63]
  ds_read_b64_tr_b16 v[224:225], v254 offset:2048
  ds_read_b64_tr_b16 v[226:227], v254 offset:2560
  ds_read_b64_tr_b16 v[228:229], v255 offset:2048
  ds_read_b64_tr_b16 v[230:231], v255 offset:2560
  ds_read_b64_tr_b16 v[232:233], v254 offset:10240
  ds_read_b64_tr_b16 v[234:235], v254 offset:10752
  ds_read_b64_tr_b16 v[236:237], v255 offset:10240
  ds_read_b64_tr_b16 v[238:239], v255 offset:10752
  s_waitcnt lgkmcnt(8)
  v_mfma_f32_32x32x16_bf16 v[0:15], v[208:211], v[192:195], v[0:15]
  v_mfma_f32_32x32x16_bf16 v[16:31], v[212:215], v[192:195], v[16:31]
  v_mfma_f32_32x32x16_bf16 v[32:47], v[216:219], v[192:195], v[32:47]
  v_mfma_f32_32x32x16_bf16 v[48:63], v[220:223], v[192:195], v[48:63]
  ds_read_b64_tr_b16 v[208:209], v254 offset:4096
  ds_read_b64_tr_b16 v[210:211], v254 offset:4608
  ds_read_b64_tr_b16 v[212:213], v255 offset:4096
  ds_read_b64_tr_b16 v[214:215], v255 offset:4608
  ds_read_b64_tr_b16 v[216:217], v254 offset:12288
  ds_read_b64_tr_b16 v[218:219], v254 offset:12800
  ds_read_b64_tr_b16 v[220:221], v255 offset:12288
  ds_read_b64_tr_b16 v[222:223], v255 offset:12800
  s_waitcnt lgkmcnt(8)
  v_mfma_f32_32x32x16_bf16 v[0:15], v[224:227], v[196:199], v[0:15]
  v_mfma_f32_32x32x16_bf16 v[16:31], v[228:231], v[196:199], v[16:31]
  v_mfma_f32_32x32x16_bf16 v[32:47], v[232:235], v[196:199], v[32:47]
  v_mfma_f32_32x32x16_bf16 v[48:63], v[236:239], v[196:199], v[48:63]
  ds_read_b64_tr_b16 v[224:225], v254 offset:6144
  ds_read_b64_tr_b16 v[226:227], v254 offset:6656
  ds_read_b64_tr_b16 v[228:229], v255 offset:6144
  ds_read_b64_tr_b16 v[230:231], v255 offset:6656
  ds_read_b64_tr_b16 v[232:233], v254 offset:14336
  ds_read_b64_tr_b16 v[234:235], v254 offset:14848
  ds_read_b64_tr_b16 v[236:237], v255 offset:14336
  ds_read_b64_tr_b16 v[238:239], v255 offset:14848
  s_waitcnt lgkmcnt(8)
  v_mfma_f32_32x32x16_bf16 v[0:15], v[208:211], v[200:203], v[0:15]
  v_mfma_f32_32x32x16_bf16 v[16:31], v[212:215], v[200:203], v[16:31]
  v_mfma_f32_32x32x16_bf16 v[32:47], v[216:219], v[200:203], v[32:47]
  v_mfma_f32_32x32x16_bf16 v[48:63], v[220:223], v[200:203], v[48:63]
  s_waitcnt lgkmcnt(0)
  v_mfma_f32_32x32x16_bf16 v[0:15], v[224:227], v[204:207], v[0:15]
  v_mfma_f32_32x32x16_bf16 v[16:31], v[228:231], v[204:207], v[16:31]
  v_mfma_f32_32x32x16_bf16 v[32:47], v[232:235], v[204:207], v[32:47]
  v_mfma_f32_32x32x16_bf16 v[48:63], v[236:239], v[204:207], v[48:63]
  s_barrier
  s_nop 15
  s_lshr_b32 s59, s12, 5
  s_add_u32 s59, s59, s56
  s_mul_i32 s59, s59, 331776
  s_lshl_b32 s18, s13, 12
  s_add_u32 s59, s59, s18
  s_add_u32 s59, s59, 16777216
  v_lshl_add_u32 v251, v246, 4, s59
  v_lshl_add_u32 v251, v247, 3, v251
  s_mov_b32 s20, 0xbfb8aa3b
  s_mov_b32 s21, s20
  s_mov_b32 s26, 1.0
  s_mov_b32 s27, 1.0

  v_pk_mul_f32 v[208:209], v[0:1], s[20:21]
  v_pk_mul_f32 v[210:211], v[2:3], s[20:21]
  v_exp_f32 v208, v208
  v_exp_f32 v209, v209
  v_exp_f32 v210, v210
  v_exp_f32 v211, v211
  v_pk_mul_f32 v[212:213], v[0:1], v[32:33]
  v_pk_mul_f32 v[214:215], v[2:3], v[34:35]
  v_pk_add_f32 v[208:209], v[208:209], s[26:27]
  v_pk_add_f32 v[210:211], v[210:211], s[26:27]
  v_rcp_f32 v208, v208
  v_rcp_f32 v209, v209
  v_rcp_f32 v210, v210
  v_rcp_f32 v211, v211
  s_nop 0
  v_pk_mul_f32 v[212:213], v[212:213], v[208:209]
  v_pk_mul_f32 v[214:215], v[214:215], v[210:211]
  v_cvt_pk_bf16_f32 v216, v212, v213
  v_cvt_pk_bf16_f32 v217, v214, v215
  buffer_store_dwordx2 v[216:217], v251, s[60:63], 0 offen offset:0
  v_pk_mul_f32 v[218:219], v[4:5], s[20:21]
  v_pk_mul_f32 v[220:221], v[6:7], s[20:21]
  v_exp_f32 v218, v218
  v_exp_f32 v219, v219
  v_exp_f32 v220, v220
  v_exp_f32 v221, v221
  v_pk_mul_f32 v[222:223], v[4:5], v[36:37]
  v_pk_mul_f32 v[224:225], v[6:7], v[38:39]
  v_pk_add_f32 v[218:219], v[218:219], s[26:27]
  v_pk_add_f32 v[220:221], v[220:221], s[26:27]
  v_rcp_f32 v218, v218
  v_rcp_f32 v219, v219
  v_rcp_f32 v220, v220
  v_rcp_f32 v221, v221
  s_nop 0
  v_pk_mul_f32 v[222:223], v[222:223], v[218:219]
  v_pk_mul_f32 v[224:225], v[224:225], v[220:221]
  v_cvt_pk_bf16_f32 v226, v222, v223
  v_cvt_pk_bf16_f32 v227, v224, v225
  buffer_store_dwordx2 v[226:227], v251, s[60:63], 0 offen offset:512
  v_pk_mul_f32 v[228:229], v[8:9], s[20:21]
  v_pk_mul_f32 v[230:231], v[10:11], s[20:21]
  v_exp_f32 v228, v228
  v_exp_f32 v229, v229
  v_exp_f32 v230, v230
  v_exp_f32 v231, v231
  v_pk_mul_f32 v[232:233], v[8:9], v[40:41]
  v_pk_mul_f32 v[234:235], v[10:11], v[42:43]
  v_pk_add_f32 v[228:229], v[228:229], s[26:27]
  v_pk_add_f32 v[230:231], v[230:231], s[26:27]
  v_rcp_f32 v228, v228
  v_rcp_f32 v229, v229
  v_rcp_f32 v230, v230
  v_rcp_f32 v231, v231
  s_nop 0
  v_pk_mul_f32 v[232:233], v[232:233], v[228:229]
  v_pk_mul_f32 v[234:235], v[234:235], v[230:231]
  v_cvt_pk_bf16_f32 v236, v232, v233
  v_cvt_pk_bf16_f32 v237, v234, v235
  buffer_store_dwordx2 v[236:237], v251, s[60:63], 0 offen offset:1024
  v_pk_mul_f32 v[208:209], v[12:13], s[20:21]
  v_pk_mul_f32 v[210:211], v[14:15], s[20:21]
  v_exp_f32 v208, v208
  v_exp_f32 v209, v209
  v_exp_f32 v210, v210
  v_exp_f32 v211, v211
  v_pk_mul_f32 v[212:213], v[12:13], v[44:45]
  v_pk_mul_f32 v[214:215], v[14:15], v[46:47]
  v_pk_add_f32 v[208:209], v[208:209], s[26:27]
  v_pk_add_f32 v[210:211], v[210:211], s[26:27]
  v_rcp_f32 v208, v208
  v_rcp_f32 v209, v209
  v_rcp_f32 v210, v210
  v_rcp_f32 v211, v211
  s_nop 0
  v_pk_mul_f32 v[212:213], v[212:213], v[208:209]
  v_pk_mul_f32 v[214:215], v[214:215], v[210:211]
  v_cvt_pk_bf16_f32 v216, v212, v213
  v_cvt_pk_bf16_f32 v217, v214, v215
  buffer_store_dwordx2 v[216:217], v251, s[60:63], 0 offen offset:1536
  v_pk_mul_f32 v[218:219], v[16:17], s[20:21]
  v_pk_mul_f32 v[220:221], v[18:19], s[20:21]
  v_exp_f32 v218, v218
  v_exp_f32 v219, v219
  v_exp_f32 v220, v220
  v_exp_f32 v221, v221
  v_pk_mul_f32 v[222:223], v[16:17], v[48:49]
  v_pk_mul_f32 v[224:225], v[18:19], v[50:51]
  v_pk_add_f32 v[218:219], v[218:219], s[26:27]
  v_pk_add_f32 v[220:221], v[220:221], s[26:27]
  v_rcp_f32 v218, v218
  v_rcp_f32 v219, v219
  v_rcp_f32 v220, v220
  v_rcp_f32 v221, v221
  s_nop 0
  v_pk_mul_f32 v[222:223], v[222:223], v[218:219]
  v_pk_mul_f32 v[224:225], v[224:225], v[220:221]
  v_cvt_pk_bf16_f32 v226, v222, v223
  v_cvt_pk_bf16_f32 v227, v224, v225
  buffer_store_dwordx2 v[226:227], v251, s[60:63], 0 offen offset:2048
  v_pk_mul_f32 v[228:229], v[20:21], s[20:21]
  v_pk_mul_f32 v[230:231], v[22:23], s[20:21]
  v_exp_f32 v228, v228
  v_exp_f32 v229, v229
  v_exp_f32 v230, v230
  v_exp_f32 v231, v231
  v_pk_mul_f32 v[232:233], v[20:21], v[52:53]
  v_pk_mul_f32 v[234:235], v[22:23], v[54:55]
  v_pk_add_f32 v[228:229], v[228:229], s[26:27]
  v_pk_add_f32 v[230:231], v[230:231], s[26:27]
  v_rcp_f32 v228, v228
  v_rcp_f32 v229, v229
  v_rcp_f32 v230, v230
  v_rcp_f32 v231, v231
  s_nop 0
  v_pk_mul_f32 v[232:233], v[232:233], v[228:229]
  v_pk_mul_f32 v[234:235], v[234:235], v[230:231]
  v_cvt_pk_bf16_f32 v236, v232, v233
  v_cvt_pk_bf16_f32 v237, v234, v235
  buffer_store_dwordx2 v[236:237], v251, s[60:63], 0 offen offset:2560
  v_pk_mul_f32 v[208:209], v[24:25], s[20:21]
  v_pk_mul_f32 v[210:211], v[26:27], s[20:21]
  v_exp_f32 v208, v208
  v_exp_f32 v209, v209
  v_exp_f32 v210, v210
  v_exp_f32 v211, v211
  v_pk_mul_f32 v[212:213], v[24:25], v[56:57]
  v_pk_mul_f32 v[214:215], v[26:27], v[58:59]
  v_pk_add_f32 v[208:209], v[208:209], s[26:27]
  v_pk_add_f32 v[210:211], v[210:211], s[26:27]
  v_rcp_f32 v208, v208
  v_rcp_f32 v209, v209
  v_rcp_f32 v210, v210
  v_rcp_f32 v211, v211
  s_nop 0
  v_pk_mul_f32 v[212:213], v[212:213], v[208:209]
  v_pk_mul_f32 v[214:215], v[214:215], v[210:211]
  v_cvt_pk_bf16_f32 v216, v212, v213
  v_cvt_pk_bf16_f32 v217, v214, v215
  buffer_store_dwordx2 v[216:217], v251, s[60:63], 0 offen offset:3072
  v_pk_mul_f32 v[218:219], v[28:29], s[20:21]
  v_pk_mul_f32 v[220:221], v[30:31], s[20:21]
  v_exp_f32 v218, v218
  v_exp_f32 v219, v219
  v_exp_f32 v220, v220
  v_exp_f32 v221, v221
  v_pk_mul_f32 v[222:223], v[28:29], v[60:61]
  v_pk_mul_f32 v[224:225], v[30:31], v[62:63]
  v_pk_add_f32 v[218:219], v[218:219], s[26:27]
  v_pk_add_f32 v[220:221], v[220:221], s[26:27]
  v_rcp_f32 v218, v218
  v_rcp_f32 v219, v219
  v_rcp_f32 v220, v220
  v_rcp_f32 v221, v221
  s_nop 0
  v_pk_mul_f32 v[222:223], v[222:223], v[218:219]
  v_pk_mul_f32 v[224:225], v[224:225], v[220:221]
  v_cvt_pk_bf16_f32 v226, v222, v223
  v_cvt_pk_bf16_f32 v227, v224, v225
  buffer_store_dwordx2 v[226:227], v251, s[60:63], 0 offen offset:3584
  s_add_u32 s13, s13, 1
  s_cmp_lt_u32 s13, s19
  s_cselect_b32 s13, s13, s24
G1_END:

  s_endpgm
  .globl attn_kernel
  .p2align 8
  .type attn_kernel,@function
attn_kernel:
  s_cmp_lt_u32 s2, 256
  s_cbranch_scc1 AT_START
  s_sub_u32 s2, s2, 256
  s_branch G2_START
AT_START:

  s_cmp_ge_u32 s2, 256
  s_cbranch_scc1 AT_END
  s_load_dwordx2 s[10:11], s[0:1], 72
  s_and_b32 s4, s2, 7
  s_lshl_b32 s4, s4, 2
  s_bfe_u32 s5, s2, 0x20003
  s_add_u32 s4, s4, s5
  s_lshr_b32 s5, s2, 5
  v_and_b32 v127, 63, v0
  v_lshrrev_b32 v16, 6, v0
  s_nop 0
  v_readfirstlane_b32 s56, v16
  v_and_b32 v17, 31, v127
  v_lshrrev_b32 v18, 5, v127
  s_mov_b32 s57, s56
  s_waitcnt lgkmcnt(0)

  s_mov_b32 s40, s10
  s_and_b32 s41, s11, 0xffff
  s_mov_b32 s42, 268435456
  s_mov_b32 s43, 0x00020000
  s_lshl_b32 s6, s4, 11
  s_lshl_b32 s7, s5, 8
  s_add_u32 s6, s6, s7
  s_lshl_b32 s7, s57, 5
  s_add_u32 s6, s6, s7
  v_add_u32 v19, s6, v17
  v_lshlrev_b32 v19, 6, v19
  v_lshl_add_u32 v19, v18, 4, v19
  v_add_u32 v19, 4194304, v19
  buffer_load_dwordx4 v[64:67], v19, s[40:43], 0 offen
  buffer_load_dwordx4 v[68:71], v19, s[40:43], 0 offen offset:32

  v_and_b32 v17, 31, v127
  v_lshrrev_b32 v18, 5, v127
  s_lshl_b32 s7, s4, 17
  s_add_u32 s7, s7, 8388608
  s_lshl_b32 s8, s56, 10
  s_add_u32 s7, s7, s8
  v_lshrrev_b32 v20, 2, v127
  v_lshlrev_b32 v20, 6, v20
  v_and_b32 v21, 3, v127
  v_bfe_u32 v22, v127, 4, 2
  v_xor_b32 v21, v21, v22
  v_lshl_add_u32 v20, v21, 4, v20
  v_add_u32 v122, s7, v20
  s_lshl_b32 s7, s4, 17
  s_add_u32 s7, s7, 12582912
  s_lshl_b32 s8, s56, 2
  v_lshrrev_b32 v20, 4, v127
  v_add_u32 v20, s8, v20
  v_and_b32 v21, 15, v20
  v_and_b32 v23, 15, v127
  v_xor_b32 v21, v21, v23
  v_lshlrev_b32 v20, 12, v20
  v_lshl_add_u32 v20, v21, 4, v20
  v_add_u32 v123, s7, v20
  v_bfe_u32 v20, v127, 2, 2
  v_lshlrev_b32 v21, 6, v17

  v_or_b32 v22, 0, v18
  v_xor_b32 v22, v22, v20
  v_lshl_add_u32 v112, v22, 4, v21
  v_or_b32 v22, 2, v18
  v_xor_b32 v22, v22, v20
  v_lshl_add_u32 v113, v22, 4, v21
  v_and_b32 v20, 15, v127
  v_lshlrev_b32 v21, 8, v17
  v_add_u32 v21, 8192, v21
  v_or_b32 v22, 0, v18
  v_xor_b32 v22, v22, v20
  v_lshl_add_u32 v114, v22, 4, v21
  v_or_b32 v22, 2, v18
  v_xor_b32 v22, v22, v20
  v_lshl_add_u32 v115, v22, 4, v21
  v_or_b32 v22, 4, v18
  v_xor_b32 v22, v22, v20
  v_lshl_add_u32 v116, v22, 4, v21
  v_or_b32 v22, 6, v18
  v_xor_b32 v22, v22, v20
  v_lshl_add_u32 v117, v22, 4, v21
  v_or_b32 v22, 8, v18
  v_xor_b32 v22, v22, v20
  v_lshl_add_u32 v118, v22, 4, v21
  v_or_b32 v22, 10, v18
  v_xor_b32 v22, v22, v20
  v_lshl_add_u32 v119, v22, 4, v21
  v_or_b32 v22, 12, v18
  v_xor_b32 v22, v22, v20
  v_lshl_add_u32 v120, v22, 4, v21
  v_or_b32 v22, 14, v18
  v_xor_b32 v22, v22, v20
  v_lshl_add_u32 v121, v22, 4, v21
  s_mov_b32 s12, 0x3eac49ba
  s_mov_b32 s13, s12
  s_mov_b32 s14, 0x3b800100
  s_mov_b32 s15, s14
  s_lshl_b32 s54, s56, 10
  s_mov_b32 s52, 0
  s_mov_b32 s53, 0
  s_add_u32 m0, s54, 0
  s_nop 0
  buffer_load_dwordx4 v122, s[40:43], s52 offen lds
  s_add_u32 m0, s54, 8192
  s_nop 0
  buffer_load_dwordx4 v123, s[40:43], s53 offen lds
  s_add_u32 s52, s52, 8192
  s_add_u32 s53, s53, 256
  s_add_u32 m0, s54, 16384
  s_nop 0
  buffer_load_dwordx4 v122, s[40:43], s52 offen lds
  s_add_u32 m0, s54, 24576
  s_nop 0
  buffer_load_dwordx4 v123, s[40:43], s53 offen lds
  s_add_u32 s52, s52, 8192
  s_add_u32 s53, s53, 256
  s_add_u32 m0, s54, 32768
  s_nop 0
  buffer_load_dwordx4 v122, s[40:43], s52 offen lds
  s_add_u32 m0, s54, 40960
  s_nop 0
  buffer_load_dwordx4 v123, s[40:43], s53 offen lds
  s_add_u32 s52, s52, 8192
  s_add_u32 s53, s53, 256
  v_mov_b32 v0, 0
  v_mov_b32 v48, 0
  v_mov_b32 v1, 0
  v_mov_b32 v49, 0
  v_mov_b32 v2, 0
  v_mov_b32 v50, 0
  v_mov_b32 v3, 0
  v_mov_b32 v51, 0
  v_mov_b32 v4, 0
  v_mov_b32 v52, 0
  v_mov_b32 v5, 0
  v_mov_b32 v53, 0
  v_mov_b32 v6, 0
  v_mov_b32 v54, 0
  v_mov_b32 v7, 0
  v_mov_b32 v55, 0
  v_mov_b32 v8, 0
  v_mov_b32 v56, 0
  v_mov_b32 v9, 0
  v_mov_b32 v57, 0
  v_mov_b32 v10, 0
  v_mov_b32 v58, 0
  v_mov_b32 v11, 0
  v_mov_b32 v59, 0
  v_mov_b32 v12, 0
  v_mov_b32 v60, 0
  v_mov_b32 v13, 0
  v_mov_b32 v61, 0
  v_mov_b32 v14, 0
  v_mov_b32 v62, 0
  v_mov_b32 v15, 0
  v_mov_b32 v63, 0
  v_mov_b32 v126, 0xff800000
  s_mov_b64 s[34:35], -1
  v_mov_b32 v104, 0
  v_mov_b32 v96, 0
  v_mov_b32 v105, 0
  v_mov_b32 v97, 0
  v_mov_b32 v106, 0
  v_mov_b32 v98, 0
  v_mov_b32 v107, 0
  v_mov_b32 v99, 0
  v_mov_b32 v108, 0
  v_mov_b32 v100, 0
  v_mov_b32 v109, 0
  v_mov_b32 v101, 0
  v_mov_b32 v110, 0
  v_mov_b32 v102, 0
  v_mov_b32 v111, 0
  v_mov_b32 v103, 0
  s_mov_b32 s30, 0
  s_waitcnt vmcnt(4)
  s_barrier
  ds_read_b128 v[72:75], v112 offset:0
  ds_read_b128 v[76:79], v113 offset:0
  ds_read_b128 v[80:83], v112 offset:2048
  ds_read_b128 v[84:87], v113 offset:2048
  s_waitcnt lgkmcnt(2)
  v_mfma_f32_32x32x16_bf16 v[16:31], v[72:75], v[64:67], v[48:63]
  v_mfma_f32_32x32x16_bf16 v[16:31], v[76:79], v[68:71], v[16:31]
  s_waitcnt lgkmcnt(0)
  s_nop 7
  s_nop 7
  s_nop 7
AT_LOOPA:
  s_waitcnt lgkmcnt(2)
  v_mfma_f32_32x32x16_bf16 v[32:47], v[80:83], v[64:67], v[48:63]
  v_mfma_f32_32x32x16_bf16 v[32:47], v[84:87], v[68:71], v[32:47]
  ds_read_b128 v[72:75], v112 offset:4096
  ds_read_b128 v[76:79], v113 offset:4096
  s_cmp_lg_u32 s34, 0
  s_cbranch_scc1 AT_SLOWA0
AT_FA0:
  v_exp_f32 v16, v16
  v_exp_f32 v17, v17
  v_exp_f32 v18, v18
  v_exp_f32 v19, v19
  v_exp_f32 v20, v20
  v_exp_f32 v21, v21
  v_exp_f32 v22, v22
  v_exp_f32 v23, v23
  s_waitcnt lgkmcnt(2)
  v_mfma_f32_32x32x16_bf16 v[0:15], v[96:99], v[104:107], v[0:15]
  v_exp_f32 v24, v24
  v_exp_f32 v25, v25
  v_exp_f32 v26, v26
  v_exp_f32 v27, v27
  v_mfma_f32_32x32x16_bf16 v[0:15], v[100:103], v[108:111], v[0:15]
  ds_read_b128 v[88:91], v114 offset:0
  ds_read_b128 v[92:95], v115 offset:0
  v_exp_f32 v28, v28
  v_exp_f32 v29, v29
  v_exp_f32 v30, v30
  v_exp_f32 v31, v31
  v_cvt_pk_bf16_f32 v104, v16, v17
  v_cvt_pk_bf16_f32 v105, v18, v19
  v_cvt_pk_bf16_f32 v106, v20, v21
  v_cvt_pk_bf16_f32 v107, v22, v23
  v_cvt_pk_bf16_f32 v108, v24, v25
  v_cvt_pk_bf16_f32 v109, v26, v27
  v_cvt_pk_bf16_f32 v110, v28, v29
  v_cvt_pk_bf16_f32 v111, v30, v31
  s_waitcnt lgkmcnt(2)
  v_mfma_f32_32x32x16_bf16 v[16:31], v[72:75], v[64:67], v[48:63]
  v_exp_f32 v32, v32
  v_exp_f32 v33, v33
  v_exp_f32 v34, v34
  v_exp_f32 v35, v35
  v_mfma_f32_32x32x16_bf16 v[16:31], v[76:79], v[68:71], v[16:31]
  s_waitcnt vmcnt(2)
  s_barrier
  s_add_u32 m0, s54, 49152
  s_nop 0
  buffer_load_dwordx4 v122, s[40:43], s52 offen lds
  s_add_u32 m0, s54, 57344
  s_nop 0
  buffer_load_dwordx4 v123, s[40:43], s53 offen lds
  s_add_u32 s52, s52, 8192
  s_add_u32 s53, s53, 256
  ds_read_b128 v[80:83], v112 offset:6144
  ds_read_b128 v[84:87], v113 offset:6144
  v_exp_f32 v36, v36
  v_exp_f32 v37, v37
  v_exp_f32 v38, v38
  v_exp_f32 v39, v39
  s_waitcnt lgkmcnt(2)
  v_mfma_f32_32x32x16_bf16 v[0:15], v[88:91], v[104:107], v[0:15]
  v_exp_f32 v40, v40
  v_exp_f32 v41, v41
  v_exp_f32 v42, v42
  v_exp_f32 v43, v43
  v_mfma_f32_32x32x16_bf16 v[0:15], v[92:95], v[108:111], v[0:15]
  ds_read_b128 v[96:99], v116 offset:0
  ds_read_b128 v[100:103], v117 offset:0
  v_exp_f32 v44, v44
  v_exp_f32 v45, v45
  v_exp_f32 v46, v46
  v_exp_f32 v47, v47
  v_cvt_pk_bf16_f32 v104, v32, v33
  v_cvt_pk_bf16_f32 v105, v34, v35
  v_cvt_pk_bf16_f32 v106, v36, v37
  v_cvt_pk_bf16_f32 v107, v38, v39
  v_cvt_pk_bf16_f32 v108, v40, v41
  v_cvt_pk_bf16_f32 v109, v42, v43
  v_cvt_pk_bf16_f32 v110, v44, v45
  v_cvt_pk_bf16_f32 v111, v46, v47
  s_waitcnt lgkmcnt(2)
  v_mfma_f32_32x32x16_bf16 v[32:47], v[80:83], v[64:67], v[48:63]
  v_exp_f32 v16, v16
  v_exp_f32 v17, v17
  v_exp_f32 v18, v18
  v_exp_f32 v19, v19
  v_mfma_f32_32x32x16_bf16 v[32:47], v[84:87], v[68:71], v[32:47]
  ds_read_b128 v[72:75], v112 offset:16384
  ds_read_b128 v[76:79], v113 offset:16384
  v_exp_f32 v20, v20
  v_exp_f32 v21, v21
  v_exp_f32 v22, v22
  v_exp_f32 v23, v23
  s_waitcnt lgkmcnt(2)
  v_mfma_f32_32x32x16_bf16 v[0:15], v[96:99], v[104:107], v[0:15]
  v_exp_f32 v24, v24
  v_exp_f32 v25, v25
  v_exp_f32 v26, v26
  v_exp_f32 v27, v27
  v_mfma_f32_32x32x16_bf16 v[0:15], v[100:103], v[108:111], v[0:15]
  ds_read_b128 v[88:91], v118 offset:0
  ds_read_b128 v[92:95], v119 offset:0
  v_exp_f32 v28, v28
  v_exp_f32 v29, v29
  v_exp_f32 v30, v30
  v_exp_f32 v31, v31
  v_cvt_pk_bf16_f32 v104, v16, v17
  v_cvt_pk_bf16_f32 v105, v18, v19
  v_cvt_pk_bf16_f32 v106, v20, v21
  v_cvt_pk_bf16_f32 v107, v22, v23
  v_cvt_pk_bf16_f32 v108, v24, v25
  v_cvt_pk_bf16_f32 v109, v26, v27
  v_cvt_pk_bf16_f32 v110, v28, v29
  v_cvt_pk_bf16_f32 v111, v30, v31
  s_waitcnt lgkmcnt(2)
  v_mfma_f32_32x32x16_bf16 v[16:31], v[72:75], v[64:67], v[48:63]
  v_exp_f32 v32, v32
  v_exp_f32 v33, v33
  v_exp_f32 v34, v34
  v_exp_f32 v35, v35
  v_mfma_f32_32x32x16_bf16 v[16:31], v[76:79], v[68:71], v[16:31]
  ds_read_b128 v[80:83], v112 offset:18432
  ds_read_b128 v[84:87], v113 offset:18432
  v_exp_f32 v36, v36
  v_exp_f32 v37, v37
  v_exp_f32 v38, v38
  v_exp_f32 v39, v39
  s_waitcnt lgkmcnt(2)
  v_mfma_f32_32x32x16_bf16 v[0:15], v[88:91], v[104:107], v[0:15]
  v_exp_f32 v40, v40
  v_exp_f32 v41, v41
  v_exp_f32 v42, v42
  v_exp_f32 v43, v43
  v_mfma_f32_32x32x16_bf16 v[0:15], v[92:95], v[108:111], v[0:15]
  ds_read_b128 v[96:99], v120 offset:0
  ds_read_b128 v[100:103], v121 offset:0
  v_exp_f32 v44, v44
  v_exp_f32 v45, v45
  v_exp_f32 v46, v46
  v_exp_f32 v47, v47
  v_cvt_pk_bf16_f32 v104, v32, v33
  v_cvt_pk_bf16_f32 v105, v34, v35
  v_cvt_pk_bf16_f32 v106, v36, v37
  v_cvt_pk_bf16_f32 v107, v38, v39
  v_cvt_pk_bf16_f32 v108, v40, v41
  v_cvt_pk_bf16_f32 v109, v42, v43
  v_cvt_pk_bf16_f32 v110, v44, v45
  v_cvt_pk_bf16_f32 v111, v46, v47
  s_waitcnt lgkmcnt(2)
  v_mfma_f32_32x32x16_bf16 v[32:47], v[80:83], v[64:67], v[48:63]
  v_exp_f32 v16, v16
  v_exp_f32 v17, v17
  v_exp_f32 v18, v18
  v_exp_f32 v19, v19
  v_mfma_f32_32x32x16_bf16 v[32:47], v[84:87], v[68:71], v[32:47]
  ds_read_b128 v[72:75], v112 offset:20480
  ds_read_b128 v[76:79], v113 offset:20480
  v_exp_f32 v20, v20
  v_exp_f32 v21, v21
  v_exp_f32 v22, v22
  v_exp_f32 v23, v23
  s_waitcnt lgkmcnt(2)
  v_mfma_f32_32x32x16_bf16 v[0:15], v[96:99], v[104:107], v[0:15]
  v_exp_f32 v24, v24
  v_exp_f32 v25, v25
  v_exp_f32 v26, v26
  v_exp_f32 v27, v27
  v_mfma_f32_32x32x16_bf16 v[0:15], v[100:103], v[108:111], v[0:15]
  ds_read_b128 v[88:91], v114 offset:16384
  ds_read_b128 v[92:95], v115 offset:16384
  v_exp_f32 v28, v28
  v_exp_f32 v29, v29
  v_exp_f32 v30, v30
  v_exp_f32 v31, v31
  v_cvt_pk_bf16_f32 v104, v16, v17
  v_cvt_pk_bf16_f32 v105, v18, v19
  v_cvt_pk_bf16_f32 v106, v20, v21
  v_cvt_pk_bf16_f32 v107, v22, v23
  v_cvt_pk_bf16_f32 v108, v24, v25
  v_cvt_pk_bf16_f32 v109, v26, v27
  v_cvt_pk_bf16_f32 v110, v28, v29
  v_cvt_pk_bf16_f32 v111, v30, v31
  s_waitcnt lgkmcnt(2)
  v_mfma_f32_32x32x16_bf16 v[16:31], v[72:75], v[64:67], v[48:63]
  v_exp_f32 v32, v32
  v_exp_f32 v33, v33
  v_exp_f32 v34, v34
  v_exp_f32 v35, v35
  v_mfma_f32_32x32x16_bf16 v[16:31], v[76:79], v[68:71], v[16:31]
  s_waitcnt vmcnt(2)
  s_barrier
  s_add_u32 m0, s54, 0
  s_nop 0
  buffer_load_dwordx4 v122, s[40:43], s52 offen lds
  s_add_u32 m0, s54, 8192
  s_nop 0
  buffer_load_dwordx4 v123, s[40:43], s53 offen lds
  s_add_u32 s52, s52, 8192
  s_add_u32 s53, s53, 256
  ds_read_b128 v[80:83], v112 offset:22528
  ds_read_b128 v[84:87], v113 offset:22528
  v_exp_f32 v36, v36
  v_exp_f32 v37, v37
  v_exp_f32 v38, v38
  v_exp_f32 v39, v39
  s_waitcnt lgkmcnt(2)
  v_mfma_f32_32x32x16_bf16 v[0:15], v[88:91], v[104:107], v[0:15]
  v_exp_f32 v40, v40
  v_exp_f32 v41, v41
  v_exp_f32 v42, v42
  v_exp_f32 v43, v43
  v_mfma_f32_32x32x16_bf16 v[0:15], v[92:95], v[108:111], v[0:15]
  ds_read_b128 v[96:99], v116 offset:16384
  ds_read_b128 v[100:103], v117 offset:16384
  v_exp_f32 v44, v44
  v_exp_f32 v45, v45
  v_exp_f32 v46, v46
  v_exp_f32 v47, v47
  v_cvt_pk_bf16_f32 v104, v32, v33
  v_cvt_pk_bf16_f32 v105, v34, v35
  v_cvt_pk_bf16_f32 v106, v36, v37
  v_cvt_pk_bf16_f32 v107, v38, v39
  v_cvt_pk_bf16_f32 v108, v40, v41
  v_cvt_pk_bf16_f32 v109, v42, v43
  v_cvt_pk_bf16_f32 v110, v44, v45
  v_cvt_pk_bf16_f32 v111, v46, v47
  s_waitcnt lgkmcnt(2)
  v_mfma_f32_32x32x16_bf16 v[32:47], v[80:83], v[64:67], v[48:63]
  v_exp_f32 v16, v16
  v_exp_f32 v17, v17
  v_exp_f32 v18, v18
  v_exp_f32 v19, v19
  v_mfma_f32_32x32x16_bf16 v[32:47], v[84:87], v[68:71], v[32:47]
  ds_read_b128 v[72:75], v112 offset:32768
  ds_read_b128 v[76:79], v113 offset:32768
  v_exp_f32 v20, v20
  v_exp_f32 v21, v21
  v_exp_f32 v22, v22
  v_exp_f32 v23, v23
  s_waitcnt lgkmcnt(2)
  v_mfma_f32_32x32x16_bf16 v[0:15], v[96:99], v[104:107], v[0:15]
  v_exp_f32 v24, v24
  v_exp_f32 v25, v25
  v_exp_f32 v26, v26
  v_exp_f32 v27, v27
  v_mfma_f32_32x32x16_bf16 v[0:15], v[100:103], v[108:111], v[0:15]
  ds_read_b128 v[88:91], v118 offset:16384
  ds_read_b128 v[92:95], v119 offset:16384
  v_exp_f32 v28, v28
  v_exp_f32 v29, v29
  v_exp_f32 v30, v30
  v_exp_f32 v31, v31
  v_cvt_pk_bf16_f32 v104, v16, v17
  v_cvt_pk_bf16_f32 v105, v18, v19
  v_cvt_pk_bf16_f32 v106, v20, v21
  v_cvt_pk_bf16_f32 v107, v22, v23
  v_cvt_pk_bf16_f32 v108, v24, v25
  v_cvt_pk_bf16_f32 v109, v26, v27
  v_cvt_pk_bf16_f32 v110, v28, v29
  v_cvt_pk_bf16_f32 v111, v30, v31
  s_waitcnt lgkmcnt(2)
  v_mfma_f32_32x32x16_bf16 v[16:31], v[72:75], v[64:67], v[48:63]
  v_exp_f32 v32, v32
  v_exp_f32 v33, v33
  v_exp_f32 v34, v34
  v_exp_f32 v35, v35
  v_mfma_f32_32x32x16_bf16 v[16:31], v[76:79], v[68:71], v[16:31]
  ds_read_b128 v[80:83], v112 offset:34816
  ds_read_b128 v[84:87], v113 offset:34816
  v_exp_f32 v36, v36
  v_exp_f32 v37, v37
  v_exp_f32 v38, v38
  v_exp_f32 v39, v39
  s_waitcnt lgkmcnt(2)
  v_mfma_f32_32x32x16_bf16 v[0:15], v[88:91], v[104:107], v[0:15]
  v_exp_f32 v40, v40
  v_exp_f32 v41, v41
  v_exp_f32 v42, v42
  v_exp_f32 v43, v43
  v_mfma_f32_32x32x16_bf16 v[0:15], v[92:95], v[108:111], v[0:15]
  ds_read_b128 v[96:99], v120 offset:16384
  ds_read_b128 v[100:103], v121 offset:16384
  v_exp_f32 v44, v44
  v_exp_f32 v45, v45
  v_exp_f32 v46, v46
  v_exp_f32 v47, v47
  v_cvt_pk_bf16_f32 v104, v32, v33
  v_cvt_pk_bf16_f32 v105, v34, v35
  v_cvt_pk_bf16_f32 v106, v36, v37
  v_cvt_pk_bf16_f32 v107, v38, v39
  v_cvt_pk_bf16_f32 v108, v40, v41
  v_cvt_pk_bf16_f32 v109, v42, v43
  v_cvt_pk_bf16_f32 v110, v44, v45
  v_cvt_pk_bf16_f32 v111, v46, v47
  s_waitcnt lgkmcnt(2)
  v_mfma_f32_32x32x16_bf16 v[32:47], v[80:83], v[64:67], v[48:63]
  v_exp_f32 v16, v16
  v_exp_f32 v17, v17
  v_exp_f32 v18, v18
  v_exp_f32 v19, v19
  v_mfma_f32_32x32x16_bf16 v[32:47], v[84:87], v[68:71], v[32:47]
  ds_read_b128 v[72:75], v112 offset:36864
  ds_read_b128 v[76:79], v113 offset:36864
  v_exp_f32 v20, v20
  v_exp_f32 v21, v21
  v_exp_f32 v22, v22
  v_exp_f32 v23, v23
  s_waitcnt lgkmcnt(2)
  v_mfma_f32_32x32x16_bf16 v[0:15], v[96:99], v[104:107], v[0:15]
  v_exp_f32 v24, v24
  v_exp_f32 v25, v25
  v_exp_f32 v26, v26
  v_exp_f32 v27, v27
  v_mfma_f32_32x32x16_bf16 v[0:15], v[100:103], v[108:111], v[0:15]
  ds_read_b128 v[88:91], v114 offset:32768
  ds_read_b128 v[92:95], v115 offset:32768
  v_exp_f32 v28, v28
  v_exp_f32 v29, v29
  v_exp_f32 v30, v30
  v_exp_f32 v31, v31
  v_cvt_pk_bf16_f32 v104, v16, v17
  v_cvt_pk_bf16_f32 v105, v18, v19
  v_cvt_pk_bf16_f32 v106, v20, v21
  v_cvt_pk_bf16_f32 v107, v22, v23
  v_cvt_pk_bf16_f32 v108, v24, v25
  v_cvt_pk_bf16_f32 v109, v26, v27
  v_cvt_pk_bf16_f32 v110, v28, v29
  v_cvt_pk_bf16_f32 v111, v30, v31
  s_waitcnt lgkmcnt(2)
  v_mfma_f32_32x32x16_bf16 v[16:31], v[72:75], v[64:67], v[48:63]
  v_exp_f32 v32, v32
  v_exp_f32 v33, v33
  v_exp_f32 v34, v34
  v_exp_f32 v35, v35
  v_mfma_f32_32x32x16_bf16 v[16:31], v[76:79], v[68:71], v[16:31]
  s_waitcnt vmcnt(2)
  s_barrier
  s_add_u32 m0, s54, 16384
  s_nop 0
  buffer_load_dwordx4 v122, s[40:43], s52 offen lds
  s_add_u32 m0, s54, 24576
  s_nop 0
  buffer_load_dwordx4 v123, s[40:43], s53 offen lds
  s_add_u32 s52, s52, 8192
  s_add_u32 s53, s53, 256
  ds_read_b128 v[80:83], v112 offset:38912
  ds_read_b128 v[84:87], v113 offset:38912
  v_exp_f32 v36, v36
  v_exp_f32 v37, v37
  v_exp_f32 v38, v38
  v_exp_f32 v39, v39
  s_waitcnt lgkmcnt(2)
  v_mfma_f32_32x32x16_bf16 v[0:15], v[88:91], v[104:107], v[0:15]
  v_exp_f32 v40, v40
  v_exp_f32 v41, v41
  v_exp_f32 v42, v42
  v_exp_f32 v43, v43
  v_mfma_f32_32x32x16_bf16 v[0:15], v[92:95], v[108:111], v[0:15]
  ds_read_b128 v[96:99], v116 offset:32768
  ds_read_b128 v[100:103], v117 offset:32768
  v_exp_f32 v44, v44
  v_exp_f32 v45, v45
  v_exp_f32 v46, v46
  v_exp_f32 v47, v47
  v_cvt_pk_bf16_f32 v104, v32, v33
  v_cvt_pk_bf16_f32 v105, v34, v35
  v_cvt_pk_bf16_f32 v106, v36, v37
  v_cvt_pk_bf16_f32 v107, v38, v39
  v_cvt_pk_bf16_f32 v108, v40, v41
  v_cvt_pk_bf16_f32 v109, v42, v43
  v_cvt_pk_bf16_f32 v110, v44, v45
  v_cvt_pk_bf16_f32 v111, v46, v47
  s_waitcnt lgkmcnt(2)
  v_mfma_f32_32x32x16_bf16 v[32:47], v[80:83], v[64:67], v[48:63]
  v_exp_f32 v16, v16
  v_exp_f32 v17, v17
  v_exp_f32 v18, v18
  v_exp_f32 v19, v19
  v_mfma_f32_32x32x16_bf16 v[32:47], v[84:87], v[68:71], v[32:47]
  ds_read_b128 v[72:75], v112 offset:49152
  ds_read_b128 v[76:79], v113 offset:49152
  v_exp_f32 v20, v20
  v_exp_f32 v21, v21
  v_exp_f32 v22, v22
  v_exp_f32 v23, v23
  s_waitcnt lgkmcnt(2)
  v_mfma_f32_32x32x16_bf16 v[0:15], v[96:99], v[104:107], v[0:15]
  v_exp_f32 v24, v24
  v_exp_f32 v25, v25
  v_exp_f32 v26, v26
  v_exp_f32 v27, v27
  v_mfma_f32_32x32x16_bf16 v[0:15], v[100:103], v[108:111], v[0:15]
  ds_read_b128 v[88:91], v118 offset:32768
  ds_read_b128 v[92:95], v119 offset:32768
  v_exp_f32 v28, v28
  v_exp_f32 v29, v29
  v_exp_f32 v30, v30
  v_exp_f32 v31, v31
  v_cvt_pk_bf16_f32 v104, v16, v17
  v_cvt_pk_bf16_f32 v105, v18, v19
  v_cvt_pk_bf16_f32 v106, v20, v21
  v_cvt_pk_bf16_f32 v107, v22, v23
  v_cvt_pk_bf16_f32 v108, v24, v25
  v_cvt_pk_bf16_f32 v109, v26, v27
  v_cvt_pk_bf16_f32 v110, v28, v29
  v_cvt_pk_bf16_f32 v111, v30, v31
  s_waitcnt lgkmcnt(2)
  v_mfma_f32_32x32x16_bf16 v[16:31], v[72:75], v[64:67], v[48:63]
  v_exp_f32 v32, v32
  v_exp_f32 v33, v33
  v_exp_f32 v34, v34
  v_exp_f32 v35, v35
  v_mfma_f32_32x32x16_bf16 v[16:31], v[76:79], v[68:71], v[16:31]
  ds_read_b128 v[80:83], v112 offset:51200
  ds_read_b128 v[84:87], v113 offset:51200
  v_exp_f32 v36, v36
  v_exp_f32 v37, v37
  v_exp_f32 v38, v38
  v_exp_f32 v39, v39
  s_waitcnt lgkmcnt(2)
  v_mfma_f32_32x32x16_bf16 v[0:15], v[88:91], v[104:107], v[0:15]
  v_exp_f32 v40, v40
  v_exp_f32 v41, v41
  v_exp_f32 v42, v42
  v_exp_f32 v43, v43
  v_mfma_f32_32x32x16_bf16 v[0:15], v[92:95], v[108:111], v[0:15]
  ds_read_b128 v[96:99], v120 offset:32768
  ds_read_b128 v[100:103], v121 offset:32768
  v_exp_f32 v44, v44
  v_exp_f32 v45, v45
  v_exp_f32 v46, v46
  v_exp_f32 v47, v47
  v_cvt_pk_bf16_f32 v104, v32, v33
  v_cvt_pk_bf16_f32 v105, v34, v35
  v_cvt_pk_bf16_f32 v106, v36, v37
  v_cvt_pk_bf16_f32 v107, v38, v39
  v_cvt_pk_bf16_f32 v108, v40, v41
  v_cvt_pk_bf16_f32 v109, v42, v43
  v_cvt_pk_bf16_f32 v110, v44, v45
  v_cvt_pk_bf16_f32 v111, v46, v47
  s_waitcnt lgkmcnt(2)
  v_mfma_f32_32x32x16_bf16 v[32:47], v[80:83], v[64:67], v[48:63]
  v_exp_f32 v16, v16
  v_exp_f32 v17, v17
  v_exp_f32 v18, v18
  v_exp_f32 v19, v19
  v_mfma_f32_32x32x16_bf16 v[32:47], v[84:87], v[68:71], v[32:47]
  ds_read_b128 v[72:75], v112 offset:53248
  ds_read_b128 v[76:79], v113 offset:53248
  v_exp_f32 v20, v20
  v_exp_f32 v21, v21
  v_exp_f32 v22, v22
  v_exp_f32 v23, v23
  s_waitcnt lgkmcnt(2)
  v_mfma_f32_32x32x16_bf16 v[0:15], v[96:99], v[104:107], v[0:15]
  v_exp_f32 v24, v24
  v_exp_f32 v25, v25
  v_exp_f32 v26, v26
  v_exp_f32 v27, v27
  v_mfma_f32_32x32x16_bf16 v[0:15], v[100:103], v[108:111], v[0:15]
  ds_read_b128 v[88:91], v114 offset:49152
  ds_read_b128 v[92:95], v115 offset:49152
  v_exp_f32 v28, v28
  v_exp_f32 v29, v29
  v_exp_f32 v30, v30
  v_exp_f32 v31, v31
  v_cvt_pk_bf16_f32 v104, v16, v17
  v_cvt_pk_bf16_f32 v105, v18, v19
  v_cvt_pk_bf16_f32 v106, v20, v21
  v_cvt_pk_bf16_f32 v107, v22, v23
  v_cvt_pk_bf16_f32 v108, v24, v25
  v_cvt_pk_bf16_f32 v109, v26, v27
  v_cvt_pk_bf16_f32 v110, v28, v29
  v_cvt_pk_bf16_f32 v111, v30, v31
  s_waitcnt lgkmcnt(2)
  v_mfma_f32_32x32x16_bf16 v[16:31], v[72:75], v[64:67], v[48:63]
  v_exp_f32 v32, v32
  v_exp_f32 v33, v33
  v_exp_f32 v34, v34
  v_exp_f32 v35, v35
  v_mfma_f32_32x32x16_bf16 v[16:31], v[76:79], v[68:71], v[16:31]
  s_waitcnt vmcnt(2)
  s_barrier
  s_add_u32 m0, s54, 32768
  s_nop 0
  buffer_load_dwordx4 v122, s[40:43], s52 offen lds
  s_add_u32 m0, s54, 40960
  s_nop 0
  buffer_load_dwordx4 v123, s[40:43], s53 offen lds
  s_add_u32 s52, s52, 8192
  s_add_u32 s53, s53, 256
  ds_read_b128 v[80:83], v112 offset:55296
  ds_read_b128 v[84:87], v113 offset:55296
  v_exp_f32 v36, v36
  v_exp_f32 v37, v37
  v_exp_f32 v38, v38
  v_exp_f32 v39, v39
  s_waitcnt lgkmcnt(2)
  v_mfma_f32_32x32x16_bf16 v[0:15], v[88:91], v[104:107], v[0:15]
  v_exp_f32 v40, v40
  v_exp_f32 v41, v41
  v_exp_f32 v42, v42
  v_exp_f32 v43, v43
  v_mfma_f32_32x32x16_bf16 v[0:15], v[92:95], v[108:111], v[0:15]
  ds_read_b128 v[96:99], v116 offset:49152
  ds_read_b128 v[100:103], v117 offset:49152
  v_exp_f32 v44, v44
  v_exp_f32 v45, v45
  v_exp_f32 v46, v46
  v_exp_f32 v47, v47
  v_cvt_pk_bf16_f32 v104, v32, v33
  v_cvt_pk_bf16_f32 v105, v34, v35
  v_cvt_pk_bf16_f32 v106, v36, v37
  v_cvt_pk_bf16_f32 v107, v38, v39
  v_cvt_pk_bf16_f32 v108, v40, v41
  v_cvt_pk_bf16_f32 v109, v42, v43
  v_cvt_pk_bf16_f32 v110, v44, v45
  v_cvt_pk_bf16_f32 v111, v46, v47
  s_waitcnt lgkmcnt(2)
  v_mfma_f32_32x32x16_bf16 v[32:47], v[80:83], v[64:67], v[48:63]
  v_exp_f32 v16, v16
  v_exp_f32 v17, v17
  v_exp_f32 v18, v18
  v_exp_f32 v19, v19
  v_mfma_f32_32x32x16_bf16 v[32:47], v[84:87], v[68:71], v[32:47]
  ds_read_b128 v[72:75], v112 offset:0
  ds_read_b128 v[76:79], v113 offset:0
  v_exp_f32 v20, v20
  v_exp_f32 v21, v21
  v_exp_f32 v22, v22
  v_exp_f32 v23, v23
  s_waitcnt lgkmcnt(2)
  v_mfma_f32_32x32x16_bf16 v[0:15], v[96:99], v[104:107], v[0:15]
  v_exp_f32 v24, v24
  v_exp_f32 v25, v25
  v_exp_f32 v26, v26
  v_exp_f32 v27, v27
  v_mfma_f32_32x32x16_bf16 v[0:15], v[100:103], v[108:111], v[0:15]
  ds_read_b128 v[88:91], v118 offset:49152
  ds_read_b128 v[92:95], v119 offset:49152
  v_exp_f32 v28, v28
  v_exp_f32 v29, v29
  v_exp_f32 v30, v30
  v_exp_f32 v31, v31
  v_cvt_pk_bf16_f32 v104, v16, v17
  v_cvt_pk_bf16_f32 v105, v18, v19
  v_cvt_pk_bf16_f32 v106, v20, v21
  v_cvt_pk_bf16_f32 v107, v22, v23
  v_cvt_pk_bf16_f32 v108, v24, v25
  v_cvt_pk_bf16_f32 v109, v26, v27
  v_cvt_pk_bf16_f32 v110, v28, v29
  v_cvt_pk_bf16_f32 v111, v30, v31
  s_waitcnt lgkmcnt(2)
  v_mfma_f32_32x32x16_bf16 v[16:31], v[72:75], v[64:67], v[48:63]
  v_exp_f32 v32, v32
  v_exp_f32 v33, v33
  v_exp_f32 v34, v34
  v_exp_f32 v35, v35
  v_mfma_f32_32x32x16_bf16 v[16:31], v[76:79], v[68:71], v[16:31]
  ds_read_b128 v[80:83], v112 offset:2048
  ds_read_b128 v[84:87], v113 offset:2048
  v_exp_f32 v36, v36
  v_exp_f32 v37, v37
  v_exp_f32 v38, v38
  v_exp_f32 v39, v39
  s_waitcnt lgkmcnt(2)
  v_mfma_f32_32x32x16_bf16 v[0:15], v[88:91], v[104:107], v[0:15]
  v_exp_f32 v40, v40
  v_exp_f32 v41, v41
  v_exp_f32 v42, v42
  v_exp_f32 v43, v43
  v_mfma_f32_32x32x16_bf16 v[0:15], v[92:95], v[108:111], v[0:15]
  ds_read_b128 v[96:99], v120 offset:49152
  ds_read_b128 v[100:103], v121 offset:49152
  v_exp_f32 v44, v44
  v_exp_f32 v45, v45
  v_exp_f32 v46, v46
  v_exp_f32 v47, v47
  v_cvt_pk_bf16_f32 v104, v32, v33
  v_cvt_pk_bf16_f32 v105, v34, v35
  v_cvt_pk_bf16_f32 v106, v36, v37
  v_cvt_pk_bf16_f32 v107, v38, v39
  v_cvt_pk_bf16_f32 v108, v40, v41
  v_cvt_pk_bf16_f32 v109, v42, v43
  v_cvt_pk_bf16_f32 v110, v44, v45
  v_cvt_pk_bf16_f32 v111, v46, v47
  s_add_u32 s30, s30, 1
  s_cmp_lt_u32 s30, 4
  s_cbranch_scc1 AT_LOOPA
  s_branch AT_FINA
AT_SLOWA0:
  v_max3_f32 v104, v16, v17, v18
  v_max3_f32 v104, v104, v19, v20
  v_max3_f32 v104, v104, v21, v22
  v_max3_f32 v104, v104, v23, v24
  v_max3_f32 v104, v104, v25, v26
  v_max3_f32 v104, v104, v27, v28
  v_max3_f32 v104, v104, v29, v30
  v_max_f32 v104, v104, v31
  v_mov_b32 v105, v104
  s_nop 1
  v_permlane32_swap_b32 v104, v105
  s_nop 1
  v_max3_f32 v104, v104, v105, v126
  v_mov_b32 v126, 0
  s_mov_b64 s[34:35], 0
  s_nop 7
  s_nop 7
  v_sub_f32 v16, v16, v104
  v_sub_f32 v48, v48, v104
  v_sub_f32 v32, v32, v104
  v_sub_f32 v17, v17, v104
  v_sub_f32 v49, v49, v104
  v_sub_f32 v33, v33, v104
  v_sub_f32 v18, v18, v104
  v_sub_f32 v50, v50, v104
  v_sub_f32 v34, v34, v104
  v_sub_f32 v19, v19, v104
  v_sub_f32 v51, v51, v104
  v_sub_f32 v35, v35, v104
  v_sub_f32 v20, v20, v104
  v_sub_f32 v52, v52, v104
  v_sub_f32 v36, v36, v104
  v_sub_f32 v21, v21, v104
  v_sub_f32 v53, v53, v104
  v_sub_f32 v37, v37, v104
  v_sub_f32 v22, v22, v104
  v_sub_f32 v54, v54, v104
  v_sub_f32 v38, v38, v104
  v_sub_f32 v23, v23, v104
  v_sub_f32 v55, v55, v104
  v_sub_f32 v39, v39, v104
  v_sub_f32 v24, v24, v104
  v_sub_f32 v56, v56, v104
  v_sub_f32 v40, v40, v104
  v_sub_f32 v25, v25, v104
  v_sub_f32 v57, v57, v104
  v_sub_f32 v41, v41, v104
  v_sub_f32 v26, v26, v104
  v_sub_f32 v58, v58, v104
  v_sub_f32 v42, v42, v104
  v_sub_f32 v27, v27, v104
  v_sub_f32 v59, v59, v104
  v_sub_f32 v43, v43, v104
  v_sub_f32 v28, v28, v104
  v_sub_f32 v60, v60, v104
  v_sub_f32 v44, v44, v104
  v_sub_f32 v29, v29, v104
  v_sub_f32 v61, v61, v104
  v_sub_f32 v45, v45, v104
  v_sub_f32 v30, v30, v104
  v_sub_f32 v62, v62, v104
  v_sub_f32 v46, v46, v104
  v_sub_f32 v31, v31, v104
  v_sub_f32 v63, v63, v104
  v_sub_f32 v47, v47, v104
  v_mov_b32 v104, 0
  v_mov_b32 v105, 0
  s_branch AT_FA0
AT_FINA:
  s_waitcnt lgkmcnt(0)
  s_nop 1
  v_mfma_f32_32x32x16_bf16 v[0:15], v[96:99], v[104:107], v[0:15]
  v_mfma_f32_32x32x16_bf16 v[0:15], v[100:103], v[108:111], v[0:15]
  s_nop 15
  s_waitcnt vmcnt(0)
  s_nop 15
  s_barrier
  v_mov_b32 v16, 0x71800000
  v_cmp_nlt_f32 vcc, v10, v16
  s_cmp_lg_u64 vcc, 0
  s_cselect_b32 s6, 1, 0
  v_mov_b32 v16, s6
  s_lshl_b32 s6, s56, 2
  s_add_u32 s6, s6, 65536
  v_mov_b32 v17, s6
  ds_write_b32 v17, v16
  v_and_b32 v17, 7, v127
  v_lshlrev_b32 v17, 2, v17
  v_add_u32 v17, 65536, v17
  s_waitcnt lgkmcnt(0)
  s_barrier
  ds_read_b32 v16, v17
  s_waitcnt lgkmcnt(0)
  v_cmp_ne_u32 vcc, 0, v16
  s_cbranch_vccz AT_MERGE
  s_barrier

  v_and_b32 v17, 31, v127
  v_lshrrev_b32 v18, 5, v127
  s_lshl_b32 s7, s4, 17
  s_add_u32 s7, s7, 8388608
  s_lshl_b32 s8, s56, 11
  s_add_u32 s7, s7, s8
  v_lshrrev_b32 v20, 2, v127
  v_lshlrev_b32 v20, 6, v20
  v_and_b32 v21, 3, v127
  v_bfe_u32 v22, v127, 4, 2
  v_xor_b32 v21, v21, v22
  v_lshl_add_u32 v20, v21, 4, v20
  v_add_u32 v122, s7, v20
  v_add_u32 v123, 1024, v122
  s_lshl_b32 s7, s4, 17
  s_add_u32 s7, s7, 12582912
  s_lshl_b32 s8, s56, 2
  v_and_b32 v23, 31, v127

  s_add_u32 s9, s8, 0
  v_add_u32 v20, s9, v18
  v_and_b32 v21, 15, v20
  v_xor_b32 v21, v21, v23
  v_lshlrev_b32 v20, 12, v20
  v_lshl_add_u32 v20, v21, 4, v20
  v_add_u32 v124, s7, v20

  s_add_u32 s9, s8, 2
  v_add_u32 v20, s9, v18
  v_and_b32 v21, 15, v20
  v_xor_b32 v21, v21, v23
  v_lshlrev_b32 v20, 12, v20
  v_lshl_add_u32 v20, v21, 4, v20
  v_add_u32 v125, s7, v20

  v_bfe_u32 v20, v127, 2, 2
  v_lshlrev_b32 v21, 6, v17

  v_or_b32 v22, 0, v18
  v_xor_b32 v22, v22, v20
  v_lshl_add_u32 v112, v22, 4, v21
  v_or_b32 v22, 2, v18
  v_xor_b32 v22, v22, v20
  v_lshl_add_u32 v113, v22, 4, v21
  v_and_b32 v20, 15, v127
  v_lshlrev_b32 v21, 9, v17
  v_add_u32 v21, 16384, v21
  v_or_b32 v22, 0, v18
  v_xor_b32 v22, v22, v20
  v_lshl_add_u32 v114, v22, 4, v21
  v_or_b32 v22, 2, v18
  v_xor_b32 v22, v22, v20
  v_lshl_add_u32 v115, v22, 4, v21
  v_or_b32 v22, 4, v18
  v_xor_b32 v22, v22, v20
  v_lshl_add_u32 v116, v22, 4, v21
  v_or_b32 v22, 6, v18
  v_xor_b32 v22, v22, v20
  v_lshl_add_u32 v117, v22, 4, v21
  v_or_b32 v22, 8, v18
  v_xor_b32 v22, v22, v20
  v_lshl_add_u32 v118, v22, 4, v21
  v_or_b32 v22, 10, v18
  v_xor_b32 v22, v22, v20
  v_lshl_add_u32 v119, v22, 4, v21
  v_or_b32 v22, 12, v18
  v_xor_b32 v22, v22, v20
  v_lshl_add_u32 v120, v22, 4, v21
  v_or_b32 v22, 14, v18
  v_xor_b32 v22, v22, v20
  v_lshl_add_u32 v121, v22, 4, v21
  s_lshl_b32 s54, s56, 11
  s_mov_b32 s52, 0
  s_mov_b32 s53, 0
  v_mov_b32 v0, 0
  v_mov_b32 v48, 0
  v_mov_b32 v1, 0
  v_mov_b32 v49, 0
  v_mov_b32 v2, 0
  v_mov_b32 v50, 0
  v_mov_b32 v3, 0
  v_mov_b32 v51, 0
  v_mov_b32 v4, 0
  v_mov_b32 v52, 0
  v_mov_b32 v5, 0
  v_mov_b32 v53, 0
  v_mov_b32 v6, 0
  v_mov_b32 v54, 0
  v_mov_b32 v7, 0
  v_mov_b32 v55, 0
  v_mov_b32 v8, 0
  v_mov_b32 v56, 0
  v_mov_b32 v9, 0
  v_mov_b32 v57, 0
  v_mov_b32 v10, 0
  v_mov_b32 v58, 0
  v_mov_b32 v11, 0
  v_mov_b32 v59, 0
  v_mov_b32 v12, 0
  v_mov_b32 v60, 0
  v_mov_b32 v13, 0
  v_mov_b32 v61, 0
  v_mov_b32 v14, 0
  v_mov_b32 v62, 0
  v_mov_b32 v15, 0
  v_mov_b32 v63, 0
  v_mov_b32 v126, 0xff800000
  s_mov_b64 s[34:35], -1
  s_add_u32 m0, s54, 0
  s_nop 0
  buffer_load_dwordx4 v122, s[40:43], s52 offen lds
  s_add_u32 m0, s54, 1024
  s_nop 0
  buffer_load_dwordx4 v123, s[40:43], s52 offen lds
  s_add_u32 m0, s54, 16384
  s_nop 0
  buffer_load_dwordx4 v124, s[40:43], s53 offen lds
  s_add_u32 m0, s54, 17408
  s_nop 0
  buffer_load_dwordx4 v125, s[40:43], s53 offen lds
  s_mov_b32 s30, 0
AT_LOOPB:
  s_add_u32 s52, s52, 16384
  s_add_u32 s53, s53, 512
  s_xor_b32 s54, s54, 0x8000
  s_add_u32 m0, s54, 0
  s_nop 0
  buffer_load_dwordx4 v122, s[40:43], s52 offen lds
  s_add_u32 m0, s54, 1024
  s_nop 0
  buffer_load_dwordx4 v123, s[40:43], s52 offen lds
  s_add_u32 m0, s54, 16384
  s_nop 0
  buffer_load_dwordx4 v124, s[40:43], s53 offen lds
  s_add_u32 m0, s54, 17408
  s_nop 0
  buffer_load_dwordx4 v125, s[40:43], s53 offen lds
  s_waitcnt vmcnt(4)
  s_barrier
  ds_read_b128 v[72:75], v112 offset:0
  ds_read_b128 v[76:79], v113 offset:0
  ds_read_b128 v[80:83], v112 offset:2048
  ds_read_b128 v[84:87], v113 offset:2048
  ds_read_b128 v[88:91], v114 offset:0
  ds_read_b128 v[92:95], v115 offset:0
  s_waitcnt lgkmcnt(4)
  v_mfma_f32_32x32x16_bf16 v[16:31], v[72:75], v[64:67], v[48:63]
  v_mfma_f32_32x32x16_bf16 v[16:31], v[76:79], v[68:71], v[16:31]
  s_nop 7
  s_mov_b32 s31, 0
AT_INB:
  s_waitcnt lgkmcnt(2)
  v_mfma_f32_32x32x16_bf16 v[32:47], v[80:83], v[64:67], v[48:63]
  v_mfma_f32_32x32x16_bf16 v[32:47], v[84:87], v[68:71], v[32:47]
  ds_read_b128 v[72:75], v112 offset:4096
  ds_read_b128 v[76:79], v113 offset:4096
  ds_read_b128 v[96:99], v116 offset:0
  ds_read_b128 v[100:103], v117 offset:0
  v_max3_f32 v104, v16, v17, v18
  v_max3_f32 v104, v104, v19, v20
  v_max3_f32 v104, v104, v21, v22
  v_max3_f32 v104, v104, v23, v24
  v_max3_f32 v104, v104, v25, v26
  v_max3_f32 v104, v104, v27, v28
  v_max3_f32 v104, v104, v29, v30
  v_max_f32 v104, v104, v31
  v_cmp_lt_f32 vcc, 0x41000000, v104
  s_or_b64 vcc, vcc, s[34:35]
  s_cbranch_vccnz AT_SLOWB0
AT_FB0:
  v_exp_f32 v16, v16
  v_exp_f32 v17, v17
  v_exp_f32 v18, v18
  v_exp_f32 v19, v19
  v_exp_f32 v20, v20
  v_exp_f32 v21, v21
  v_exp_f32 v22, v22
  v_exp_f32 v23, v23
  v_exp_f32 v24, v24
  v_exp_f32 v25, v25
  v_exp_f32 v26, v26
  v_exp_f32 v27, v27
  v_exp_f32 v28, v28
  v_exp_f32 v29, v29
  v_exp_f32 v30, v30
  v_exp_f32 v31, v31
  v_cvt_pk_bf16_f32 v104, v16, v17
  v_cvt_pk_bf16_f32 v105, v18, v19
  v_cvt_pk_bf16_f32 v106, v20, v21
  v_cvt_pk_bf16_f32 v107, v22, v23
  v_cvt_pk_bf16_f32 v108, v24, v25
  v_cvt_pk_bf16_f32 v109, v26, v27
  v_cvt_pk_bf16_f32 v110, v28, v29
  v_cvt_pk_bf16_f32 v111, v30, v31
  s_waitcnt lgkmcnt(4)
  s_nop 1
  v_mfma_f32_32x32x16_bf16 v[0:15], v[88:91], v[104:107], v[0:15]
  v_mfma_f32_32x32x16_bf16 v[0:15], v[92:95], v[108:111], v[0:15]
  s_waitcnt lgkmcnt(2)
  v_mfma_f32_32x32x16_bf16 v[16:31], v[72:75], v[64:67], v[48:63]
  v_mfma_f32_32x32x16_bf16 v[16:31], v[76:79], v[68:71], v[16:31]
  ds_read_b128 v[80:83], v112 offset:6144
  ds_read_b128 v[84:87], v113 offset:6144
  ds_read_b128 v[88:91], v118 offset:0
  ds_read_b128 v[92:95], v119 offset:0
  v_max3_f32 v104, v32, v33, v34
  v_max3_f32 v104, v104, v35, v36
  v_max3_f32 v104, v104, v37, v38
  v_max3_f32 v104, v104, v39, v40
  v_max3_f32 v104, v104, v41, v42
  v_max3_f32 v104, v104, v43, v44
  v_max3_f32 v104, v104, v45, v46
  v_max_f32 v104, v104, v47
  v_cmp_lt_f32 vcc, 0x41000000, v104
  s_or_b64 vcc, vcc, s[34:35]
  s_cbranch_vccnz AT_SLOWB1
AT_FB1:
  v_exp_f32 v32, v32
  v_exp_f32 v33, v33
  v_exp_f32 v34, v34
  v_exp_f32 v35, v35
  v_exp_f32 v36, v36
  v_exp_f32 v37, v37
  v_exp_f32 v38, v38
  v_exp_f32 v39, v39
  v_exp_f32 v40, v40
  v_exp_f32 v41, v41
  v_exp_f32 v42, v42
  v_exp_f32 v43, v43
  v_exp_f32 v44, v44
  v_exp_f32 v45, v45
  v_exp_f32 v46, v46
  v_exp_f32 v47, v47
  v_cvt_pk_bf16_f32 v104, v32, v33
  v_cvt_pk_bf16_f32 v105, v34, v35
  v_cvt_pk_bf16_f32 v106, v36, v37
  v_cvt_pk_bf16_f32 v107, v38, v39
  v_cvt_pk_bf16_f32 v108, v40, v41
  v_cvt_pk_bf16_f32 v109, v42, v43
  v_cvt_pk_bf16_f32 v110, v44, v45
  v_cvt_pk_bf16_f32 v111, v46, v47
  s_waitcnt lgkmcnt(4)
  s_nop 1
  v_mfma_f32_32x32x16_bf16 v[0:15], v[96:99], v[104:107], v[0:15]
  v_mfma_f32_32x32x16_bf16 v[0:15], v[100:103], v[108:111], v[0:15]
  s_waitcnt lgkmcnt(2)
  v_mfma_f32_32x32x16_bf16 v[32:47], v[80:83], v[64:67], v[48:63]
  v_mfma_f32_32x32x16_bf16 v[32:47], v[84:87], v[68:71], v[32:47]
  ds_read_b128 v[72:75], v112 offset:8192
  ds_read_b128 v[76:79], v113 offset:8192
  ds_read_b128 v[96:99], v120 offset:0
  ds_read_b128 v[100:103], v121 offset:0
  v_max3_f32 v104, v16, v17, v18
  v_max3_f32 v104, v104, v19, v20
  v_max3_f32 v104, v104, v21, v22
  v_max3_f32 v104, v104, v23, v24
  v_max3_f32 v104, v104, v25, v26
  v_max3_f32 v104, v104, v27, v28
  v_max3_f32 v104, v104, v29, v30
  v_max_f32 v104, v104, v31
  v_cmp_lt_f32 vcc, 0x41000000, v104
  s_or_b64 vcc, vcc, s[34:35]
  s_cbranch_vccnz AT_SLOWB2
AT_FB2:
  v_exp_f32 v16, v16
  v_exp_f32 v17, v17
  v_exp_f32 v18, v18
  v_exp_f32 v19, v19
  v_exp_f32 v20, v20
  v_exp_f32 v21, v21
  v_exp_f32 v22, v22
  v_exp_f32 v23, v23
  v_exp_f32 v24, v24
  v_exp_f32 v25, v25
  v_exp_f32 v26, v26
  v_exp_f32 v27, v27
  v_exp_f32 v28, v28
  v_exp_f32 v29, v29
  v_exp_f32 v30, v30
  v_exp_f32 v31, v31
  v_cvt_pk_bf16_f32 v104, v16, v17
  v_cvt_pk_bf16_f32 v105, v18, v19
  v_cvt_pk_bf16_f32 v106, v20, v21
  v_cvt_pk_bf16_f32 v107, v22, v23
  v_cvt_pk_bf16_f32 v108, v24, v25
  v_cvt_pk_bf16_f32 v109, v26, v27
  v_cvt_pk_bf16_f32 v110, v28, v29
  v_cvt_pk_bf16_f32 v111, v30, v31
  s_waitcnt lgkmcnt(4)
  s_nop 1
  v_mfma_f32_32x32x16_bf16 v[0:15], v[88:91], v[104:107], v[0:15]
  v_mfma_f32_32x32x16_bf16 v[0:15], v[92:95], v[108:111], v[0:15]
  s_waitcnt lgkmcnt(2)
  v_mfma_f32_32x32x16_bf16 v[16:31], v[72:75], v[64:67], v[48:63]
  v_mfma_f32_32x32x16_bf16 v[16:31], v[76:79], v[68:71], v[16:31]
  ds_read_b128 v[80:83], v112 offset:10240
  ds_read_b128 v[84:87], v113 offset:10240
  ds_read_b128 v[88:91], v114 offset:256
  ds_read_b128 v[92:95], v115 offset:256
  v_max3_f32 v104, v32, v33, v34
  v_max3_f32 v104, v104, v35, v36
  v_max3_f32 v104, v104, v37, v38
  v_max3_f32 v104, v104, v39, v40
  v_max3_f32 v104, v104, v41, v42
  v_max3_f32 v104, v104, v43, v44
  v_max3_f32 v104, v104, v45, v46
  v_max_f32 v104, v104, v47
  v_cmp_lt_f32 vcc, 0x41000000, v104
  s_or_b64 vcc, vcc, s[34:35]
  s_cbranch_vccnz AT_SLOWB3
AT_FB3:
  v_exp_f32 v32, v32
  v_exp_f32 v33, v33
  v_exp_f32 v34, v34
  v_exp_f32 v35, v35
  v_exp_f32 v36, v36
  v_exp_f32 v37, v37
  v_exp_f32 v38, v38
  v_exp_f32 v39, v39
  v_exp_f32 v40, v40
  v_exp_f32 v41, v41
  v_exp_f32 v42, v42
  v_exp_f32 v43, v43
  v_exp_f32 v44, v44
  v_exp_f32 v45, v45
  v_exp_f32 v46, v46
  v_exp_f32 v47, v47
  v_cvt_pk_bf16_f32 v104, v32, v33
  v_cvt_pk_bf16_f32 v105, v34, v35
  v_cvt_pk_bf16_f32 v106, v36, v37
  v_cvt_pk_bf16_f32 v107, v38, v39
  v_cvt_pk_bf16_f32 v108, v40, v41
  v_cvt_pk_bf16_f32 v109, v42, v43
  v_cvt_pk_bf16_f32 v110, v44, v45
  v_cvt_pk_bf16_f32 v111, v46, v47
  s_waitcnt lgkmcnt(4)
  s_nop 1
  v_mfma_f32_32x32x16_bf16 v[0:15], v[96:99], v[104:107], v[0:15]
  v_mfma_f32_32x32x16_bf16 v[0:15], v[100:103], v[108:111], v[0:15]
  v_add_u32 v112, 8192, v112
  v_add_u32 v113, 8192, v113
  v_add_u32 v114, 256, v114
  v_add_u32 v115, 256, v115
  v_add_u32 v116, 256, v116
  v_add_u32 v117, 256, v117
  v_add_u32 v118, 256, v118
  v_add_u32 v119, 256, v119
  v_add_u32 v120, 256, v120
  v_add_u32 v121, 256, v121
  s_add_u32 s31, s31, 1
  s_cmp_lt_u32 s31, 2
  s_cbranch_scc1 AT_INB
  v_subrev_u32 v112, 16384, v112
  v_subrev_u32 v113, 16384, v113
  v_subrev_u32 v114, 512, v114
  v_subrev_u32 v115, 512, v115
  v_subrev_u32 v116, 512, v116
  v_subrev_u32 v117, 512, v117
  v_subrev_u32 v118, 512, v118
  v_subrev_u32 v119, 512, v119
  v_subrev_u32 v120, 512, v120
  v_subrev_u32 v121, 512, v121
  v_xor_b32 v112, 0x8000, v112
  v_xor_b32 v113, 0x8000, v113
  v_xor_b32 v114, 0x8000, v114
  v_xor_b32 v115, 0x8000, v115
  v_xor_b32 v116, 0x8000, v116
  v_xor_b32 v117, 0x8000, v117
  v_xor_b32 v118, 0x8000, v118
  v_xor_b32 v119, 0x8000, v119
  v_xor_b32 v120, 0x8000, v120
  v_xor_b32 v121, 0x8000, v121
  s_waitcnt lgkmcnt(0)
  s_barrier
  s_add_u32 s30, s30, 1
  s_cmp_lt_u32 s30, 8
  s_cbranch_scc1 AT_LOOPB
  s_branch AT_FINB
AT_SLOWB0:
  v_mov_b32 v105, v104
  s_nop 1
  v_permlane32_swap_b32 v104, v105
  s_nop 1
  v_max3_f32 v104, v104, v105, v126
  v_mov_b32 v126, 0
  s_mov_b64 s[34:35], 0
  v_exp_f32 v105, -v104
  v_subrev_f32 v106, 0x42fe0000, v104
  s_nop 7
  s_nop 7
  v_sub_f32 v16, v16, v104
  v_sub_f32 v48, v48, v104
  v_mul_f32 v0, v0, v105
  v_sub_f32 v32, v32, v104
  v_sub_f32 v17, v17, v104
  v_sub_f32 v49, v49, v104
  v_mul_f32 v1, v1, v105
  v_sub_f32 v33, v33, v104
  v_sub_f32 v18, v18, v104
  v_sub_f32 v50, v50, v104
  v_mul_f32 v2, v2, v105
  v_sub_f32 v34, v34, v104
  v_sub_f32 v19, v19, v104
  v_sub_f32 v51, v51, v104
  v_mul_f32 v3, v3, v105
  v_sub_f32 v35, v35, v104
  v_sub_f32 v20, v20, v104
  v_sub_f32 v52, v52, v104
  v_mul_f32 v4, v4, v105
  v_sub_f32 v36, v36, v104
  v_sub_f32 v21, v21, v104
  v_sub_f32 v53, v53, v104
  v_mul_f32 v5, v5, v105
  v_sub_f32 v37, v37, v104
  v_sub_f32 v22, v22, v104
  v_sub_f32 v54, v54, v104
  v_mul_f32 v6, v6, v105
  v_sub_f32 v38, v38, v104
  v_sub_f32 v23, v23, v104
  v_sub_f32 v55, v55, v104
  v_mul_f32 v7, v7, v105
  v_sub_f32 v39, v39, v104
  v_sub_f32 v24, v24, v104
  v_sub_f32 v56, v56, v104
  v_mul_f32 v8, v8, v105
  v_sub_f32 v40, v40, v104
  v_sub_f32 v25, v25, v104
  v_sub_f32 v57, v57, v104
  v_mul_f32 v9, v9, v105
  v_sub_f32 v41, v41, v104
  v_sub_f32 v26, v26, v104
  v_sub_f32 v58, v58, v104
  v_mul_f32 v10, v10, v105
  v_sub_f32 v42, v42, v104
  v_sub_f32 v27, v27, v104
  v_sub_f32 v59, v59, v104
  v_mul_f32 v11, v11, v105
  v_sub_f32 v43, v43, v104
  v_sub_f32 v28, v28, v104
  v_sub_f32 v60, v60, v104
  v_mul_f32 v12, v12, v105
  v_sub_f32 v44, v44, v104
  v_sub_f32 v29, v29, v104
  v_sub_f32 v61, v61, v104
  v_mul_f32 v13, v13, v105
  v_sub_f32 v45, v45, v104
  v_sub_f32 v30, v30, v104
  v_sub_f32 v62, v62, v104
  v_mul_f32 v14, v14, v105
  v_sub_f32 v46, v46, v104
  v_sub_f32 v31, v31, v104
  v_sub_f32 v63, v63, v104
  v_mul_f32 v15, v15, v105
  v_sub_f32 v47, v47, v104
  s_branch AT_FB0
AT_SLOWB1:
  v_mov_b32 v105, v104
  s_nop 1
  v_permlane32_swap_b32 v104, v105
  s_nop 1
  v_max3_f32 v104, v104, v105, v126
  v_mov_b32 v126, 0
  s_mov_b64 s[34:35], 0
  v_exp_f32 v105, -v104
  v_subrev_f32 v106, 0x42fe0000, v104
  s_nop 7
  s_nop 7
  v_sub_f32 v32, v32, v104
  v_sub_f32 v48, v48, v104
  v_mul_f32 v0, v0, v105
  v_sub_f32 v16, v16, v104
  v_sub_f32 v33, v33, v104
  v_sub_f32 v49, v49, v104
  v_mul_f32 v1, v1, v105
  v_sub_f32 v17, v17, v104
  v_sub_f32 v34, v34, v104
  v_sub_f32 v50, v50, v104
  v_mul_f32 v2, v2, v105
  v_sub_f32 v18, v18, v104
  v_sub_f32 v35, v35, v104
  v_sub_f32 v51, v51, v104
  v_mul_f32 v3, v3, v105
  v_sub_f32 v19, v19, v104
  v_sub_f32 v36, v36, v104
  v_sub_f32 v52, v52, v104
  v_mul_f32 v4, v4, v105
  v_sub_f32 v20, v20, v104
  v_sub_f32 v37, v37, v104
  v_sub_f32 v53, v53, v104
  v_mul_f32 v5, v5, v105
  v_sub_f32 v21, v21, v104
  v_sub_f32 v38, v38, v104
  v_sub_f32 v54, v54, v104
  v_mul_f32 v6, v6, v105
  v_sub_f32 v22, v22, v104
  v_sub_f32 v39, v39, v104
  v_sub_f32 v55, v55, v104
  v_mul_f32 v7, v7, v105
  v_sub_f32 v23, v23, v104
  v_sub_f32 v40, v40, v104
  v_sub_f32 v56, v56, v104
  v_mul_f32 v8, v8, v105
  v_sub_f32 v24, v24, v104
  v_sub_f32 v41, v41, v104
  v_sub_f32 v57, v57, v104
  v_mul_f32 v9, v9, v105
  v_sub_f32 v25, v25, v104
  v_sub_f32 v42, v42, v104
  v_sub_f32 v58, v58, v104
  v_mul_f32 v10, v10, v105
  v_sub_f32 v26, v26, v104
  v_sub_f32 v43, v43, v104
  v_sub_f32 v59, v59, v104
  v_mul_f32 v11, v11, v105
  v_sub_f32 v27, v27, v104
  v_sub_f32 v44, v44, v104
  v_sub_f32 v60, v60, v104
  v_mul_f32 v12, v12, v105
  v_sub_f32 v28, v28, v104
  v_sub_f32 v45, v45, v104
  v_sub_f32 v61, v61, v104
  v_mul_f32 v13, v13, v105
  v_sub_f32 v29, v29, v104
  v_sub_f32 v46, v46, v104
  v_sub_f32 v62, v62, v104
  v_mul_f32 v14, v14, v105
  v_sub_f32 v30, v30, v104
  v_sub_f32 v47, v47, v104
  v_sub_f32 v63, v63, v104
  v_mul_f32 v15, v15, v105
  v_sub_f32 v31, v31, v104
  s_branch AT_FB1
AT_SLOWB2:
  v_mov_b32 v105, v104
  s_nop 1
  v_permlane32_swap_b32 v104, v105
  s_nop 1
  v_max3_f32 v104, v104, v105, v126
  v_mov_b32 v126, 0
  s_mov_b64 s[34:35], 0
  v_exp_f32 v105, -v104
  v_subrev_f32 v106, 0x42fe0000, v104
  s_nop 7
  s_nop 7
  v_sub_f32 v16, v16, v104
  v_sub_f32 v48, v48, v104
  v_mul_f32 v0, v0, v105
  v_sub_f32 v32, v32, v104
  v_sub_f32 v17, v17, v104
  v_sub_f32 v49, v49, v104
  v_mul_f32 v1, v1, v105
  v_sub_f32 v33, v33, v104
  v_sub_f32 v18, v18, v104
  v_sub_f32 v50, v50, v104
  v_mul_f32 v2, v2, v105
  v_sub_f32 v34, v34, v104
  v_sub_f32 v19, v19, v104
  v_sub_f32 v51, v51, v104
  v_mul_f32 v3, v3, v105
  v_sub_f32 v35, v35, v104
  v_sub_f32 v20, v20, v104
  v_sub_f32 v52, v52, v104
  v_mul_f32 v4, v4, v105
  v_sub_f32 v36, v36, v104
  v_sub_f32 v21, v21, v104
  v_sub_f32 v53, v53, v104
  v_mul_f32 v5, v5, v105
  v_sub_f32 v37, v37, v104
  v_sub_f32 v22, v22, v104
  v_sub_f32 v54, v54, v104
  v_mul_f32 v6, v6, v105
  v_sub_f32 v38, v38, v104
  v_sub_f32 v23, v23, v104
  v_sub_f32 v55, v55, v104
  v_mul_f32 v7, v7, v105
  v_sub_f32 v39, v39, v104
  v_sub_f32 v24, v24, v104
  v_sub_f32 v56, v56, v104
  v_mul_f32 v8, v8, v105
  v_sub_f32 v40, v40, v104
  v_sub_f32 v25, v25, v104
  v_sub_f32 v57, v57, v104
  v_mul_f32 v9, v9, v105
  v_sub_f32 v41, v41, v104
  v_sub_f32 v26, v26, v104
  v_sub_f32 v58, v58, v104
  v_mul_f32 v10, v10, v105
  v_sub_f32 v42, v42, v104
  v_sub_f32 v27, v27, v104
  v_sub_f32 v59, v59, v104
  v_mul_f32 v11, v11, v105
  v_sub_f32 v43, v43, v104
  v_sub_f32 v28, v28, v104
  v_sub_f32 v60, v60, v104
  v_mul_f32 v12, v12, v105
  v_sub_f32 v44, v44, v104
  v_sub_f32 v29, v29, v104
  v_sub_f32 v61, v61, v104
  v_mul_f32 v13, v13, v105
  v_sub_f32 v45, v45, v104
  v_sub_f32 v30, v30, v104
  v_sub_f32 v62, v62, v104
  v_mul_f32 v14, v14, v105
  v_sub_f32 v46, v46, v104
  v_sub_f32 v31, v31, v104
  v_sub_f32 v63, v63, v104
  v_mul_f32 v15, v15, v105
  v_sub_f32 v47, v47, v104
  s_branch AT_FB2
AT_SLOWB3:
  v_mov_b32 v105, v104
  s_nop 1
  v_permlane32_swap_b32 v104, v105
  s_nop 1
  v_max3_f32 v104, v104, v105, v126
  v_mov_b32 v126, 0
  s_mov_b64 s[34:35], 0
  v_exp_f32 v105, -v104
  v_subrev_f32 v106, 0x42fe0000, v104
  s_nop 7
  s_nop 7
  v_sub_f32 v32, v32, v104
  v_sub_f32 v48, v48, v104
  v_mul_f32 v0, v0, v105
  v_sub_f32 v16, v16, v104
  v_sub_f32 v33, v33, v104
  v_sub_f32 v49, v49, v104
  v_mul_f32 v1, v1, v105
  v_sub_f32 v17, v17, v104
  v_sub_f32 v34, v34, v104
  v_sub_f32 v50, v50, v104
  v_mul_f32 v2, v2, v105
  v_sub_f32 v18, v18, v104
  v_sub_f32 v35, v35, v104
  v_sub_f32 v51, v51, v104
  v_mul_f32 v3, v3, v105
  v_sub_f32 v19, v19, v104
  v_sub_f32 v36, v36, v104
  v_sub_f32 v52, v52, v104
  v_mul_f32 v4, v4, v105
  v_sub_f32 v20, v20, v104
  v_sub_f32 v37, v37, v104
  v_sub_f32 v53, v53, v104
  v_mul_f32 v5, v5, v105
  v_sub_f32 v21, v21, v104
  v_sub_f32 v38, v38, v104
  v_sub_f32 v54, v54, v104
  v_mul_f32 v6, v6, v105
  v_sub_f32 v22, v22, v104
  v_sub_f32 v39, v39, v104
  v_sub_f32 v55, v55, v104
  v_mul_f32 v7, v7, v105
  v_sub_f32 v23, v23, v104
  v_sub_f32 v40, v40, v104
  v_sub_f32 v56, v56, v104
  v_mul_f32 v8, v8, v105
  v_sub_f32 v24, v24, v104
  v_sub_f32 v41, v41, v104
  v_sub_f32 v57, v57, v104
  v_mul_f32 v9, v9, v105
  v_sub_f32 v25, v25, v104
  v_sub_f32 v42, v42, v104
  v_sub_f32 v58, v58, v104
  v_mul_f32 v10, v10, v105
  v_sub_f32 v26, v26, v104
  v_sub_f32 v43, v43, v104
  v_sub_f32 v59, v59, v104
  v_mul_f32 v11, v11, v105
  v_sub_f32 v27, v27, v104
  v_sub_f32 v44, v44, v104
  v_sub_f32 v60, v60, v104
  v_mul_f32 v12, v12, v105
  v_sub_f32 v28, v28, v104
  v_sub_f32 v45, v45, v104
  v_sub_f32 v61, v61, v104
  v_mul_f32 v13, v13, v105
  v_sub_f32 v29, v29, v104
  v_sub_f32 v46, v46, v104
  v_sub_f32 v62, v62, v104
  v_mul_f32 v14, v14, v105
  v_sub_f32 v30, v30, v104
  v_sub_f32 v47, v47, v104
  v_sub_f32 v63, v63, v104
  v_mul_f32 v15, v15, v105
  v_sub_f32 v31, v31, v104
  s_branch AT_FB3
AT_FINB:
  s_waitcnt vmcnt(0)
  s_nop 15
AT_MERGE:
  v_and_b32 v17, 31, v127
  v_lshrrev_b32 v18, 5, v127
  v_rcp_f32 v33, v10
  s_lshl_b32 s6, s5, 8
  s_lshl_b32 s7, s57, 5
  s_add_u32 s6, s6, s7
  s_lshr_b32 s6, s6, 5
  s_mul_i32 s6, s6, 331776
  s_add_u32 s6, s6, 16777216
  v_lshl_add_u32 v19, v17, 4, s6
  s_mul_i32 s8, s4, 18
  s_add_u32 s8, s8, 4608
  v_lshl_add_u32 v41, v18, 2, s8

  v_mul_f32 v0, v0, v33
  v_mul_f32 v1, v1, v33
  v_mul_f32 v2, v2, v33
  v_mul_f32 v3, v3, v33
  v_mul_f32 v4, v4, v33
  v_mul_f32 v5, v5, v33
  v_mul_f32 v6, v6, v33
  v_mul_f32 v7, v7, v33
  v_mul_f32 v8, v8, v33
  v_mul_f32 v9, v9, v33
  v_cvt_pk_bf16_f32 v36, v0, v1
  v_cvt_pk_bf16_f32 v37, v2, v3
  v_add_u32 v42, 0, v41
  v_lshrrev_b32 v46, 3, v42
  v_and_b32 v42, 7, v42
  v_lshl_add_u32 v42, v42, 1, v19
  v_lshl_add_u32 v42, v46, 9, v42
  v_add_u32 v43, 2, v41
  v_lshrrev_b32 v46, 3, v43
  v_and_b32 v43, 7, v43
  v_lshl_add_u32 v43, v43, 1, v19
  v_lshl_add_u32 v43, v46, 9, v43
  buffer_store_dword v36, v42, s[40:43], 0 offen
  buffer_store_dword v37, v43, s[40:43], 0 offen
  v_cvt_pk_bf16_f32 v38, v4, v5
  v_cvt_pk_bf16_f32 v39, v6, v7
  v_add_u32 v44, 8, v41
  v_lshrrev_b32 v46, 3, v44
  v_and_b32 v44, 7, v44
  v_lshl_add_u32 v44, v44, 1, v19
  v_lshl_add_u32 v44, v46, 9, v44
  v_add_u32 v45, 10, v41
  v_lshrrev_b32 v46, 3, v45
  v_and_b32 v45, 7, v45
  v_lshl_add_u32 v45, v45, 1, v19
  v_lshl_add_u32 v45, v46, 9, v45
  buffer_store_dword v38, v44, s[40:43], 0 offen
  buffer_store_dword v39, v45, s[40:43], 0 offen
  v_add_u32 v47, 16, v41
  v_lshrrev_b32 v46, 3, v47
  v_and_b32 v47, 7, v47
  v_lshl_add_u32 v47, v47, 1, v19
  v_lshl_add_u32 v47, v46, 9, v47
  v_cvt_pk_bf16_f32 v40, v8, v9
  v_cmp_eq_u32 vcc, 0, v18
  s_and_saveexec_b64 s[24:25], vcc
  s_cbranch_execz AT_SK
  buffer_store_dword v40, v47, s[40:43], 0 offen
AT_SK:
  s_or_b64 exec, exec, s[24:25]
  s_waitcnt vmcnt(0)

AT_END:
  s_endpgm
G2_START:
  s_cmp_ge_u32 s2, 240
  s_cbranch_scc1 G2_END
  s_load_dwordx2 s[4:5], s[0:1], 16
  s_load_dwordx2 s[6:7], s[0:1], 48
  s_load_dwordx2 s[10:11], s[0:1], 72
  s_and_b32 s12, s2, 7
  s_lshr_b32 s13, s2, 3
  s_mul_i32 s28, s13, 43
  s_lshr_b32 s28, s28, 8
  s_mul_i32 s14, s28, 6
  s_sub_u32 s13, s13, s14
  s_mul_i32 s12, s12, 5
  s_add_u32 s12, s12, s28
  s_lshr_b32 s28, s12, 3
  s_and_b32 s12, s12, 7
  s_mul_i32 s29, s28, 14
  s_min_u32 s30, s28, 2
  s_add_u32 s29, s29, s30
  s_cmp_lt_u32 s28, 2
  s_cselect_b32 s30, 15, 14
  v_and_b32 v120, 63, v0
  v_lshrrev_b32 v121, 6, v0
  s_nop 0
  v_readfirstlane_b32 s56, v121
  s_waitcnt lgkmcnt(0)
  s_add_u32 s40, s10, 16777216
  s_addc_u32 s41, s11, 0
  s_and_b32 s41, s41, 0xffff
  s_mov_b32 s42, 21233664
  s_mov_b32 s43, 0x00020000
  s_mov_b32 s44, s6
  s_and_b32 s45, s7, 0xffff
  s_mov_b32 s46, 5308416
  s_mov_b32 s47, 0x00020000
  s_mov_b32 s49, 663552
  s_lshl_b32 s55, s56, 11
  s_cmp_lt_u32 s56, 6
  s_cbranch_scc1 G2_W6
  s_mov_b32 s46, 0
  s_mov_b32 s49, 0
G2_W6:
  s_lshl_b32 s59, s12, 3
  s_add_u32 s59, s59, s56
  s_mul_i32 s58, s59, 331776
  v_lshl_add_u32 v122, v120, 4, s58
  s_lshl_b32 s52, s29, 12
  s_and_b32 s58, s56, 1
  s_lshl_b32 s58, s58, 5
  v_lshrrev_b32 v121, 2, v120
  v_add_u32 v121, s58, v121
  v_mul_u32_u24 v121, 1152, v121
  v_and_b32 v123, 3, v120
  v_lshl_add_u32 v121, v123, 4, v121
  s_lshr_b32 s58, s56, 1
  s_lshl_b32 s58, s58, 6
  s_mul_i32 s57, s13, 192
  s_add_u32 s58, s58, s57
  v_add_u32 v124, s58, v121
  v_add_u32 v125, 18432, v124
  s_mul_i32 s53, s29, 73728

  v_lshrrev_b32 v121, 5, v120
  v_bfe_u32 v123, v120, 2, 2
  v_lshl_add_u32 v121, v121, 3, v123
  v_lshlrev_b32 v121, 6, v121
  v_bfe_u32 v123, v120, 4, 1
  v_lshl_add_u32 v121, v123, 5, v121
  v_and_b32 v123, 3, v120
  v_lshl_add_u32 v126, v123, 3, v121
  v_add_u32 v127, 36864, v126

  v_mov_b32 v0, 0
  v_mov_b32 v1, 0
  v_mov_b32 v2, 0
  v_mov_b32 v3, 0
  v_mov_b32 v4, 0
  v_mov_b32 v5, 0
  v_mov_b32 v6, 0
  v_mov_b32 v7, 0
  v_mov_b32 v8, 0
  v_mov_b32 v9, 0
  v_mov_b32 v10, 0
  v_mov_b32 v11, 0
  v_mov_b32 v12, 0
  v_mov_b32 v13, 0
  v_mov_b32 v14, 0
  v_mov_b32 v15, 0
  v_mov_b32 v16, 0
  v_mov_b32 v17, 0
  v_mov_b32 v18, 0
  v_mov_b32 v19, 0
  v_mov_b32 v20, 0
  v_mov_b32 v21, 0
  v_mov_b32 v22, 0
  v_mov_b32 v23, 0
  v_mov_b32 v24, 0
  v_mov_b32 v25, 0
  v_mov_b32 v26, 0
  v_mov_b32 v27, 0
  v_mov_b32 v28, 0
  v_mov_b32 v29, 0
  v_mov_b32 v30, 0
  v_mov_b32 v31, 0
  v_mov_b32 v32, 0
  v_mov_b32 v33, 0
  v_mov_b32 v34, 0
  v_mov_b32 v35, 0
  v_mov_b32 v36, 0
  v_mov_b32 v37, 0
  v_mov_b32 v38, 0
  v_mov_b32 v39, 0
  v_mov_b32 v40, 0
  v_mov_b32 v41, 0
  v_mov_b32 v42, 0
  v_mov_b32 v43, 0
  v_mov_b32 v44, 0
  v_mov_b32 v45, 0
  v_mov_b32 v46, 0
  v_mov_b32 v47, 0
  s_cmp_lt_u32 s56, 6
  s_cbranch_scc1 G2_PRO
  s_branch G2_PROB
G2_PRO:

  s_add_u32 m0, s55, 0
  s_nop 0
  buffer_load_dwordx4 v124, s[44:47], s53 offen lds
  s_add_u32 m0, s55, 1024
  s_nop 0
  buffer_load_dwordx4 v125, s[44:47], s53 offen lds
  s_add_u32 s53, s53, 73728
  s_add_u32 s29, s29, 1
  s_add_u32 m0, s55, 12288
  s_nop 0
  buffer_load_dwordx4 v124, s[44:47], s53 offen lds
  s_add_u32 m0, s55, 13312
  s_nop 0
  buffer_load_dwordx4 v125, s[44:47], s53 offen lds
  s_add_u32 s53, s53, 73728
  s_add_u32 s29, s29, 1
  s_add_u32 m0, s55, 24576
  s_nop 0
  buffer_load_dwordx4 v124, s[44:47], s53 offen lds
  s_add_u32 m0, s55, 25600
  s_nop 0
  buffer_load_dwordx4 v125, s[44:47], s53 offen lds
  s_add_u32 s53, s53, 73728
  s_add_u32 s29, s29, 1
  buffer_load_dwordx4 v[48:51], v122, s[40:43], s52 offen offset:0
  buffer_load_dwordx4 v[52:55], v122, s[40:43], s52 offen offset:1024
  buffer_load_dwordx4 v[56:59], v122, s[40:43], s52 offen offset:2048
  buffer_load_dwordx4 v[60:63], v122, s[40:43], s52 offen offset:3072
  s_add_u32 s52, s52, 4096
  s_add_u32 m0, s55, 36864
  s_nop 0
  buffer_load_dwordx4 v124, s[44:47], s53 offen lds
  s_add_u32 m0, s55, 37888
  s_nop 0
  buffer_load_dwordx4 v125, s[44:47], s53 offen lds
  s_add_u32 s53, s53, 73728
  s_add_u32 s29, s29, 1
  buffer_load_dwordx4 v[64:67], v122, s[40:43], s52 offen offset:0
  buffer_load_dwordx4 v[68:71], v122, s[40:43], s52 offen offset:1024
  buffer_load_dwordx4 v[72:75], v122, s[40:43], s52 offen offset:2048
  buffer_load_dwordx4 v[76:79], v122, s[40:43], s52 offen offset:3072
  s_add_u32 s52, s52, 4096
  s_add_u32 m0, s55, 49152
  s_nop 0
  buffer_load_dwordx4 v124, s[44:47], s53 offen lds
  s_add_u32 m0, s55, 50176
  s_nop 0
  buffer_load_dwordx4 v125, s[44:47], s53 offen lds
  s_add_u32 s53, s53, 73728
  s_add_u32 s29, s29, 1
  buffer_load_dwordx4 v[80:83], v122, s[40:43], s52 offen offset:0
  buffer_load_dwordx4 v[84:87], v122, s[40:43], s52 offen offset:1024
  buffer_load_dwordx4 v[88:91], v122, s[40:43], s52 offen offset:2048
  buffer_load_dwordx4 v[92:95], v122, s[40:43], s52 offen offset:3072
  s_add_u32 s52, s52, 4096
  s_waitcnt vmcnt(18)
  s_barrier
  ds_read_b64_tr_b16 v[96:97], v126 offset:0
  ds_read_b64_tr_b16 v[98:99], v126 offset:256
  ds_read_b64_tr_b16 v[100:101], v126 offset:4096
  ds_read_b64_tr_b16 v[102:103], v126 offset:4352
  ds_read_b64_tr_b16 v[104:105], v126 offset:8192
  ds_read_b64_tr_b16 v[106:107], v126 offset:8448
G2_LOOPA:
  s_waitcnt vmcnt(12)
  ds_read_b64_tr_b16 v[108:109], v126 offset:1024
  ds_read_b64_tr_b16 v[110:111], v126 offset:1280
  ds_read_b64_tr_b16 v[112:113], v126 offset:5120
  ds_read_b64_tr_b16 v[114:115], v126 offset:5376
  ds_read_b64_tr_b16 v[116:117], v126 offset:9216
  ds_read_b64_tr_b16 v[118:119], v126 offset:9472
  s_waitcnt lgkmcnt(6)
  v_mfma_f32_32x32x16_bf16 v[0:15], v[96:99], v[48:51], v[0:15]
  v_mfma_f32_32x32x16_bf16 v[16:31], v[100:103], v[48:51], v[16:31]
  v_mfma_f32_32x32x16_bf16 v[32:47], v[104:107], v[48:51], v[32:47]
  ds_read_b64_tr_b16 v[96:97], v126 offset:2048
  ds_read_b64_tr_b16 v[98:99], v126 offset:2304
  ds_read_b64_tr_b16 v[100:101], v126 offset:6144
  ds_read_b64_tr_b16 v[102:103], v126 offset:6400
  ds_read_b64_tr_b16 v[104:105], v126 offset:10240
  ds_read_b64_tr_b16 v[106:107], v126 offset:10496
  s_waitcnt lgkmcnt(6)
  v_mfma_f32_32x32x16_bf16 v[0:15], v[108:111], v[52:55], v[0:15]
  v_mfma_f32_32x32x16_bf16 v[16:31], v[112:115], v[52:55], v[16:31]
  v_mfma_f32_32x32x16_bf16 v[32:47], v[116:119], v[52:55], v[32:47]
  s_waitcnt vmcnt(22)
  s_barrier
  s_add_u32 m0, s55, 61440
  s_nop 0
  buffer_load_dwordx4 v124, s[44:47], s53 offen lds
  s_add_u32 m0, s55, 62464
  s_nop 0
  buffer_load_dwordx4 v125, s[44:47], s53 offen lds
  s_add_u32 s53, s53, 73728
  s_add_u32 s29, s29, 1
  ds_read_b64_tr_b16 v[108:109], v126 offset:3072
  ds_read_b64_tr_b16 v[110:111], v126 offset:3328
  ds_read_b64_tr_b16 v[112:113], v126 offset:7168
  ds_read_b64_tr_b16 v[114:115], v126 offset:7424
  ds_read_b64_tr_b16 v[116:117], v126 offset:11264
  ds_read_b64_tr_b16 v[118:119], v126 offset:11520
  s_waitcnt lgkmcnt(6)
  v_mfma_f32_32x32x16_bf16 v[0:15], v[96:99], v[56:59], v[0:15]
  v_mfma_f32_32x32x16_bf16 v[16:31], v[100:103], v[56:59], v[16:31]
  v_mfma_f32_32x32x16_bf16 v[32:47], v[104:107], v[56:59], v[32:47]
  ds_read_b64_tr_b16 v[96:97], v126 offset:12288
  ds_read_b64_tr_b16 v[98:99], v126 offset:12544
  ds_read_b64_tr_b16 v[100:101], v126 offset:16384
  ds_read_b64_tr_b16 v[102:103], v126 offset:16640
  ds_read_b64_tr_b16 v[104:105], v126 offset:20480
  ds_read_b64_tr_b16 v[106:107], v126 offset:20736
  s_waitcnt lgkmcnt(6)
  v_mfma_f32_32x32x16_bf16 v[0:15], v[108:111], v[60:63], v[0:15]
  v_mfma_f32_32x32x16_bf16 v[16:31], v[112:115], v[60:63], v[16:31]
  v_mfma_f32_32x32x16_bf16 v[32:47], v[116:119], v[60:63], v[32:47]
  buffer_load_dwordx4 v[48:51], v122, s[40:43], s52 offen offset:0
  buffer_load_dwordx4 v[52:55], v122, s[40:43], s52 offen offset:1024
  buffer_load_dwordx4 v[56:59], v122, s[40:43], s52 offen offset:2048
  buffer_load_dwordx4 v[60:63], v122, s[40:43], s52 offen offset:3072
  s_add_u32 s52, s52, 4096
  s_sub_u32 s30, s30, 1
  s_cmp_eq_u32 s30, 0
  s_cbranch_scc1 G2_EPI
  s_waitcnt vmcnt(12)
  ds_read_b64_tr_b16 v[108:109], v126 offset:13312
  ds_read_b64_tr_b16 v[110:111], v126 offset:13568
  ds_read_b64_tr_b16 v[112:113], v126 offset:17408
  ds_read_b64_tr_b16 v[114:115], v126 offset:17664
  ds_read_b64_tr_b16 v[116:117], v126 offset:21504
  ds_read_b64_tr_b16 v[118:119], v126 offset:21760
  s_waitcnt lgkmcnt(6)
  v_mfma_f32_32x32x16_bf16 v[0:15], v[96:99], v[64:67], v[0:15]
  v_mfma_f32_32x32x16_bf16 v[16:31], v[100:103], v[64:67], v[16:31]
  v_mfma_f32_32x32x16_bf16 v[32:47], v[104:107], v[64:67], v[32:47]
  ds_read_b64_tr_b16 v[96:97], v126 offset:14336
  ds_read_b64_tr_b16 v[98:99], v126 offset:14592
  ds_read_b64_tr_b16 v[100:101], v126 offset:18432
  ds_read_b64_tr_b16 v[102:103], v126 offset:18688
  ds_read_b64_tr_b16 v[104:105], v126 offset:22528
  ds_read_b64_tr_b16 v[106:107], v126 offset:22784
  s_waitcnt lgkmcnt(6)
  v_mfma_f32_32x32x16_bf16 v[0:15], v[108:111], v[68:71], v[0:15]
  v_mfma_f32_32x32x16_bf16 v[16:31], v[112:115], v[68:71], v[16:31]
  v_mfma_f32_32x32x16_bf16 v[32:47], v[116:119], v[68:71], v[32:47]
  s_waitcnt vmcnt(22)
  s_barrier
  s_add_u32 m0, s55, 0
  s_nop 0
  buffer_load_dwordx4 v124, s[44:47], s53 offen lds
  s_add_u32 m0, s55, 1024
  s_nop 0
  buffer_load_dwordx4 v125, s[44:47], s53 offen lds
  s_add_u32 s53, s53, 73728
  s_add_u32 s29, s29, 1
  ds_read_b64_tr_b16 v[108:109], v126 offset:15360
  ds_read_b64_tr_b16 v[110:111], v126 offset:15616
  ds_read_b64_tr_b16 v[112:113], v126 offset:19456
  ds_read_b64_tr_b16 v[114:115], v126 offset:19712
  ds_read_b64_tr_b16 v[116:117], v126 offset:23552
  ds_read_b64_tr_b16 v[118:119], v126 offset:23808
  s_waitcnt lgkmcnt(6)
  v_mfma_f32_32x32x16_bf16 v[0:15], v[96:99], v[72:75], v[0:15]
  v_mfma_f32_32x32x16_bf16 v[16:31], v[100:103], v[72:75], v[16:31]
  v_mfma_f32_32x32x16_bf16 v[32:47], v[104:107], v[72:75], v[32:47]
  ds_read_b64_tr_b16 v[96:97], v126 offset:24576
  ds_read_b64_tr_b16 v[98:99], v126 offset:24832
  ds_read_b64_tr_b16 v[100:101], v126 offset:28672
  ds_read_b64_tr_b16 v[102:103], v126 offset:28928
  ds_read_b64_tr_b16 v[104:105], v126 offset:32768
  ds_read_b64_tr_b16 v[106:107], v126 offset:33024
  s_waitcnt lgkmcnt(6)
  v_mfma_f32_32x32x16_bf16 v[0:15], v[108:111], v[76:79], v[0:15]
  v_mfma_f32_32x32x16_bf16 v[16:31], v[112:115], v[76:79], v[16:31]
  v_mfma_f32_32x32x16_bf16 v[32:47], v[116:119], v[76:79], v[32:47]
  buffer_load_dwordx4 v[64:67], v122, s[40:43], s52 offen offset:0
  buffer_load_dwordx4 v[68:71], v122, s[40:43], s52 offen offset:1024
  buffer_load_dwordx4 v[72:75], v122, s[40:43], s52 offen offset:2048
  buffer_load_dwordx4 v[76:79], v122, s[40:43], s52 offen offset:3072
  s_add_u32 s52, s52, 4096
  s_sub_u32 s30, s30, 1
  s_cmp_eq_u32 s30, 0
  s_cbranch_scc1 G2_EPI
  s_waitcnt vmcnt(12)
  ds_read_b64_tr_b16 v[108:109], v126 offset:25600
  ds_read_b64_tr_b16 v[110:111], v126 offset:25856
  ds_read_b64_tr_b16 v[112:113], v126 offset:29696
  ds_read_b64_tr_b16 v[114:115], v126 offset:29952
  ds_read_b64_tr_b16 v[116:117], v126 offset:33792
  ds_read_b64_tr_b16 v[118:119], v126 offset:34048
  s_waitcnt lgkmcnt(6)
  v_mfma_f32_32x32x16_bf16 v[0:15], v[96:99], v[80:83], v[0:15]
  v_mfma_f32_32x32x16_bf16 v[16:31], v[100:103], v[80:83], v[16:31]
  v_mfma_f32_32x32x16_bf16 v[32:47], v[104:107], v[80:83], v[32:47]
  ds_read_b64_tr_b16 v[96:97], v126 offset:26624
  ds_read_b64_tr_b16 v[98:99], v126 offset:26880
  ds_read_b64_tr_b16 v[100:101], v126 offset:30720
  ds_read_b64_tr_b16 v[102:103], v126 offset:30976
  ds_read_b64_tr_b16 v[104:105], v126 offset:34816
  ds_read_b64_tr_b16 v[106:107], v126 offset:35072
  s_waitcnt lgkmcnt(6)
  v_mfma_f32_32x32x16_bf16 v[0:15], v[108:111], v[84:87], v[0:15]
  v_mfma_f32_32x32x16_bf16 v[16:31], v[112:115], v[84:87], v[16:31]
  v_mfma_f32_32x32x16_bf16 v[32:47], v[116:119], v[84:87], v[32:47]
  s_waitcnt vmcnt(22)
  s_barrier
  s_add_u32 m0, s55, 12288
  s_nop 0
  buffer_load_dwordx4 v124, s[44:47], s53 offen lds
  s_add_u32 m0, s55, 13312
  s_nop 0
  buffer_load_dwordx4 v125, s[44:47], s53 offen lds
  s_add_u32 s53, s53, 73728
  s_add_u32 s29, s29, 1
  ds_read_b64_tr_b16 v[108:109], v126 offset:27648
  ds_read_b64_tr_b16 v[110:111], v126 offset:27904
  ds_read_b64_tr_b16 v[112:113], v126 offset:31744
  ds_read_b64_tr_b16 v[114:115], v126 offset:32000
  ds_read_b64_tr_b16 v[116:117], v126 offset:35840
  ds_read_b64_tr_b16 v[118:119], v126 offset:36096
  s_waitcnt lgkmcnt(6)
  v_mfma_f32_32x32x16_bf16 v[0:15], v[96:99], v[88:91], v[0:15]
  v_mfma_f32_32x32x16_bf16 v[16:31], v[100:103], v[88:91], v[16:31]
  v_mfma_f32_32x32x16_bf16 v[32:47], v[104:107], v[88:91], v[32:47]
  ds_read_b64_tr_b16 v[96:97], v127 offset:0
  ds_read_b64_tr_b16 v[98:99], v127 offset:256
  ds_read_b64_tr_b16 v[100:101], v127 offset:4096
  ds_read_b64_tr_b16 v[102:103], v127 offset:4352
  ds_read_b64_tr_b16 v[104:105], v127 offset:8192
  ds_read_b64_tr_b16 v[106:107], v127 offset:8448
  s_waitcnt lgkmcnt(6)
  v_mfma_f32_32x32x16_bf16 v[0:15], v[108:111], v[92:95], v[0:15]
  v_mfma_f32_32x32x16_bf16 v[16:31], v[112:115], v[92:95], v[16:31]
  v_mfma_f32_32x32x16_bf16 v[32:47], v[116:119], v[92:95], v[32:47]
  buffer_load_dwordx4 v[80:83], v122, s[40:43], s52 offen offset:0
  buffer_load_dwordx4 v[84:87], v122, s[40:43], s52 offen offset:1024
  buffer_load_dwordx4 v[88:91], v122, s[40:43], s52 offen offset:2048
  buffer_load_dwordx4 v[92:95], v122, s[40:43], s52 offen offset:3072
  s_add_u32 s52, s52, 4096
  s_sub_u32 s30, s30, 1
  s_cmp_eq_u32 s30, 0
  s_cbranch_scc1 G2_EPI
  s_waitcnt vmcnt(12)
  ds_read_b64_tr_b16 v[108:109], v127 offset:1024
  ds_read_b64_tr_b16 v[110:111], v127 offset:1280
  ds_read_b64_tr_b16 v[112:113], v127 offset:5120
  ds_read_b64_tr_b16 v[114:115], v127 offset:5376
  ds_read_b64_tr_b16 v[116:117], v127 offset:9216
  ds_read_b64_tr_b16 v[118:119], v127 offset:9472
  s_waitcnt lgkmcnt(6)
  v_mfma_f32_32x32x16_bf16 v[0:15], v[96:99], v[48:51], v[0:15]
  v_mfma_f32_32x32x16_bf16 v[16:31], v[100:103], v[48:51], v[16:31]
  v_mfma_f32_32x32x16_bf16 v[32:47], v[104:107], v[48:51], v[32:47]
  ds_read_b64_tr_b16 v[96:97], v127 offset:2048
  ds_read_b64_tr_b16 v[98:99], v127 offset:2304
  ds_read_b64_tr_b16 v[100:101], v127 offset:6144
  ds_read_b64_tr_b16 v[102:103], v127 offset:6400
  ds_read_b64_tr_b16 v[104:105], v127 offset:10240
  ds_read_b64_tr_b16 v[106:107], v127 offset:10496
  s_waitcnt lgkmcnt(6)
  v_mfma_f32_32x32x16_bf16 v[0:15], v[108:111], v[52:55], v[0:15]
  v_mfma_f32_32x32x16_bf16 v[16:31], v[112:115], v[52:55], v[16:31]
  v_mfma_f32_32x32x16_bf16 v[32:47], v[116:119], v[52:55], v[32:47]
  s_waitcnt vmcnt(22)
  s_barrier
  s_add_u32 m0, s55, 24576
  s_nop 0
  buffer_load_dwordx4 v124, s[44:47], s53 offen lds
  s_add_u32 m0, s55, 25600
  s_nop 0
  buffer_load_dwordx4 v125, s[44:47], s53 offen lds
  s_add_u32 s53, s53, 73728
  s_add_u32 s29, s29, 1
  ds_read_b64_tr_b16 v[108:109], v127 offset:3072
  ds_read_b64_tr_b16 v[110:111], v127 offset:3328
  ds_read_b64_tr_b16 v[112:113], v127 offset:7168
  ds_read_b64_tr_b16 v[114:115], v127 offset:7424
  ds_read_b64_tr_b16 v[116:117], v127 offset:11264
  ds_read_b64_tr_b16 v[118:119], v127 offset:11520
  s_waitcnt lgkmcnt(6)
  v_mfma_f32_32x32x16_bf16 v[0:15], v[96:99], v[56:59], v[0:15]
  v_mfma_f32_32x32x16_bf16 v[16:31], v[100:103], v[56:59], v[16:31]
  v_mfma_f32_32x32x16_bf16 v[32:47], v[104:107], v[56:59], v[32:47]
  ds_read_b64_tr_b16 v[96:97], v127 offset:12288
  ds_read_b64_tr_b16 v[98:99], v127 offset:12544
  ds_read_b64_tr_b16 v[100:101], v127 offset:16384
  ds_read_b64_tr_b16 v[102:103], v127 offset:16640
  ds_read_b64_tr_b16 v[104:105], v127 offset:20480
  ds_read_b64_tr_b16 v[106:107], v127 offset:20736
  s_waitcnt lgkmcnt(6)
  v_mfma_f32_32x32x16_bf16 v[0:15], v[108:111], v[60:63], v[0:15]
  v_mfma_f32_32x32x16_bf16 v[16:31], v[112:115], v[60:63], v[16:31]
  v_mfma_f32_32x32x16_bf16 v[32:47], v[116:119], v[60:63], v[32:47]
  buffer_load_dwordx4 v[48:51], v122, s[40:43], s52 offen offset:0
  buffer_load_dwordx4 v[52:55], v122, s[40:43], s52 offen offset:1024
  buffer_load_dwordx4 v[56:59], v122, s[40:43], s52 offen offset:2048
  buffer_load_dwordx4 v[60:63], v122, s[40:43], s52 offen offset:3072
  s_add_u32 s52, s52, 4096
  s_sub_u32 s30, s30, 1
  s_cmp_eq_u32 s30, 0
  s_cbranch_scc1 G2_EPI
  s_waitcnt vmcnt(12)
  ds_read_b64_tr_b16 v[108:109], v127 offset:13312
  ds_read_b64_tr_b16 v[110:111], v127 offset:13568
  ds_read_b64_tr_b16 v[112:113], v127 offset:17408
  ds_read_b64_tr_b16 v[114:115], v127 offset:17664
  ds_read_b64_tr_b16 v[116:117], v127 offset:21504
  ds_read_b64_tr_b16 v[118:119], v127 offset:21760
  s_waitcnt lgkmcnt(6)
  v_mfma_f32_32x32x16_bf16 v[0:15], v[96:99], v[64:67], v[0:15]
  v_mfma_f32_32x32x16_bf16 v[16:31], v[100:103], v[64:67], v[16:31]
  v_mfma_f32_32x32x16_bf16 v[32:47], v[104:107], v[64:67], v[32:47]
  ds_read_b64_tr_b16 v[96:97], v127 offset:14336
  ds_read_b64_tr_b16 v[98:99], v127 offset:14592
  ds_read_b64_tr_b16 v[100:101], v127 offset:18432
  ds_read_b64_tr_b16 v[102:103], v127 offset:18688
  ds_read_b64_tr_b16 v[104:105], v127 offset:22528
  ds_read_b64_tr_b16 v[106:107], v127 offset:22784
  s_waitcnt lgkmcnt(6)
  v_mfma_f32_32x32x16_bf16 v[0:15], v[108:111], v[68:71], v[0:15]
  v_mfma_f32_32x32x16_bf16 v[16:31], v[112:115], v[68:71], v[16:31]
  v_mfma_f32_32x32x16_bf16 v[32:47], v[116:119], v[68:71], v[32:47]
  s_waitcnt vmcnt(22)
  s_barrier
  s_add_u32 m0, s55, 36864
  s_nop 0
  buffer_load_dwordx4 v124, s[44:47], s53 offen lds
  s_add_u32 m0, s55, 37888
  s_nop 0
  buffer_load_dwordx4 v125, s[44:47], s53 offen lds
  s_add_u32 s53, s53, 73728
  s_add_u32 s29, s29, 1
  ds_read_b64_tr_b16 v[108:109], v127 offset:15360
  ds_read_b64_tr_b16 v[110:111], v127 offset:15616
  ds_read_b64_tr_b16 v[112:113], v127 offset:19456
  ds_read_b64_tr_b16 v[114:115], v127 offset:19712
  ds_read_b64_tr_b16 v[116:117], v127 offset:23552
  ds_read_b64_tr_b16 v[118:119], v127 offset:23808
  s_waitcnt lgkmcnt(6)
  v_mfma_f32_32x32x16_bf16 v[0:15], v[96:99], v[72:75], v[0:15]
  v_mfma_f32_32x32x16_bf16 v[16:31], v[100:103], v[72:75], v[16:31]
  v_mfma_f32_32x32x16_bf16 v[32:47], v[104:107], v[72:75], v[32:47]
  ds_read_b64_tr_b16 v[96:97], v127 offset:24576
  ds_read_b64_tr_b16 v[98:99], v127 offset:24832
  ds_read_b64_tr_b16 v[100:101], v127 offset:28672
  ds_read_b64_tr_b16 v[102:103], v127 offset:28928
  ds_read_b64_tr_b16 v[104:105], v127 offset:32768
  ds_read_b64_tr_b16 v[106:107], v127 offset:33024
  s_waitcnt lgkmcnt(6)
  v_mfma_f32_32x32x16_bf16 v[0:15], v[108:111], v[76:79], v[0:15]
  v_mfma_f32_32x32x16_bf16 v[16:31], v[112:115], v[76:79], v[16:31]
  v_mfma_f32_32x32x16_bf16 v[32:47], v[116:119], v[76:79], v[32:47]
  buffer_load_dwordx4 v[64:67], v122, s[40:43], s52 offen offset:0
  buffer_load_dwordx4 v[68:71], v122, s[40:43], s52 offen offset:1024
  buffer_load_dwordx4 v[72:75], v122, s[40:43], s52 offen offset:2048
  buffer_load_dwordx4 v[76:79], v122, s[40:43], s52 offen offset:3072
  s_add_u32 s52, s52, 4096
  s_sub_u32 s30, s30, 1
  s_cmp_eq_u32 s30, 0
  s_cbranch_scc1 G2_EPI
  s_waitcnt vmcnt(12)
  ds_read_b64_tr_b16 v[108:109], v127 offset:25600
  ds_read_b64_tr_b16 v[110:111], v127 offset:25856
  ds_read_b64_tr_b16 v[112:113], v127 offset:29696
  ds_read_b64_tr_b16 v[114:115], v127 offset:29952
  ds_read_b64_tr_b16 v[116:117], v127 offset:33792
  ds_read_b64_tr_b16 v[118:119], v127 offset:34048
  s_waitcnt lgkmcnt(6)
  v_mfma_f32_32x32x16_bf16 v[0:15], v[96:99], v[80:83], v[0:15]
  v_mfma_f32_32x32x16_bf16 v[16:31], v[100:103], v[80:83], v[16:31]
  v_mfma_f32_32x32x16_bf16 v[32:47], v[104:107], v[80:83], v[32:47]
  ds_read_b64_tr_b16 v[96:97], v127 offset:26624
  ds_read_b64_tr_b16 v[98:99], v127 offset:26880
  ds_read_b64_tr_b16 v[100:101], v127 offset:30720
  ds_read_b64_tr_b16 v[102:103], v127 offset:30976
  ds_read_b64_tr_b16 v[104:105], v127 offset:34816
  ds_read_b64_tr_b16 v[106:107], v127 offset:35072
  s_waitcnt lgkmcnt(6)
  v_mfma_f32_32x32x16_bf16 v[0:15], v[108:111], v[84:87], v[0:15]
  v_mfma_f32_32x32x16_bf16 v[16:31], v[112:115], v[84:87], v[16:31]
  v_mfma_f32_32x32x16_bf16 v[32:47], v[116:119], v[84:87], v[32:47]
  s_waitcnt vmcnt(22)
  s_barrier
  s_add_u32 m0, s55, 49152
  s_nop 0
  buffer_load_dwordx4 v124, s[44:47], s53 offen lds
  s_add_u32 m0, s55, 50176
  s_nop 0
  buffer_load_dwordx4 v125, s[44:47], s53 offen lds
  s_add_u32 s53, s53, 73728
  s_add_u32 s29, s29, 1
  ds_read_b64_tr_b16 v[108:109], v127 offset:27648
  ds_read_b64_tr_b16 v[110:111], v127 offset:27904
  ds_read_b64_tr_b16 v[112:113], v127 offset:31744
  ds_read_b64_tr_b16 v[114:115], v127 offset:32000
  ds_read_b64_tr_b16 v[116:117], v127 offset:35840
  ds_read_b64_tr_b16 v[118:119], v127 offset:36096
  s_waitcnt lgkmcnt(6)
  v_mfma_f32_32x32x16_bf16 v[0:15], v[96:99], v[88:91], v[0:15]
  v_mfma_f32_32x32x16_bf16 v[16:31], v[100:103], v[88:91], v[16:31]
  v_mfma_f32_32x32x16_bf16 v[32:47], v[104:107], v[88:91], v[32:47]
  ds_read_b64_tr_b16 v[96:97], v126 offset:0
  ds_read_b64_tr_b16 v[98:99], v126 offset:256
  ds_read_b64_tr_b16 v[100:101], v126 offset:4096
  ds_read_b64_tr_b16 v[102:103], v126 offset:4352
  ds_read_b64_tr_b16 v[104:105], v126 offset:8192
  ds_read_b64_tr_b16 v[106:107], v126 offset:8448
  s_waitcnt lgkmcnt(6)
  v_mfma_f32_32x32x16_bf16 v[0:15], v[108:111], v[92:95], v[0:15]
  v_mfma_f32_32x32x16_bf16 v[16:31], v[112:115], v[92:95], v[16:31]
  v_mfma_f32_32x32x16_bf16 v[32:47], v[116:119], v[92:95], v[32:47]
  buffer_load_dwordx4 v[80:83], v122, s[40:43], s52 offen offset:0
  buffer_load_dwordx4 v[84:87], v122, s[40:43], s52 offen offset:1024
  buffer_load_dwordx4 v[88:91], v122, s[40:43], s52 offen offset:2048
  buffer_load_dwordx4 v[92:95], v122, s[40:43], s52 offen offset:3072
  s_add_u32 s52, s52, 4096
  s_sub_u32 s30, s30, 1
  s_cmp_eq_u32 s30, 0
  s_cbranch_scc1 G2_EPI
  s_branch G2_LOOPA
G2_PROB:
  s_mov_b32 m0, 73728
  s_nop 0
  buffer_load_dwordx4 v124, s[44:47], s53 offen lds
  buffer_load_dwordx4 v125, s[44:47], s53 offen lds
  s_mov_b32 m0, 73728
  s_nop 0
  buffer_load_dwordx4 v124, s[44:47], s53 offen lds
  buffer_load_dwordx4 v125, s[44:47], s53 offen lds
  s_mov_b32 m0, 73728
  s_nop 0
  buffer_load_dwordx4 v124, s[44:47], s53 offen lds
  buffer_load_dwordx4 v125, s[44:47], s53 offen lds
  buffer_load_dwordx4 v[48:51], v122, s[40:43], s52 offen offset:0
  buffer_load_dwordx4 v[52:55], v122, s[40:43], s52 offen offset:1024
  buffer_load_dwordx4 v[56:59], v122, s[40:43], s52 offen offset:2048
  buffer_load_dwordx4 v[60:63], v122, s[40:43], s52 offen offset:3072
  s_add_u32 s52, s52, 4096
  s_mov_b32 m0, 73728
  s_nop 0
  buffer_load_dwordx4 v124, s[44:47], s53 offen lds
  buffer_load_dwordx4 v125, s[44:47], s53 offen lds
  buffer_load_dwordx4 v[64:67], v122, s[40:43], s52 offen offset:0
  buffer_load_dwordx4 v[68:71], v122, s[40:43], s52 offen offset:1024
  buffer_load_dwordx4 v[72:75], v122, s[40:43], s52 offen offset:2048
  buffer_load_dwordx4 v[76:79], v122, s[40:43], s52 offen offset:3072
  s_add_u32 s52, s52, 4096
  s_mov_b32 m0, 73728
  s_nop 0
  buffer_load_dwordx4 v124, s[44:47], s53 offen lds
  buffer_load_dwordx4 v125, s[44:47], s53 offen lds
  buffer_load_dwordx4 v[80:83], v122, s[40:43], s52 offen offset:0
  buffer_load_dwordx4 v[84:87], v122, s[40:43], s52 offen offset:1024
  buffer_load_dwordx4 v[88:91], v122, s[40:43], s52 offen offset:2048
  buffer_load_dwordx4 v[92:95], v122, s[40:43], s52 offen offset:3072
  s_add_u32 s52, s52, 4096
  s_waitcnt vmcnt(18)
  s_barrier
  ds_read_b64_tr_b16 v[96:97], v126 offset:0
  ds_read_b64_tr_b16 v[98:99], v126 offset:256
  ds_read_b64_tr_b16 v[100:101], v126 offset:4096
  ds_read_b64_tr_b16 v[102:103], v126 offset:4352
  ds_read_b64_tr_b16 v[104:105], v126 offset:8192
  ds_read_b64_tr_b16 v[106:107], v126 offset:8448
G2_LOOPB:
  s_waitcnt vmcnt(12)
  ds_read_b64_tr_b16 v[108:109], v126 offset:1024
  ds_read_b64_tr_b16 v[110:111], v126 offset:1280
  ds_read_b64_tr_b16 v[112:113], v126 offset:5120
  ds_read_b64_tr_b16 v[114:115], v126 offset:5376
  ds_read_b64_tr_b16 v[116:117], v126 offset:9216
  ds_read_b64_tr_b16 v[118:119], v126 offset:9472
  s_waitcnt lgkmcnt(6)
  v_mfma_f32_32x32x16_bf16 v[0:15], v[96:99], v[48:51], v[0:15]
  v_mfma_f32_32x32x16_bf16 v[16:31], v[100:103], v[48:51], v[16:31]
  v_mfma_f32_32x32x16_bf16 v[32:47], v[104:107], v[48:51], v[32:47]
  ds_read_b64_tr_b16 v[96:97], v126 offset:2048
  ds_read_b64_tr_b16 v[98:99], v126 offset:2304
  ds_read_b64_tr_b16 v[100:101], v126 offset:6144
  ds_read_b64_tr_b16 v[102:103], v126 offset:6400
  ds_read_b64_tr_b16 v[104:105], v126 offset:10240
  ds_read_b64_tr_b16 v[106:107], v126 offset:10496
  s_waitcnt lgkmcnt(6)
  v_mfma_f32_32x32x16_bf16 v[0:15], v[108:111], v[52:55], v[0:15]
  v_mfma_f32_32x32x16_bf16 v[16:31], v[112:115], v[52:55], v[16:31]
  v_mfma_f32_32x32x16_bf16 v[32:47], v[116:119], v[52:55], v[32:47]
  s_waitcnt vmcnt(22)
  s_barrier
  s_mov_b32 m0, 73728
  s_nop 0
  buffer_load_dwordx4 v124, s[44:47], s53 offen lds
  buffer_load_dwordx4 v125, s[44:47], s53 offen lds
  ds_read_b64_tr_b16 v[108:109], v126 offset:3072
  ds_read_b64_tr_b16 v[110:111], v126 offset:3328
  ds_read_b64_tr_b16 v[112:113], v126 offset:7168
  ds_read_b64_tr_b16 v[114:115], v126 offset:7424
  ds_read_b64_tr_b16 v[116:117], v126 offset:11264
  ds_read_b64_tr_b16 v[118:119], v126 offset:11520
  s_waitcnt lgkmcnt(6)
  v_mfma_f32_32x32x16_bf16 v[0:15], v[96:99], v[56:59], v[0:15]
  v_mfma_f32_32x32x16_bf16 v[16:31], v[100:103], v[56:59], v[16:31]
  v_mfma_f32_32x32x16_bf16 v[32:47], v[104:107], v[56:59], v[32:47]
  ds_read_b64_tr_b16 v[96:97], v126 offset:12288
  ds_read_b64_tr_b16 v[98:99], v126 offset:12544
  ds_read_b64_tr_b16 v[100:101], v126 offset:16384
  ds_read_b64_tr_b16 v[102:103], v126 offset:16640
  ds_read_b64_tr_b16 v[104:105], v126 offset:20480
  ds_read_b64_tr_b16 v[106:107], v126 offset:20736
  s_waitcnt lgkmcnt(6)
  v_mfma_f32_32x32x16_bf16 v[0:15], v[108:111], v[60:63], v[0:15]
  v_mfma_f32_32x32x16_bf16 v[16:31], v[112:115], v[60:63], v[16:31]
  v_mfma_f32_32x32x16_bf16 v[32:47], v[116:119], v[60:63], v[32:47]
  buffer_load_dwordx4 v[48:51], v122, s[40:43], s52 offen offset:0
  buffer_load_dwordx4 v[52:55], v122, s[40:43], s52 offen offset:1024
  buffer_load_dwordx4 v[56:59], v122, s[40:43], s52 offen offset:2048
  buffer_load_dwordx4 v[60:63], v122, s[40:43], s52 offen offset:3072
  s_add_u32 s52, s52, 4096
  s_sub_u32 s30, s30, 1
  s_cmp_eq_u32 s30, 0
  s_cbranch_scc1 G2_EPI
  s_waitcnt vmcnt(12)
  ds_read_b64_tr_b16 v[108:109], v126 offset:13312
  ds_read_b64_tr_b16 v[110:111], v126 offset:13568
  ds_read_b64_tr_b16 v[112:113], v126 offset:17408
  ds_read_b64_tr_b16 v[114:115], v126 offset:17664
  ds_read_b64_tr_b16 v[116:117], v126 offset:21504
  ds_read_b64_tr_b16 v[118:119], v126 offset:21760
  s_waitcnt lgkmcnt(6)
  v_mfma_f32_32x32x16_bf16 v[0:15], v[96:99], v[64:67], v[0:15]
  v_mfma_f32_32x32x16_bf16 v[16:31], v[100:103], v[64:67], v[16:31]
  v_mfma_f32_32x32x16_bf16 v[32:47], v[104:107], v[64:67], v[32:47]
  ds_read_b64_tr_b16 v[96:97], v126 offset:14336
  ds_read_b64_tr_b16 v[98:99], v126 offset:14592
  ds_read_b64_tr_b16 v[100:101], v126 offset:18432
  ds_read_b64_tr_b16 v[102:103], v126 offset:18688
  ds_read_b64_tr_b16 v[104:105], v126 offset:22528
  ds_read_b64_tr_b16 v[106:107], v126 offset:22784
  s_waitcnt lgkmcnt(6)
  v_mfma_f32_32x32x16_bf16 v[0:15], v[108:111], v[68:71], v[0:15]
  v_mfma_f32_32x32x16_bf16 v[16:31], v[112:115], v[68:71], v[16:31]
  v_mfma_f32_32x32x16_bf16 v[32:47], v[116:119], v[68:71], v[32:47]
  s_waitcnt vmcnt(22)
  s_barrier
  s_mov_b32 m0, 73728
  s_nop 0
  buffer_load_dwordx4 v124, s[44:47], s53 offen lds
  buffer_load_dwordx4 v125, s[44:47], s53 offen lds
  ds_read_b64_tr_b16 v[108:109], v126 offset:15360
  ds_read_b64_tr_b16 v[110:111], v126 offset:15616
  ds_read_b64_tr_b16 v[112:113], v126 offset:19456
  ds_read_b64_tr_b16 v[114:115], v126 offset:19712
  ds_read_b64_tr_b16 v[116:117], v126 offset:23552
  ds_read_b64_tr_b16 v[118:119], v126 offset:23808
  s_waitcnt lgkmcnt(6)
  v_mfma_f32_32x32x16_bf16 v[0:15], v[96:99], v[72:75], v[0:15]
  v_mfma_f32_32x32x16_bf16 v[16:31], v[100:103], v[72:75], v[16:31]
  v_mfma_f32_32x32x16_bf16 v[32:47], v[104:107], v[72:75], v[32:47]
  ds_read_b64_tr_b16 v[96:97], v126 offset:24576
  ds_read_b64_tr_b16 v[98:99], v126 offset:24832
  ds_read_b64_tr_b16 v[100:101], v126 offset:28672
  ds_read_b64_tr_b16 v[102:103], v126 offset:28928
  ds_read_b64_tr_b16 v[104:105], v126 offset:32768
  ds_read_b64_tr_b16 v[106:107], v126 offset:33024
  s_waitcnt lgkmcnt(6)
  v_mfma_f32_32x32x16_bf16 v[0:15], v[108:111], v[76:79], v[0:15]
  v_mfma_f32_32x32x16_bf16 v[16:31], v[112:115], v[76:79], v[16:31]
  v_mfma_f32_32x32x16_bf16 v[32:47], v[116:119], v[76:79], v[32:47]
  buffer_load_dwordx4 v[64:67], v122, s[40:43], s52 offen offset:0
  buffer_load_dwordx4 v[68:71], v122, s[40:43], s52 offen offset:1024
  buffer_load_dwordx4 v[72:75], v122, s[40:43], s52 offen offset:2048
  buffer_load_dwordx4 v[76:79], v122, s[40:43], s52 offen offset:3072
  s_add_u32 s52, s52, 4096
  s_sub_u32 s30, s30, 1
  s_cmp_eq_u32 s30, 0
  s_cbranch_scc1 G2_EPI
  s_waitcnt vmcnt(12)
  ds_read_b64_tr_b16 v[108:109], v126 offset:25600
  ds_read_b64_tr_b16 v[110:111], v126 offset:25856
  ds_read_b64_tr_b16 v[112:113], v126 offset:29696
  ds_read_b64_tr_b16 v[114:115], v126 offset:29952
  ds_read_b64_tr_b16 v[116:117], v126 offset:33792
  ds_read_b64_tr_b16 v[118:119], v126 offset:34048
  s_waitcnt lgkmcnt(6)
  v_mfma_f32_32x32x16_bf16 v[0:15], v[96:99], v[80:83], v[0:15]
  v_mfma_f32_32x32x16_bf16 v[16:31], v[100:103], v[80:83], v[16:31]
  v_mfma_f32_32x32x16_bf16 v[32:47], v[104:107], v[80:83], v[32:47]
  ds_read_b64_tr_b16 v[96:97], v126 offset:26624
  ds_read_b64_tr_b16 v[98:99], v126 offset:26880
  ds_read_b64_tr_b16 v[100:101], v126 offset:30720
  ds_read_b64_tr_b16 v[102:103], v126 offset:30976
  ds_read_b64_tr_b16 v[104:105], v126 offset:34816
  ds_read_b64_tr_b16 v[106:107], v126 offset:35072
  s_waitcnt lgkmcnt(6)
  v_mfma_f32_32x32x16_bf16 v[0:15], v[108:111], v[84:87], v[0:15]
  v_mfma_f32_32x32x16_bf16 v[16:31], v[112:115], v[84:87], v[16:31]
  v_mfma_f32_32x32x16_bf16 v[32:47], v[116:119], v[84:87], v[32:47]
  s_waitcnt vmcnt(22)
  s_barrier
  s_mov_b32 m0, 73728
  s_nop 0
  buffer_load_dwordx4 v124, s[44:47], s53 offen lds
  buffer_load_dwordx4 v125, s[44:47], s53 offen lds
  ds_read_b64_tr_b16 v[108:109], v126 offset:27648
  ds_read_b64_tr_b16 v[110:111], v126 offset:27904
  ds_read_b64_tr_b16 v[112:113], v126 offset:31744
  ds_read_b64_tr_b16 v[114:115], v126 offset:32000
  ds_read_b64_tr_b16 v[116:117], v126 offset:35840
  ds_read_b64_tr_b16 v[118:119], v126 offset:36096
  s_waitcnt lgkmcnt(6)
  v_mfma_f32_32x32x16_bf16 v[0:15], v[96:99], v[88:91], v[0:15]
  v_mfma_f32_32x32x16_bf16 v[16:31], v[100:103], v[88:91], v[16:31]
  v_mfma_f32_32x32x16_bf16 v[32:47], v[104:107], v[88:91], v[32:47]
  ds_read_b64_tr_b16 v[96:97], v127 offset:0
  ds_read_b64_tr_b16 v[98:99], v127 offset:256
  ds_read_b64_tr_b16 v[100:101], v127 offset:4096
  ds_read_b64_tr_b16 v[102:103], v127 offset:4352
  ds_read_b64_tr_b16 v[104:105], v127 offset:8192
  ds_read_b64_tr_b16 v[106:107], v127 offset:8448
  s_waitcnt lgkmcnt(6)
  v_mfma_f32_32x32x16_bf16 v[0:15], v[108:111], v[92:95], v[0:15]
  v_mfma_f32_32x32x16_bf16 v[16:31], v[112:115], v[92:95], v[16:31]
  v_mfma_f32_32x32x16_bf16 v[32:47], v[116:119], v[92:95], v[32:47]
  buffer_load_dwordx4 v[80:83], v122, s[40:43], s52 offen offset:0
  buffer_load_dwordx4 v[84:87], v122, s[40:43], s52 offen offset:1024
  buffer_load_dwordx4 v[88:91], v122, s[40:43], s52 offen offset:2048
  buffer_load_dwordx4 v[92:95], v122, s[40:43], s52 offen offset:3072
  s_add_u32 s52, s52, 4096
  s_sub_u32 s30, s30, 1
  s_cmp_eq_u32 s30, 0
  s_cbranch_scc1 G2_EPI
  s_waitcnt vmcnt(12)
  ds_read_b64_tr_b16 v[108:109], v127 offset:1024
  ds_read_b64_tr_b16 v[110:111], v127 offset:1280
  ds_read_b64_tr_b16 v[112:113], v127 offset:5120
  ds_read_b64_tr_b16 v[114:115], v127 offset:5376
  ds_read_b64_tr_b16 v[116:117], v127 offset:9216
  ds_read_b64_tr_b16 v[118:119], v127 offset:9472
  s_waitcnt lgkmcnt(6)
  v_mfma_f32_32x32x16_bf16 v[0:15], v[96:99], v[48:51], v[0:15]
  v_mfma_f32_32x32x16_bf16 v[16:31], v[100:103], v[48:51], v[16:31]
  v_mfma_f32_32x32x16_bf16 v[32:47], v[104:107], v[48:51], v[32:47]
  ds_read_b64_tr_b16 v[96:97], v127 offset:2048
  ds_read_b64_tr_b16 v[98:99], v127 offset:2304
  ds_read_b64_tr_b16 v[100:101], v127 offset:6144
  ds_read_b64_tr_b16 v[102:103], v127 offset:6400
  ds_read_b64_tr_b16 v[104:105], v127 offset:10240
  ds_read_b64_tr_b16 v[106:107], v127 offset:10496
  s_waitcnt lgkmcnt(6)
  v_mfma_f32_32x32x16_bf16 v[0:15], v[108:111], v[52:55], v[0:15]
  v_mfma_f32_32x32x16_bf16 v[16:31], v[112:115], v[52:55], v[16:31]
  v_mfma_f32_32x32x16_bf16 v[32:47], v[116:119], v[52:55], v[32:47]
  s_waitcnt vmcnt(22)
  s_barrier
  s_mov_b32 m0, 73728
  s_nop 0
  buffer_load_dwordx4 v124, s[44:47], s53 offen lds
  buffer_load_dwordx4 v125, s[44:47], s53 offen lds
  ds_read_b64_tr_b16 v[108:109], v127 offset:3072
  ds_read_b64_tr_b16 v[110:111], v127 offset:3328
  ds_read_b64_tr_b16 v[112:113], v127 offset:7168
  ds_read_b64_tr_b16 v[114:115], v127 offset:7424
  ds_read_b64_tr_b16 v[116:117], v127 offset:11264
  ds_read_b64_tr_b16 v[118:119], v127 offset:11520
  s_waitcnt lgkmcnt(6)
  v_mfma_f32_32x32x16_bf16 v[0:15], v[96:99], v[56:59], v[0:15]
  v_mfma_f32_32x32x16_bf16 v[16:31], v[100:103], v[56:59], v[16:31]
  v_mfma_f32_32x32x16_bf16 v[32:47], v[104:107], v[56:59], v[32:47]
  ds_read_b64_tr_b16 v[96:97], v127 offset:12288
  ds_read_b64_tr_b16 v[98:99], v127 offset:12544
  ds_read_b64_tr_b16 v[100:101], v127 offset:16384
  ds_read_b64_tr_b16 v[102:103], v127 offset:16640
  ds_read_b64_tr_b16 v[104:105], v127 offset:20480
  ds_read_b64_tr_b16 v[106:107], v127 offset:20736
  s_waitcnt lgkmcnt(6)
  v_mfma_f32_32x32x16_bf16 v[0:15], v[108:111], v[60:63], v[0:15]
  v_mfma_f32_32x32x16_bf16 v[16:31], v[112:115], v[60:63], v[16:31]
  v_mfma_f32_32x32x16_bf16 v[32:47], v[116:119], v[60:63], v[32:47]
  buffer_load_dwordx4 v[48:51], v122, s[40:43], s52 offen offset:0
  buffer_load_dwordx4 v[52:55], v122, s[40:43], s52 offen offset:1024
  buffer_load_dwordx4 v[56:59], v122, s[40:43], s52 offen offset:2048
  buffer_load_dwordx4 v[60:63], v122, s[40:43], s52 offen offset:3072
  s_add_u32 s52, s52, 4096
  s_sub_u32 s30, s30, 1
  s_cmp_eq_u32 s30, 0
  s_cbranch_scc1 G2_EPI
  s_waitcnt vmcnt(12)
  ds_read_b64_tr_b16 v[108:109], v127 offset:13312
  ds_read_b64_tr_b16 v[110:111], v127 offset:13568
  ds_read_b64_tr_b16 v[112:113], v127 offset:17408
  ds_read_b64_tr_b16 v[114:115], v127 offset:17664
  ds_read_b64_tr_b16 v[116:117], v127 offset:21504
  ds_read_b64_tr_b16 v[118:119], v127 offset:21760
  s_waitcnt lgkmcnt(6)
  v_mfma_f32_32x32x16_bf16 v[0:15], v[96:99], v[64:67], v[0:15]
  v_mfma_f32_32x32x16_bf16 v[16:31], v[100:103], v[64:67], v[16:31]
  v_mfma_f32_32x32x16_bf16 v[32:47], v[104:107], v[64:67], v[32:47]
  ds_read_b64_tr_b16 v[96:97], v127 offset:14336
  ds_read_b64_tr_b16 v[98:99], v127 offset:14592
  ds_read_b64_tr_b16 v[100:101], v127 offset:18432
  ds_read_b64_tr_b16 v[102:103], v127 offset:18688
  ds_read_b64_tr_b16 v[104:105], v127 offset:22528
  ds_read_b64_tr_b16 v[106:107], v127 offset:22784
  s_waitcnt lgkmcnt(6)
  v_mfma_f32_32x32x16_bf16 v[0:15], v[108:111], v[68:71], v[0:15]
  v_mfma_f32_32x32x16_bf16 v[16:31], v[112:115], v[68:71], v[16:31]
  v_mfma_f32_32x32x16_bf16 v[32:47], v[116:119], v[68:71], v[32:47]
  s_waitcnt vmcnt(22)
  s_barrier
  s_mov_b32 m0, 73728
  s_nop 0
  buffer_load_dwordx4 v124, s[44:47], s53 offen lds
  buffer_load_dwordx4 v125, s[44:47], s53 offen lds
  ds_read_b64_tr_b16 v[108:109], v127 offset:15360
  ds_read_b64_tr_b16 v[110:111], v127 offset:15616
  ds_read_b64_tr_b16 v[112:113], v127 offset:19456
  ds_read_b64_tr_b16 v[114:115], v127 offset:19712
  ds_read_b64_tr_b16 v[116:117], v127 offset:23552
  ds_read_b64_tr_b16 v[118:119], v127 offset:23808
  s_waitcnt lgkmcnt(6)
  v_mfma_f32_32x32x16_bf16 v[0:15], v[96:99], v[72:75], v[0:15]
  v_mfma_f32_32x32x16_bf16 v[16:31], v[100:103], v[72:75], v[16:31]
  v_mfma_f32_32x32x16_bf16 v[32:47], v[104:107], v[72:75], v[32:47]
  ds_read_b64_tr_b16 v[96:97], v127 offset:24576
  ds_read_b64_tr_b16 v[98:99], v127 offset:24832
  ds_read_b64_tr_b16 v[100:101], v127 offset:28672
  ds_read_b64_tr_b16 v[102:103], v127 offset:28928
  ds_read_b64_tr_b16 v[104:105], v127 offset:32768
  ds_read_b64_tr_b16 v[106:107], v127 offset:33024
  s_waitcnt lgkmcnt(6)
  v_mfma_f32_32x32x16_bf16 v[0:15], v[108:111], v[76:79], v[0:15]
  v_mfma_f32_32x32x16_bf16 v[16:31], v[112:115], v[76:79], v[16:31]
  v_mfma_f32_32x32x16_bf16 v[32:47], v[116:119], v[76:79], v[32:47]
  buffer_load_dwordx4 v[64:67], v122, s[40:43], s52 offen offset:0
  buffer_load_dwordx4 v[68:71], v122, s[40:43], s52 offen offset:1024
  buffer_load_dwordx4 v[72:75], v122, s[40:43], s52 offen offset:2048
  buffer_load_dwordx4 v[76:79], v122, s[40:43], s52 offen offset:3072
  s_add_u32 s52, s52, 4096
  s_sub_u32 s30, s30, 1
  s_cmp_eq_u32 s30, 0
  s_cbranch_scc1 G2_EPI
  s_waitcnt vmcnt(12)
  ds_read_b64_tr_b16 v[108:109], v127 offset:25600
  ds_read_b64_tr_b16 v[110:111], v127 offset:25856
  ds_read_b64_tr_b16 v[112:113], v127 offset:29696
  ds_read_b64_tr_b16 v[114:115], v127 offset:29952
  ds_read_b64_tr_b16 v[116:117], v127 offset:33792
  ds_read_b64_tr_b16 v[118:119], v127 offset:34048
  s_waitcnt lgkmcnt(6)
  v_mfma_f32_32x32x16_bf16 v[0:15], v[96:99], v[80:83], v[0:15]
  v_mfma_f32_32x32x16_bf16 v[16:31], v[100:103], v[80:83], v[16:31]
  v_mfma_f32_32x32x16_bf16 v[32:47], v[104:107], v[80:83], v[32:47]
  ds_read_b64_tr_b16 v[96:97], v127 offset:26624
  ds_read_b64_tr_b16 v[98:99], v127 offset:26880
  ds_read_b64_tr_b16 v[100:101], v127 offset:30720
  ds_read_b64_tr_b16 v[102:103], v127 offset:30976
  ds_read_b64_tr_b16 v[104:105], v127 offset:34816
  ds_read_b64_tr_b16 v[106:107], v127 offset:35072
  s_waitcnt lgkmcnt(6)
  v_mfma_f32_32x32x16_bf16 v[0:15], v[108:111], v[84:87], v[0:15]
  v_mfma_f32_32x32x16_bf16 v[16:31], v[112:115], v[84:87], v[16:31]
  v_mfma_f32_32x32x16_bf16 v[32:47], v[116:119], v[84:87], v[32:47]
  s_waitcnt vmcnt(22)
  s_barrier
  s_mov_b32 m0, 73728
  s_nop 0
  buffer_load_dwordx4 v124, s[44:47], s53 offen lds
  buffer_load_dwordx4 v125, s[44:47], s53 offen lds
  ds_read_b64_tr_b16 v[108:109], v127 offset:27648
  ds_read_b64_tr_b16 v[110:111], v127 offset:27904
  ds_read_b64_tr_b16 v[112:113], v127 offset:31744
  ds_read_b64_tr_b16 v[114:115], v127 offset:32000
  ds_read_b64_tr_b16 v[116:117], v127 offset:35840
  ds_read_b64_tr_b16 v[118:119], v127 offset:36096
  s_waitcnt lgkmcnt(6)
  v_mfma_f32_32x32x16_bf16 v[0:15], v[96:99], v[88:91], v[0:15]
  v_mfma_f32_32x32x16_bf16 v[16:31], v[100:103], v[88:91], v[16:31]
  v_mfma_f32_32x32x16_bf16 v[32:47], v[104:107], v[88:91], v[32:47]
  ds_read_b64_tr_b16 v[96:97], v126 offset:0
  ds_read_b64_tr_b16 v[98:99], v126 offset:256
  ds_read_b64_tr_b16 v[100:101], v126 offset:4096
  ds_read_b64_tr_b16 v[102:103], v126 offset:4352
  ds_read_b64_tr_b16 v[104:105], v126 offset:8192
  ds_read_b64_tr_b16 v[106:107], v126 offset:8448
  s_waitcnt lgkmcnt(6)
  v_mfma_f32_32x32x16_bf16 v[0:15], v[108:111], v[92:95], v[0:15]
  v_mfma_f32_32x32x16_bf16 v[16:31], v[112:115], v[92:95], v[16:31]
  v_mfma_f32_32x32x16_bf16 v[32:47], v[116:119], v[92:95], v[32:47]
  buffer_load_dwordx4 v[80:83], v122, s[40:43], s52 offen offset:0
  buffer_load_dwordx4 v[84:87], v122, s[40:43], s52 offen offset:1024
  buffer_load_dwordx4 v[88:91], v122, s[40:43], s52 offen offset:2048
  buffer_load_dwordx4 v[92:95], v122, s[40:43], s52 offen offset:3072
  s_add_u32 s52, s52, 4096
  s_sub_u32 s30, s30, 1
  s_cmp_eq_u32 s30, 0
  s_cbranch_scc1 G2_EPI
  s_branch G2_LOOPB
G2_EPI:

  s_waitcnt vmcnt(0) lgkmcnt(0)
  s_nop 15
  s_mul_i32 s29, s28, 2359296
  s_add_u32 s29, s29, 50331648
  s_add_u32 s60, s10, s29
  s_addc_u32 s61, s11, 0
  s_and_b32 s61, s61, 0xffff
  s_mov_b32 s62, 2359296
  s_mov_b32 s63, 0x00020000
  s_lshl_b32 s59, s12, 3
  s_add_u32 s59, s59, s56
  s_mul_i32 s59, s59, 18
  s_mul_i32 s58, s13, 3
  s_add_u32 s59, s59, s58
  s_lshl_b32 s59, s59, 11
  v_lshl_add_u32 v121, v120, 4, s59

  v_cvt_pk_bf16_f32 v48, v0, v1
  v_cvt_pk_bf16_f32 v49, v2, v3
  v_cvt_pk_bf16_f32 v50, v4, v5
  v_cvt_pk_bf16_f32 v51, v6, v7
  s_mov_b32 s58, 0
  buffer_store_dwordx4 v[48:51], v121, s[60:63], s58 offen offset:0
  v_cvt_pk_bf16_f32 v52, v8, v9
  v_cvt_pk_bf16_f32 v53, v10, v11
  v_cvt_pk_bf16_f32 v54, v12, v13
  v_cvt_pk_bf16_f32 v55, v14, v15
  s_mov_b32 s58, 0
  buffer_store_dwordx4 v[52:55], v121, s[60:63], s58 offen offset:1024
  v_cvt_pk_bf16_f32 v56, v16, v17
  v_cvt_pk_bf16_f32 v57, v18, v19
  v_cvt_pk_bf16_f32 v58, v20, v21
  v_cvt_pk_bf16_f32 v59, v22, v23
  s_mov_b32 s58, 2048
  buffer_store_dwordx4 v[56:59], v121, s[60:63], s58 offen offset:0
  v_cvt_pk_bf16_f32 v60, v24, v25
  v_cvt_pk_bf16_f32 v61, v26, v27
  v_cvt_pk_bf16_f32 v62, v28, v29
  v_cvt_pk_bf16_f32 v63, v30, v31
  s_mov_b32 s58, 2048
  buffer_store_dwordx4 v[60:63], v121, s[60:63], s58 offen offset:1024
  v_cvt_pk_bf16_f32 v64, v32, v33
  v_cvt_pk_bf16_f32 v65, v34, v35
  v_cvt_pk_bf16_f32 v66, v36, v37
  v_cvt_pk_bf16_f32 v67, v38, v39
  s_mov_b32 s58, 4096
  buffer_store_dwordx4 v[64:67], v121, s[60:63], s58 offen offset:0
  v_cvt_pk_bf16_f32 v68, v40, v41
  v_cvt_pk_bf16_f32 v69, v42, v43
  v_cvt_pk_bf16_f32 v70, v44, v45
  v_cvt_pk_bf16_f32 v71, v46, v47
  s_mov_b32 s58, 4096
  buffer_store_dwordx4 v[68:71], v121, s[60:63], s58 offen offset:1024
  s_branch G2_DONE
  s_waitcnt vmcnt(0) lgkmcnt(0)
  s_barrier
  s_cmp_lg_u32 s56, 0
  s_cbranch_scc1 G2_W
  s_mov_b32 s64, s10
  s_and_b32 s65, s11, 0xffff
  s_mov_b32 s66, 268435456
  s_mov_b32 s67, 0x00020000
  s_mul_i32 s58, s12, 6
  s_add_u32 s58, s58, s13
  s_lshl_b32 s58, s58, 2
  s_add_u32 s58, s58, 49283072
  v_mov_b32 v122, s58
  v_mov_b32 v123, 1
  v_mov_b32 v124, 0
  s_mov_b64 exec, 1
  buffer_atomic_add v123, v122, s[64:67], 0 offen sc0 sc1
  s_waitcnt vmcnt(0)
  ds_write_b32 v124, v123
  s_mov_b64 exec, -1
  s_waitcnt lgkmcnt(0)
G2_W:
  s_barrier
  v_mov_b32 v124, 0
  ds_read_b32 v123, v124
  s_waitcnt lgkmcnt(0)
  v_readfirstlane_b32 s58, v123
  s_mul_hi_u32 s59, s58, 0xcccccccd
  s_lshr_b32 s59, s59, 2
  s_mul_i32 s59, s59, 5
  s_sub_u32 s58, s58, s59
  s_cmp_lg_u32 s58, 4
  s_cbranch_scc1 G2_DONE
  s_add_u32 s60, s10, 50331648
  s_addc_u32 s61, s11, 0
  s_and_b32 s61, s61, 0xffff
  s_mov_b32 s62, 11796480
  v_add_u32 v122, 4096, v121

  s_add_u32 s28, s28, 1
  s_cmp_ge_u32 s28, 5
  s_cselect_b32 s28, 0, s28
  s_mul_i32 s84, s28, 2359296

  s_add_u32 s28, s28, 1
  s_cmp_ge_u32 s28, 5
  s_cselect_b32 s28, 0, s28
  s_mul_i32 s85, s28, 2359296

  s_add_u32 s28, s28, 1
  s_cmp_ge_u32 s28, 5
  s_cselect_b32 s28, 0, s28
  s_mul_i32 s86, s28, 2359296

  s_add_u32 s28, s28, 1
  s_cmp_ge_u32 s28, 5
  s_cselect_b32 s28, 0, s28
  s_mul_i32 s87, s28, 2359296

  buffer_load_dwordx4 v[48:51], v121, s[60:63], s84 offen offset:0 sc0 sc1
  buffer_load_dwordx4 v[52:55], v121, s[60:63], s84 offen offset:1024 sc0 sc1
  buffer_load_dwordx4 v[56:59], v121, s[60:63], s84 offen offset:2048 sc0 sc1
  buffer_load_dwordx4 v[60:63], v121, s[60:63], s84 offen offset:3072 sc0 sc1
  buffer_load_dwordx4 v[64:67], v122, s[60:63], s84 offen offset:0 sc0 sc1
  buffer_load_dwordx4 v[68:71], v122, s[60:63], s84 offen offset:1024 sc0 sc1
  buffer_load_dwordx4 v[72:75], v121, s[60:63], s85 offen offset:0 sc0 sc1
  buffer_load_dwordx4 v[76:79], v121, s[60:63], s85 offen offset:1024 sc0 sc1
  buffer_load_dwordx4 v[80:83], v121, s[60:63], s85 offen offset:2048 sc0 sc1
  buffer_load_dwordx4 v[84:87], v121, s[60:63], s85 offen offset:3072 sc0 sc1
  buffer_load_dwordx4 v[88:91], v122, s[60:63], s85 offen offset:0 sc0 sc1
  buffer_load_dwordx4 v[92:95], v122, s[60:63], s85 offen offset:1024 sc0 sc1
  buffer_load_dwordx4 v[96:99], v121, s[60:63], s86 offen offset:0 sc0 sc1
  buffer_load_dwordx4 v[100:103], v121, s[60:63], s86 offen offset:1024 sc0 sc1
  buffer_load_dwordx4 v[104:107], v121, s[60:63], s86 offen offset:2048 sc0 sc1
  buffer_load_dwordx4 v[108:111], v121, s[60:63], s86 offen offset:3072 sc0 sc1
  v_lshrrev_b32 v124, 5, v120
  v_and_b32 v123, 31, v120
  v_lshlrev_b32 v124, 2, v124
  v_sub_u32 v123, v123, v124
  v_mov_b32 v124, 0x3f80
  v_mov_b32 v125, 0x3f800000

  v_cmp_eq_u32 vcc, 0, v123
  v_cndmask_b32 v112, 0, v124, vcc
  v_cmp_eq_u32 vcc, 1, v123
  v_cndmask_b32 v112, v112, v125, vcc
  v_cmp_eq_u32 vcc, 2, v123
  v_cndmask_b32 v113, 0, v124, vcc
  v_cmp_eq_u32 vcc, 3, v123
  v_cndmask_b32 v113, v113, v125, vcc
  v_cmp_eq_u32 vcc, 8, v123
  v_cndmask_b32 v114, 0, v124, vcc
  v_cmp_eq_u32 vcc, 9, v123
  v_cndmask_b32 v114, v114, v125, vcc
  v_cmp_eq_u32 vcc, 10, v123
  v_cndmask_b32 v115, 0, v124, vcc
  v_cmp_eq_u32 vcc, 11, v123
  v_cndmask_b32 v115, v115, v125, vcc
  v_cmp_eq_u32 vcc, 16, v123
  v_cndmask_b32 v116, 0, v124, vcc
  v_cmp_eq_u32 vcc, 17, v123
  v_cndmask_b32 v116, v116, v125, vcc
  v_cmp_eq_u32 vcc, 18, v123
  v_cndmask_b32 v117, 0, v124, vcc
  v_cmp_eq_u32 vcc, 19, v123
  v_cndmask_b32 v117, v117, v125, vcc
  v_cmp_eq_u32 vcc, 24, v123
  v_cndmask_b32 v118, 0, v124, vcc
  v_cmp_eq_u32 vcc, 25, v123
  v_cndmask_b32 v118, v118, v125, vcc
  v_cmp_eq_u32 vcc, 26, v123
  v_cndmask_b32 v119, 0, v124, vcc
  v_cmp_eq_u32 vcc, 27, v123
  v_cndmask_b32 v119, v119, v125, vcc
  s_nop 1
  s_waitcnt vmcnt(15)
  v_mfma_f32_32x32x16_bf16 v[0:15], v[112:115], v[48:51], v[0:15]
  buffer_load_dwordx4 v[48:51], v122, s[60:63], s86 offen offset:0 sc0 sc1
  s_waitcnt vmcnt(15)
  v_mfma_f32_32x32x16_bf16 v[0:15], v[116:119], v[52:55], v[0:15]
  buffer_load_dwordx4 v[52:55], v122, s[60:63], s86 offen offset:1024 sc0 sc1
  s_waitcnt vmcnt(15)
  v_mfma_f32_32x32x16_bf16 v[16:31], v[112:115], v[56:59], v[16:31]
  buffer_load_dwordx4 v[56:59], v121, s[60:63], s87 offen offset:0 sc0 sc1
  s_waitcnt vmcnt(15)
  v_mfma_f32_32x32x16_bf16 v[16:31], v[116:119], v[60:63], v[16:31]
  buffer_load_dwordx4 v[60:63], v121, s[60:63], s87 offen offset:1024 sc0 sc1
  s_waitcnt vmcnt(15)
  v_mfma_f32_32x32x16_bf16 v[32:47], v[112:115], v[64:67], v[32:47]
  buffer_load_dwordx4 v[64:67], v121, s[60:63], s87 offen offset:2048 sc0 sc1
  s_waitcnt vmcnt(15)
  v_mfma_f32_32x32x16_bf16 v[32:47], v[116:119], v[68:71], v[32:47]
  buffer_load_dwordx4 v[68:71], v121, s[60:63], s87 offen offset:3072 sc0 sc1
  s_waitcnt vmcnt(15)
  v_mfma_f32_32x32x16_bf16 v[0:15], v[112:115], v[72:75], v[0:15]
  buffer_load_dwordx4 v[72:75], v122, s[60:63], s87 offen offset:0 sc0 sc1
  s_waitcnt vmcnt(15)
  v_mfma_f32_32x32x16_bf16 v[0:15], v[116:119], v[76:79], v[0:15]
  buffer_load_dwordx4 v[76:79], v122, s[60:63], s87 offen offset:1024 sc0 sc1
  s_waitcnt vmcnt(15)
  v_mfma_f32_32x32x16_bf16 v[16:31], v[112:115], v[80:83], v[16:31]
  s_waitcnt vmcnt(14)
  v_mfma_f32_32x32x16_bf16 v[16:31], v[116:119], v[84:87], v[16:31]
  s_waitcnt vmcnt(13)
  v_mfma_f32_32x32x16_bf16 v[32:47], v[112:115], v[88:91], v[32:47]
  s_waitcnt vmcnt(12)
  v_mfma_f32_32x32x16_bf16 v[32:47], v[116:119], v[92:95], v[32:47]
  s_waitcnt vmcnt(11)
  v_mfma_f32_32x32x16_bf16 v[0:15], v[112:115], v[96:99], v[0:15]
  s_waitcnt vmcnt(10)
  v_mfma_f32_32x32x16_bf16 v[0:15], v[116:119], v[100:103], v[0:15]
  s_waitcnt vmcnt(9)
  v_mfma_f32_32x32x16_bf16 v[16:31], v[112:115], v[104:107], v[16:31]
  s_waitcnt vmcnt(8)
  v_mfma_f32_32x32x16_bf16 v[16:31], v[116:119], v[108:111], v[16:31]
  s_waitcnt vmcnt(7)
  v_mfma_f32_32x32x16_bf16 v[32:47], v[112:115], v[48:51], v[32:47]
  s_waitcnt vmcnt(6)
  v_mfma_f32_32x32x16_bf16 v[32:47], v[116:119], v[52:55], v[32:47]
  s_waitcnt vmcnt(5)
  v_mfma_f32_32x32x16_bf16 v[0:15], v[112:115], v[56:59], v[0:15]
  s_waitcnt vmcnt(4)
  v_mfma_f32_32x32x16_bf16 v[0:15], v[116:119], v[60:63], v[0:15]
  s_waitcnt vmcnt(3)
  v_mfma_f32_32x32x16_bf16 v[16:31], v[112:115], v[64:67], v[16:31]
  s_waitcnt vmcnt(2)
  v_mfma_f32_32x32x16_bf16 v[16:31], v[116:119], v[68:71], v[16:31]
  s_waitcnt vmcnt(1)
  v_mfma_f32_32x32x16_bf16 v[32:47], v[112:115], v[72:75], v[32:47]
  s_waitcnt vmcnt(0)
  v_mfma_f32_32x32x16_bf16 v[32:47], v[116:119], v[76:79], v[32:47]
  s_nop 15
  s_nop 3
  v_cvt_pk_bf16_f32 v48, v0, v1
  v_cvt_pk_bf16_f32 v49, v2, v3
  v_cvt_pk_bf16_f32 v50, v4, v5
  v_cvt_pk_bf16_f32 v51, v6, v7
  buffer_store_dwordx4 v[48:51], v121, s[60:63], 0 offen offset:0
  v_cvt_pk_bf16_f32 v52, v8, v9
  v_cvt_pk_bf16_f32 v53, v10, v11
  v_cvt_pk_bf16_f32 v54, v12, v13
  v_cvt_pk_bf16_f32 v55, v14, v15
  buffer_store_dwordx4 v[52:55], v121, s[60:63], 0 offen offset:1024
  v_cvt_pk_bf16_f32 v56, v16, v17
  v_cvt_pk_bf16_f32 v57, v18, v19
  v_cvt_pk_bf16_f32 v58, v20, v21
  v_cvt_pk_bf16_f32 v59, v22, v23
  buffer_store_dwordx4 v[56:59], v121, s[60:63], 0 offen offset:2048
  v_cvt_pk_bf16_f32 v60, v24, v25
  v_cvt_pk_bf16_f32 v61, v26, v27
  v_cvt_pk_bf16_f32 v62, v28, v29
  v_cvt_pk_bf16_f32 v63, v30, v31
  buffer_store_dwordx4 v[60:63], v121, s[60:63], 0 offen offset:3072
  v_cvt_pk_bf16_f32 v64, v32, v33
  v_cvt_pk_bf16_f32 v65, v34, v35
  v_cvt_pk_bf16_f32 v66, v36, v37
  v_cvt_pk_bf16_f32 v67, v38, v39
  buffer_store_dwordx4 v[64:67], v122, s[60:63], 0 offen offset:0
  v_cvt_pk_bf16_f32 v68, v40, v41
  v_cvt_pk_bf16_f32 v69, v42, v43
  v_cvt_pk_bf16_f32 v70, v44, v45
  v_cvt_pk_bf16_f32 v71, v46, v47
  buffer_store_dwordx4 v[68:71], v122, s[60:63], 0 offen offset:1024
G2_DONE:
  s_waitcnt vmcnt(0) lgkmcnt(0)
G2_END:
  s_endpgm
  .globl fin_kernel
  .p2align 8
  .type fin_kernel,@function
fin_kernel:
  s_cmp_ge_u32 s2, 192
  s_cbranch_scc1 FN_END
  s_load_dwordx2 s[4:5], s[0:1], 0
  s_load_dwordx2 s[6:7], s[0:1], 56
  s_load_dwordx2 s[8:9], s[0:1], 16
  s_load_dwordx2 s[10:11], s[0:1], 72
  s_and_b32 s12, s2, 7
  s_lshr_b32 s13, s2, 3
  s_mul_i32 s14, s13, 43
  s_lshr_b32 s14, s14, 8
  s_mul_i32 s15, s14, 6
  s_sub_u32 s13, s13, s15
  s_lshl_b32 s12, s12, 2
  s_add_u32 s12, s12, s14
  v_and_b32 v230, 63, v0
  v_lshrrev_b32 v231, 6, v0
  s_nop 0
  v_readfirstlane_b32 s56, v231
  s_lshr_b32 s57, s56, 1
  s_and_b32 s58, s56, 1
  s_lshl_b32 s12, s12, 1
  s_add_u32 s12, s12, s57
  s_waitcnt lgkmcnt(0)
  s_add_u32 s40, s10, 16777216
  s_addc_u32 s41, s11, 0
  s_add_u32 s10, s10, 50331648
  s_addc_u32 s11, s11, 0

  s_mov_b32 s40, s40
  s_and_b32 s41, s41, 0xffff
  s_mov_b32 s42, 21233664
  s_mov_b32 s43, 0x00020000
  s_mov_b32 s44, s8
  s_and_b32 s45, s9, 0xffff
  s_mov_b32 s46, 663552
  s_mov_b32 s47, 0x00020000
  s_mov_b32 s16, s4
  s_and_b32 s17, s5, 0xffff
  s_mov_b32 s18, 2359296
  s_mov_b32 s19, 0x00020000
  s_mov_b32 s20, s6
  s_and_b32 s21, s7, 0xffff
  s_mov_b32 s22, 2359296
  s_mov_b32 s23, 0x00020000
  s_mov_b32 s24, s10
  s_and_b32 s25, s11, 0xffff
  s_mov_b32 s26, 11796480
  s_mov_b32 s27, 0x00020000
  v_lshrrev_b32 v231, 2, v230
  v_mul_u32_u24 v231, 1152, v231
  v_and_b32 v232, 3, v230
  v_lshl_add_u32 v231, v232, 4, v231
  s_mul_i32 s15, s13, 192
  s_mul_i32 s59, s56, 165888
  s_add_u32 s15, s15, s59
  v_add_u32 v231, s15, v231
  s_mul_i32 s54, s56, 9216
  s_mul_i32 s15, s12, 331776
  s_mul_i32 s59, s58, 18432
  s_add_u32 s15, s15, s59
  s_add_u32 s15, s15, 294912
  v_lshl_add_u32 v232, v230, 4, s15
  s_mov_b32 s53, 0

  s_add_u32 m0, s54, 0
  s_nop 0
  buffer_load_dwordx4 v231, s[44:47], s53 offen offset:0 lds
  s_add_u32 m0, s54, 36800
  s_nop 0
  buffer_load_dwordx4 v231, s[44:47], s53 offen offset:64 lds
  s_add_u32 m0, s54, 73600
  s_nop 0
  buffer_load_dwordx4 v231, s[44:47], s53 offen offset:128 lds
  s_add_u32 s53, s53, 18432
  s_add_u32 m0, s54, 1024
  s_nop 0
  buffer_load_dwordx4 v231, s[44:47], s53 offen offset:0 lds
  s_add_u32 m0, s54, 37824
  s_nop 0
  buffer_load_dwordx4 v231, s[44:47], s53 offen offset:64 lds
  s_add_u32 m0, s54, 74624
  s_nop 0
  buffer_load_dwordx4 v231, s[44:47], s53 offen offset:128 lds
  s_add_u32 s53, s53, 18432
  s_add_u32 m0, s54, 2048
  s_nop 0
  buffer_load_dwordx4 v231, s[44:47], s53 offen offset:0 lds
  s_add_u32 m0, s54, 38848
  s_nop 0
  buffer_load_dwordx4 v231, s[44:47], s53 offen offset:64 lds
  s_add_u32 m0, s54, 75648
  s_nop 0
  buffer_load_dwordx4 v231, s[44:47], s53 offen offset:128 lds
  s_add_u32 s53, s53, 18432
  s_add_u32 m0, s54, 3072
  s_nop 0
  buffer_load_dwordx4 v231, s[44:47], s53 offen offset:0 lds
  s_add_u32 m0, s54, 39872
  s_nop 0
  buffer_load_dwordx4 v231, s[44:47], s53 offen offset:64 lds
  s_add_u32 m0, s54, 76672
  s_nop 0
  buffer_load_dwordx4 v231, s[44:47], s53 offen offset:128 lds
  s_add_u32 s53, s53, 18432
  s_add_u32 m0, s54, 4096
  s_nop 0
  buffer_load_dwordx4 v231, s[44:47], s53 offen offset:0 lds
  s_add_u32 m0, s54, 40896
  s_nop 0
  buffer_load_dwordx4 v231, s[44:47], s53 offen offset:64 lds
  s_add_u32 m0, s54, 77696
  s_nop 0
  buffer_load_dwordx4 v231, s[44:47], s53 offen offset:128 lds
  s_add_u32 s53, s53, 18432
  s_add_u32 m0, s54, 5120
  s_nop 0
  buffer_load_dwordx4 v231, s[44:47], s53 offen offset:0 lds
  s_add_u32 m0, s54, 41920
  s_nop 0
  buffer_load_dwordx4 v231, s[44:47], s53 offen offset:64 lds
  s_add_u32 m0, s54, 78720
  s_nop 0
  buffer_load_dwordx4 v231, s[44:47], s53 offen offset:128 lds
  s_add_u32 s53, s53, 18432
  s_add_u32 m0, s54, 6144
  s_nop 0
  buffer_load_dwordx4 v231, s[44:47], s53 offen offset:0 lds
  s_add_u32 m0, s54, 42944
  s_nop 0
  buffer_load_dwordx4 v231, s[44:47], s53 offen offset:64 lds
  s_add_u32 m0, s54, 79744
  s_nop 0
  buffer_load_dwordx4 v231, s[44:47], s53 offen offset:128 lds
  s_add_u32 s53, s53, 18432
  s_add_u32 m0, s54, 7168
  s_nop 0
  buffer_load_dwordx4 v231, s[44:47], s53 offen offset:0 lds
  s_add_u32 m0, s54, 43968
  s_nop 0
  buffer_load_dwordx4 v231, s[44:47], s53 offen offset:64 lds
  s_add_u32 m0, s54, 80768
  s_nop 0
  buffer_load_dwordx4 v231, s[44:47], s53 offen offset:128 lds
  s_add_u32 s53, s53, 18432
  s_add_u32 m0, s54, 8192
  s_nop 0
  buffer_load_dwordx4 v231, s[44:47], s53 offen offset:0 lds
  s_add_u32 m0, s54, 44992
  s_nop 0
  buffer_load_dwordx4 v231, s[44:47], s53 offen offset:64 lds
  s_add_u32 m0, s54, 81792
  s_nop 0
  buffer_load_dwordx4 v231, s[44:47], s53 offen offset:128 lds
  s_add_u32 s53, s53, 18432
  s_mov_b32 s52, 0
  buffer_load_dwordx4 v[48:51], v232, s[40:43], s52 offen offset:0
  buffer_load_dwordx4 v[52:55], v232, s[40:43], s52 offen offset:1024
  buffer_load_dwordx4 v[56:59], v232, s[40:43], s52 offen offset:2048
  buffer_load_dwordx4 v[60:63], v232, s[40:43], s52 offen offset:3072
  s_mov_b32 s52, 4096
  buffer_load_dwordx4 v[64:67], v232, s[40:43], s52 offen offset:0
  buffer_load_dwordx4 v[68:71], v232, s[40:43], s52 offen offset:1024
  buffer_load_dwordx4 v[72:75], v232, s[40:43], s52 offen offset:2048
  buffer_load_dwordx4 v[76:79], v232, s[40:43], s52 offen offset:3072
  s_mov_b32 s52, 8192
  buffer_load_dwordx4 v[80:83], v232, s[40:43], s52 offen offset:0
  buffer_load_dwordx4 v[84:87], v232, s[40:43], s52 offen offset:1024
  buffer_load_dwordx4 v[88:91], v232, s[40:43], s52 offen offset:2048
  buffer_load_dwordx4 v[92:95], v232, s[40:43], s52 offen offset:3072
  s_mov_b32 s52, 12288
  buffer_load_dwordx4 v[96:99], v232, s[40:43], s52 offen offset:0
  buffer_load_dwordx4 v[100:103], v232, s[40:43], s52 offen offset:1024
  buffer_load_dwordx4 v[104:107], v232, s[40:43], s52 offen offset:2048
  buffer_load_dwordx4 v[108:111], v232, s[40:43], s52 offen offset:3072
  s_mov_b32 s52, 16384
  buffer_load_dwordx4 v[112:115], v232, s[40:43], s52 offen offset:0
  buffer_load_dwordx4 v[116:119], v232, s[40:43], s52 offen offset:1024
  s_mul_i32 s15, s12, 18
  s_mul_i32 s59, s13, 3
  s_add_u32 s15, s15, s59
  s_lshl_b32 s15, s15, 11
  s_mul_i32 s59, s58, 3072
  s_add_u32 s15, s15, s59
  v_lshl_add_u32 v234, v230, 4, s15

  s_mov_b32 s28, 0
  buffer_load_dwordx4 v[120:123], v234, s[24:27], s28 offen offset:0
  buffer_load_dwordx4 v[124:127], v234, s[24:27], s28 offen offset:1024
  buffer_load_dwordx4 v[128:131], v234, s[24:27], s28 offen offset:2048
  s_mov_b32 s28, 2359296
  buffer_load_dwordx4 v[132:135], v234, s[24:27], s28 offen offset:0
  buffer_load_dwordx4 v[136:139], v234, s[24:27], s28 offen offset:1024
  buffer_load_dwordx4 v[140:143], v234, s[24:27], s28 offen offset:2048
  s_mov_b32 s28, 4718592
  buffer_load_dwordx4 v[144:147], v234, s[24:27], s28 offen offset:0
  buffer_load_dwordx4 v[148:151], v234, s[24:27], s28 offen offset:1024
  buffer_load_dwordx4 v[152:155], v234, s[24:27], s28 offen offset:2048
  s_mov_b32 s28, 7077888
  buffer_load_dwordx4 v[156:159], v234, s[24:27], s28 offen offset:0
  buffer_load_dwordx4 v[160:163], v234, s[24:27], s28 offen offset:1024
  buffer_load_dwordx4 v[164:167], v234, s[24:27], s28 offen offset:2048
  s_mov_b32 s28, 9437184
  buffer_load_dwordx4 v[168:171], v234, s[24:27], s28 offen offset:0
  buffer_load_dwordx4 v[172:175], v234, s[24:27], s28 offen offset:1024
  buffer_load_dwordx4 v[176:179], v234, s[24:27], s28 offen offset:2048
  v_and_b32 v235, 31, v230
  s_lshl_b32 s15, s12, 5
  v_add_u32 v235, s15, v235
  v_mul_u32_u24 v235, 1152, v235
  v_lshrrev_b32 v236, 5, v230
  v_lshl_add_u32 v235, v236, 4, v235
  s_mul_i32 s15, s13, 192
  s_mul_i32 s59, s58, 96
  s_add_u32 s15, s15, s59
  v_add_u32 v235, s15, v235

  buffer_load_dwordx4 v[180:183], v235, s[16:19], 0 offen offset:0
  buffer_load_dwordx4 v[184:187], v235, s[16:19], 0 offen offset:32
  buffer_load_dwordx4 v[188:191], v235, s[16:19], 0 offen offset:64
  v_lshrrev_b32 v237, 5, v230
  v_bfe_u32 v238, v230, 2, 2
  v_lshl_add_u32 v237, v237, 3, v238
  v_lshlrev_b32 v237, 6, v237
  v_bfe_u32 v238, v230, 4, 1
  v_lshl_add_u32 v237, v238, 5, v237
  v_and_b32 v238, 3, v230
  v_lshl_add_u32 v237, v238, 3, v237
  s_mul_i32 s59, s58, 18432
  v_add_u32 v237, s59, v237
  v_add_u32 v238, 36864, v237
  v_add_u32 v239, 73728, v237
  s_mul_i32 s59, s56, 6144
  s_add_u32 s59, s59, 110592
  v_lshl_add_u32 v240, v230, 4, s59
  v_xor_b32 v241, 0, v240
  s_xor_b32 s60, s56, 1
  s_mul_i32 s60, s60, 6144
  s_add_u32 s60, s60, 110592
  v_lshl_add_u32 v241, v230, 4, s60

  v_mov_b32 v0, 0
  v_mov_b32 v1, 0
  v_mov_b32 v2, 0
  v_mov_b32 v3, 0
  v_mov_b32 v4, 0
  v_mov_b32 v5, 0
  v_mov_b32 v6, 0
  v_mov_b32 v7, 0
  v_mov_b32 v8, 0
  v_mov_b32 v9, 0
  v_mov_b32 v10, 0
  v_mov_b32 v11, 0
  v_mov_b32 v12, 0
  v_mov_b32 v13, 0
  v_mov_b32 v14, 0
  v_mov_b32 v15, 0
  v_mov_b32 v16, 0
  v_mov_b32 v17, 0
  v_mov_b32 v18, 0
  v_mov_b32 v19, 0
  v_mov_b32 v20, 0
  v_mov_b32 v21, 0
  v_mov_b32 v22, 0
  v_mov_b32 v23, 0
  v_mov_b32 v24, 0
  v_mov_b32 v25, 0
  v_mov_b32 v26, 0
  v_mov_b32 v27, 0
  v_mov_b32 v28, 0
  v_mov_b32 v29, 0
  v_mov_b32 v30, 0
  v_mov_b32 v31, 0
  v_mov_b32 v32, 0
  v_mov_b32 v33, 0
  v_mov_b32 v34, 0
  v_mov_b32 v35, 0
  v_mov_b32 v36, 0
  v_mov_b32 v37, 0
  v_mov_b32 v38, 0
  v_mov_b32 v39, 0
  v_mov_b32 v40, 0
  v_mov_b32 v41, 0
  v_mov_b32 v42, 0
  v_mov_b32 v43, 0
  v_mov_b32 v44, 0
  v_mov_b32 v45, 0
  v_mov_b32 v46, 0
  v_mov_b32 v47, 0
  s_waitcnt vmcnt(36)
  s_barrier
  ds_read_b64_tr_b16 v[192:193], v237 offset:0
  ds_read_b64_tr_b16 v[194:195], v237 offset:256
  ds_read_b64_tr_b16 v[196:197], v238 offset:0
  ds_read_b64_tr_b16 v[198:199], v238 offset:256
  ds_read_b64_tr_b16 v[200:201], v239 offset:0
  ds_read_b64_tr_b16 v[202:203], v239 offset:256
  ds_read_b64_tr_b16 v[204:205], v237 offset:1024
  ds_read_b64_tr_b16 v[206:207], v237 offset:1280
  ds_read_b64_tr_b16 v[208:209], v238 offset:1024
  ds_read_b64_tr_b16 v[210:211], v238 offset:1280
  ds_read_b64_tr_b16 v[212:213], v239 offset:1024
  ds_read_b64_tr_b16 v[214:215], v239 offset:1280
  ds_read_b64_tr_b16 v[216:217], v237 offset:2048
  ds_read_b64_tr_b16 v[218:219], v237 offset:2304
  ds_read_b64_tr_b16 v[220:221], v238 offset:2048
  ds_read_b64_tr_b16 v[222:223], v238 offset:2304
  ds_read_b64_tr_b16 v[224:225], v239 offset:2048
  ds_read_b64_tr_b16 v[226:227], v239 offset:2304
  s_waitcnt vmcnt(35) lgkmcnt(12)
  v_mfma_f32_32x32x16_bf16 v[0:15], v[192:195], v[48:51], v[0:15]
  v_mfma_f32_32x32x16_bf16 v[16:31], v[196:199], v[48:51], v[16:31]
  v_mfma_f32_32x32x16_bf16 v[32:47], v[200:203], v[48:51], v[32:47]
  ds_read_b64_tr_b16 v[192:193], v237 offset:3072
  ds_read_b64_tr_b16 v[194:195], v237 offset:3328
  ds_read_b64_tr_b16 v[196:197], v238 offset:3072
  ds_read_b64_tr_b16 v[198:199], v238 offset:3328
  ds_read_b64_tr_b16 v[200:201], v239 offset:3072
  ds_read_b64_tr_b16 v[202:203], v239 offset:3328
  s_waitcnt vmcnt(34) lgkmcnt(12)
  v_mfma_f32_32x32x16_bf16 v[0:15], v[204:207], v[52:55], v[0:15]
  v_mfma_f32_32x32x16_bf16 v[16:31], v[208:211], v[52:55], v[16:31]
  v_mfma_f32_32x32x16_bf16 v[32:47], v[212:215], v[52:55], v[32:47]
  ds_read_b64_tr_b16 v[204:205], v237 offset:4096
  ds_read_b64_tr_b16 v[206:207], v237 offset:4352
  ds_read_b64_tr_b16 v[208:209], v238 offset:4096
  ds_read_b64_tr_b16 v[210:211], v238 offset:4352
  ds_read_b64_tr_b16 v[212:213], v239 offset:4096
  ds_read_b64_tr_b16 v[214:215], v239 offset:4352
  s_waitcnt vmcnt(33) lgkmcnt(12)
  v_mfma_f32_32x32x16_bf16 v[0:15], v[216:219], v[56:59], v[0:15]
  v_mfma_f32_32x32x16_bf16 v[16:31], v[220:223], v[56:59], v[16:31]
  v_mfma_f32_32x32x16_bf16 v[32:47], v[224:227], v[56:59], v[32:47]
  ds_read_b64_tr_b16 v[216:217], v237 offset:5120
  ds_read_b64_tr_b16 v[218:219], v237 offset:5376
  ds_read_b64_tr_b16 v[220:221], v238 offset:5120
  ds_read_b64_tr_b16 v[222:223], v238 offset:5376
  ds_read_b64_tr_b16 v[224:225], v239 offset:5120
  ds_read_b64_tr_b16 v[226:227], v239 offset:5376
  s_waitcnt vmcnt(32) lgkmcnt(12)
  v_mfma_f32_32x32x16_bf16 v[0:15], v[192:195], v[60:63], v[0:15]
  v_mfma_f32_32x32x16_bf16 v[16:31], v[196:199], v[60:63], v[16:31]
  v_mfma_f32_32x32x16_bf16 v[32:47], v[200:203], v[60:63], v[32:47]
  ds_read_b64_tr_b16 v[192:193], v237 offset:6144
  ds_read_b64_tr_b16 v[194:195], v237 offset:6400
  ds_read_b64_tr_b16 v[196:197], v238 offset:6144
  ds_read_b64_tr_b16 v[198:199], v238 offset:6400
  ds_read_b64_tr_b16 v[200:201], v239 offset:6144
  ds_read_b64_tr_b16 v[202:203], v239 offset:6400
  s_waitcnt vmcnt(31) lgkmcnt(12)
  v_mfma_f32_32x32x16_bf16 v[0:15], v[204:207], v[64:67], v[0:15]
  v_mfma_f32_32x32x16_bf16 v[16:31], v[208:211], v[64:67], v[16:31]
  v_mfma_f32_32x32x16_bf16 v[32:47], v[212:215], v[64:67], v[32:47]
  ds_read_b64_tr_b16 v[204:205], v237 offset:7168
  ds_read_b64_tr_b16 v[206:207], v237 offset:7424
  ds_read_b64_tr_b16 v[208:209], v238 offset:7168
  ds_read_b64_tr_b16 v[210:211], v238 offset:7424
  ds_read_b64_tr_b16 v[212:213], v239 offset:7168
  ds_read_b64_tr_b16 v[214:215], v239 offset:7424
  s_waitcnt vmcnt(30) lgkmcnt(12)
  v_mfma_f32_32x32x16_bf16 v[0:15], v[216:219], v[68:71], v[0:15]
  v_mfma_f32_32x32x16_bf16 v[16:31], v[220:223], v[68:71], v[16:31]
  v_mfma_f32_32x32x16_bf16 v[32:47], v[224:227], v[68:71], v[32:47]
  ds_read_b64_tr_b16 v[216:217], v237 offset:8192
  ds_read_b64_tr_b16 v[218:219], v237 offset:8448
  ds_read_b64_tr_b16 v[220:221], v238 offset:8192
  ds_read_b64_tr_b16 v[222:223], v238 offset:8448
  ds_read_b64_tr_b16 v[224:225], v239 offset:8192
  ds_read_b64_tr_b16 v[226:227], v239 offset:8448
  s_waitcnt vmcnt(29) lgkmcnt(12)
  v_mfma_f32_32x32x16_bf16 v[0:15], v[192:195], v[72:75], v[0:15]
  v_mfma_f32_32x32x16_bf16 v[16:31], v[196:199], v[72:75], v[16:31]
  v_mfma_f32_32x32x16_bf16 v[32:47], v[200:203], v[72:75], v[32:47]
  ds_read_b64_tr_b16 v[192:193], v237 offset:9216
  ds_read_b64_tr_b16 v[194:195], v237 offset:9472
  ds_read_b64_tr_b16 v[196:197], v238 offset:9216
  ds_read_b64_tr_b16 v[198:199], v238 offset:9472
  ds_read_b64_tr_b16 v[200:201], v239 offset:9216
  ds_read_b64_tr_b16 v[202:203], v239 offset:9472
  s_waitcnt vmcnt(28) lgkmcnt(12)
  v_mfma_f32_32x32x16_bf16 v[0:15], v[204:207], v[76:79], v[0:15]
  v_mfma_f32_32x32x16_bf16 v[16:31], v[208:211], v[76:79], v[16:31]
  v_mfma_f32_32x32x16_bf16 v[32:47], v[212:215], v[76:79], v[32:47]
  ds_read_b64_tr_b16 v[204:205], v237 offset:10240
  ds_read_b64_tr_b16 v[206:207], v237 offset:10496
  ds_read_b64_tr_b16 v[208:209], v238 offset:10240
  ds_read_b64_tr_b16 v[210:211], v238 offset:10496
  ds_read_b64_tr_b16 v[212:213], v239 offset:10240
  ds_read_b64_tr_b16 v[214:215], v239 offset:10496
  s_waitcnt vmcnt(27) lgkmcnt(12)
  v_mfma_f32_32x32x16_bf16 v[0:15], v[216:219], v[80:83], v[0:15]
  v_mfma_f32_32x32x16_bf16 v[16:31], v[220:223], v[80:83], v[16:31]
  v_mfma_f32_32x32x16_bf16 v[32:47], v[224:227], v[80:83], v[32:47]
  ds_read_b64_tr_b16 v[216:217], v237 offset:11264
  ds_read_b64_tr_b16 v[218:219], v237 offset:11520
  ds_read_b64_tr_b16 v[220:221], v238 offset:11264
  ds_read_b64_tr_b16 v[222:223], v238 offset:11520
  ds_read_b64_tr_b16 v[224:225], v239 offset:11264
  ds_read_b64_tr_b16 v[226:227], v239 offset:11520
  s_waitcnt vmcnt(26) lgkmcnt(12)
  v_mfma_f32_32x32x16_bf16 v[0:15], v[192:195], v[84:87], v[0:15]
  v_mfma_f32_32x32x16_bf16 v[16:31], v[196:199], v[84:87], v[16:31]
  v_mfma_f32_32x32x16_bf16 v[32:47], v[200:203], v[84:87], v[32:47]
  ds_read_b64_tr_b16 v[192:193], v237 offset:12288
  ds_read_b64_tr_b16 v[194:195], v237 offset:12544
  ds_read_b64_tr_b16 v[196:197], v238 offset:12288
  ds_read_b64_tr_b16 v[198:199], v238 offset:12544
  ds_read_b64_tr_b16 v[200:201], v239 offset:12288
  ds_read_b64_tr_b16 v[202:203], v239 offset:12544
  s_waitcnt vmcnt(25) lgkmcnt(12)
  v_mfma_f32_32x32x16_bf16 v[0:15], v[204:207], v[88:91], v[0:15]
  v_mfma_f32_32x32x16_bf16 v[16:31], v[208:211], v[88:91], v[16:31]
  v_mfma_f32_32x32x16_bf16 v[32:47], v[212:215], v[88:91], v[32:47]
  ds_read_b64_tr_b16 v[204:205], v237 offset:13312
  ds_read_b64_tr_b16 v[206:207], v237 offset:13568
  ds_read_b64_tr_b16 v[208:209], v238 offset:13312
  ds_read_b64_tr_b16 v[210:211], v238 offset:13568
  ds_read_b64_tr_b16 v[212:213], v239 offset:13312
  ds_read_b64_tr_b16 v[214:215], v239 offset:13568
  s_waitcnt vmcnt(24) lgkmcnt(12)
  v_mfma_f32_32x32x16_bf16 v[0:15], v[216:219], v[92:95], v[0:15]
  v_mfma_f32_32x32x16_bf16 v[16:31], v[220:223], v[92:95], v[16:31]
  v_mfma_f32_32x32x16_bf16 v[32:47], v[224:227], v[92:95], v[32:47]
  ds_read_b64_tr_b16 v[216:217], v237 offset:14336
  ds_read_b64_tr_b16 v[218:219], v237 offset:14592
  ds_read_b64_tr_b16 v[220:221], v238 offset:14336
  ds_read_b64_tr_b16 v[222:223], v238 offset:14592
  ds_read_b64_tr_b16 v[224:225], v239 offset:14336
  ds_read_b64_tr_b16 v[226:227], v239 offset:14592
  s_waitcnt vmcnt(23) lgkmcnt(12)
  v_mfma_f32_32x32x16_bf16 v[0:15], v[192:195], v[96:99], v[0:15]
  v_mfma_f32_32x32x16_bf16 v[16:31], v[196:199], v[96:99], v[16:31]
  v_mfma_f32_32x32x16_bf16 v[32:47], v[200:203], v[96:99], v[32:47]
  ds_read_b64_tr_b16 v[192:193], v237 offset:15360
  ds_read_b64_tr_b16 v[194:195], v237 offset:15616
  ds_read_b64_tr_b16 v[196:197], v238 offset:15360
  ds_read_b64_tr_b16 v[198:199], v238 offset:15616
  ds_read_b64_tr_b16 v[200:201], v239 offset:15360
  ds_read_b64_tr_b16 v[202:203], v239 offset:15616
  s_waitcnt vmcnt(22) lgkmcnt(12)
  v_mfma_f32_32x32x16_bf16 v[0:15], v[204:207], v[100:103], v[0:15]
  v_mfma_f32_32x32x16_bf16 v[16:31], v[208:211], v[100:103], v[16:31]
  v_mfma_f32_32x32x16_bf16 v[32:47], v[212:215], v[100:103], v[32:47]
  ds_read_b64_tr_b16 v[204:205], v237 offset:16384
  ds_read_b64_tr_b16 v[206:207], v237 offset:16640
  ds_read_b64_tr_b16 v[208:209], v238 offset:16384
  ds_read_b64_tr_b16 v[210:211], v238 offset:16640
  ds_read_b64_tr_b16 v[212:213], v239 offset:16384
  ds_read_b64_tr_b16 v[214:215], v239 offset:16640
  s_waitcnt vmcnt(21) lgkmcnt(12)
  v_mfma_f32_32x32x16_bf16 v[0:15], v[216:219], v[104:107], v[0:15]
  v_mfma_f32_32x32x16_bf16 v[16:31], v[220:223], v[104:107], v[16:31]
  v_mfma_f32_32x32x16_bf16 v[32:47], v[224:227], v[104:107], v[32:47]
  ds_read_b64_tr_b16 v[216:217], v237 offset:17408
  ds_read_b64_tr_b16 v[218:219], v237 offset:17664
  ds_read_b64_tr_b16 v[220:221], v238 offset:17408
  ds_read_b64_tr_b16 v[222:223], v238 offset:17664
  ds_read_b64_tr_b16 v[224:225], v239 offset:17408
  ds_read_b64_tr_b16 v[226:227], v239 offset:17664
  s_waitcnt vmcnt(20) lgkmcnt(12)
  v_mfma_f32_32x32x16_bf16 v[0:15], v[192:195], v[108:111], v[0:15]
  v_mfma_f32_32x32x16_bf16 v[16:31], v[196:199], v[108:111], v[16:31]
  v_mfma_f32_32x32x16_bf16 v[32:47], v[200:203], v[108:111], v[32:47]
  s_waitcnt vmcnt(19) lgkmcnt(6)
  v_mfma_f32_32x32x16_bf16 v[0:15], v[204:207], v[112:115], v[0:15]
  v_mfma_f32_32x32x16_bf16 v[16:31], v[208:211], v[112:115], v[16:31]
  v_mfma_f32_32x32x16_bf16 v[32:47], v[212:215], v[112:115], v[32:47]
  s_waitcnt vmcnt(18) lgkmcnt(0)
  v_mfma_f32_32x32x16_bf16 v[0:15], v[216:219], v[116:119], v[0:15]
  v_mfma_f32_32x32x16_bf16 v[16:31], v[220:223], v[116:119], v[16:31]
  v_mfma_f32_32x32x16_bf16 v[32:47], v[224:227], v[116:119], v[32:47]
  s_nop 15
  s_nop 3
  s_cmp_lg_u32 s58, 0
  s_cbranch_scc1 FN_K1
  ds_write_b128 v240, v[24:27] offset:0
  ds_write_b128 v240, v[28:31] offset:1024
  ds_write_b128 v240, v[32:35] offset:2048
  ds_write_b128 v240, v[36:39] offset:3072
  ds_write_b128 v240, v[40:43] offset:4096
  ds_write_b128 v240, v[44:47] offset:5120
  s_waitcnt lgkmcnt(0)
  s_barrier
  ds_read_b128 v[48:51], v241 offset:0
  ds_read_b128 v[52:55], v241 offset:1024
  ds_read_b128 v[56:59], v241 offset:2048
  ds_read_b128 v[60:63], v241 offset:3072
  ds_read_b128 v[64:67], v241 offset:4096
  ds_read_b128 v[68:71], v241 offset:5120
  s_waitcnt vmcnt(15)
  v_lshlrev_b32 v192, 16, v120
  v_and_b32 v193, 0xffff0000, v120
  v_add_f32 v0, v0, v192
  v_add_f32 v1, v1, v193
  v_lshlrev_b32 v192, 16, v121
  v_and_b32 v193, 0xffff0000, v121
  v_add_f32 v2, v2, v192
  v_add_f32 v3, v3, v193
  v_lshlrev_b32 v192, 16, v122
  v_and_b32 v193, 0xffff0000, v122
  v_add_f32 v4, v4, v192
  v_add_f32 v5, v5, v193
  v_lshlrev_b32 v192, 16, v123
  v_and_b32 v193, 0xffff0000, v123
  v_add_f32 v6, v6, v192
  v_add_f32 v7, v7, v193
  v_lshlrev_b32 v192, 16, v124
  v_and_b32 v193, 0xffff0000, v124
  v_add_f32 v8, v8, v192
  v_add_f32 v9, v9, v193
  v_lshlrev_b32 v192, 16, v125
  v_and_b32 v193, 0xffff0000, v125
  v_add_f32 v10, v10, v192
  v_add_f32 v11, v11, v193
  v_lshlrev_b32 v192, 16, v126
  v_and_b32 v193, 0xffff0000, v126
  v_add_f32 v12, v12, v192
  v_add_f32 v13, v13, v193
  v_lshlrev_b32 v192, 16, v127
  v_and_b32 v193, 0xffff0000, v127
  v_add_f32 v14, v14, v192
  v_add_f32 v15, v15, v193
  v_lshlrev_b32 v192, 16, v128
  v_and_b32 v193, 0xffff0000, v128
  v_add_f32 v16, v16, v192
  v_add_f32 v17, v17, v193
  v_lshlrev_b32 v192, 16, v129
  v_and_b32 v193, 0xffff0000, v129
  v_add_f32 v18, v18, v192
  v_add_f32 v19, v19, v193
  v_lshlrev_b32 v192, 16, v130
  v_and_b32 v193, 0xffff0000, v130
  v_add_f32 v20, v20, v192
  v_add_f32 v21, v21, v193
  v_lshlrev_b32 v192, 16, v131
  v_and_b32 v193, 0xffff0000, v131
  v_add_f32 v22, v22, v192
  v_add_f32 v23, v23, v193
  s_waitcnt vmcnt(12)
  v_lshlrev_b32 v192, 16, v132
  v_and_b32 v193, 0xffff0000, v132
  v_add_f32 v0, v0, v192
  v_add_f32 v1, v1, v193
  v_lshlrev_b32 v192, 16, v133
  v_and_b32 v193, 0xffff0000, v133
  v_add_f32 v2, v2, v192
  v_add_f32 v3, v3, v193
  v_lshlrev_b32 v192, 16, v134
  v_and_b32 v193, 0xffff0000, v134
  v_add_f32 v4, v4, v192
  v_add_f32 v5, v5, v193
  v_lshlrev_b32 v192, 16, v135
  v_and_b32 v193, 0xffff0000, v135
  v_add_f32 v6, v6, v192
  v_add_f32 v7, v7, v193
  v_lshlrev_b32 v192, 16, v136
  v_and_b32 v193, 0xffff0000, v136
  v_add_f32 v8, v8, v192
  v_add_f32 v9, v9, v193
  v_lshlrev_b32 v192, 16, v137
  v_and_b32 v193, 0xffff0000, v137
  v_add_f32 v10, v10, v192
  v_add_f32 v11, v11, v193
  v_lshlrev_b32 v192, 16, v138
  v_and_b32 v193, 0xffff0000, v138
  v_add_f32 v12, v12, v192
  v_add_f32 v13, v13, v193
  v_lshlrev_b32 v192, 16, v139
  v_and_b32 v193, 0xffff0000, v139
  v_add_f32 v14, v14, v192
  v_add_f32 v15, v15, v193
  v_lshlrev_b32 v192, 16, v140
  v_and_b32 v193, 0xffff0000, v140
  v_add_f32 v16, v16, v192
  v_add_f32 v17, v17, v193
  v_lshlrev_b32 v192, 16, v141
  v_and_b32 v193, 0xffff0000, v141
  v_add_f32 v18, v18, v192
  v_add_f32 v19, v19, v193
  v_lshlrev_b32 v192, 16, v142
  v_and_b32 v193, 0xffff0000, v142
  v_add_f32 v20, v20, v192
  v_add_f32 v21, v21, v193
  v_lshlrev_b32 v192, 16, v143
  v_and_b32 v193, 0xffff0000, v143
  v_add_f32 v22, v22, v192
  v_add_f32 v23, v23, v193
  s_waitcnt vmcnt(9)
  v_lshlrev_b32 v192, 16, v144
  v_and_b32 v193, 0xffff0000, v144
  v_add_f32 v0, v0, v192
  v_add_f32 v1, v1, v193
  v_lshlrev_b32 v192, 16, v145
  v_and_b32 v193, 0xffff0000, v145
  v_add_f32 v2, v2, v192
  v_add_f32 v3, v3, v193
  v_lshlrev_b32 v192, 16, v146
  v_and_b32 v193, 0xffff0000, v146
  v_add_f32 v4, v4, v192
  v_add_f32 v5, v5, v193
  v_lshlrev_b32 v192, 16, v147
  v_and_b32 v193, 0xffff0000, v147
  v_add_f32 v6, v6, v192
  v_add_f32 v7, v7, v193
  v_lshlrev_b32 v192, 16, v148
  v_and_b32 v193, 0xffff0000, v148
  v_add_f32 v8, v8, v192
  v_add_f32 v9, v9, v193
  v_lshlrev_b32 v192, 16, v149
  v_and_b32 v193, 0xffff0000, v149
  v_add_f32 v10, v10, v192
  v_add_f32 v11, v11, v193
  v_lshlrev_b32 v192, 16, v150
  v_and_b32 v193, 0xffff0000, v150
  v_add_f32 v12, v12, v192
  v_add_f32 v13, v13, v193
  v_lshlrev_b32 v192, 16, v151
  v_and_b32 v193, 0xffff0000, v151
  v_add_f32 v14, v14, v192
  v_add_f32 v15, v15, v193
  v_lshlrev_b32 v192, 16, v152
  v_and_b32 v193, 0xffff0000, v152
  v_add_f32 v16, v16, v192
  v_add_f32 v17, v17, v193
  v_lshlrev_b32 v192, 16, v153
  v_and_b32 v193, 0xffff0000, v153
  v_add_f32 v18, v18, v192
  v_add_f32 v19, v19, v193
  v_lshlrev_b32 v192, 16, v154
  v_and_b32 v193, 0xffff0000, v154
  v_add_f32 v20, v20, v192
  v_add_f32 v21, v21, v193
  v_lshlrev_b32 v192, 16, v155
  v_and_b32 v193, 0xffff0000, v155
  v_add_f32 v22, v22, v192
  v_add_f32 v23, v23, v193
  s_waitcnt vmcnt(6)
  v_lshlrev_b32 v192, 16, v156
  v_and_b32 v193, 0xffff0000, v156
  v_add_f32 v0, v0, v192
  v_add_f32 v1, v1, v193
  v_lshlrev_b32 v192, 16, v157
  v_and_b32 v193, 0xffff0000, v157
  v_add_f32 v2, v2, v192
  v_add_f32 v3, v3, v193
  v_lshlrev_b32 v192, 16, v158
  v_and_b32 v193, 0xffff0000, v158
  v_add_f32 v4, v4, v192
  v_add_f32 v5, v5, v193
  v_lshlrev_b32 v192, 16, v159
  v_and_b32 v193, 0xffff0000, v159
  v_add_f32 v6, v6, v192
  v_add_f32 v7, v7, v193
  v_lshlrev_b32 v192, 16, v160
  v_and_b32 v193, 0xffff0000, v160
  v_add_f32 v8, v8, v192
  v_add_f32 v9, v9, v193
  v_lshlrev_b32 v192, 16, v161
  v_and_b32 v193, 0xffff0000, v161
  v_add_f32 v10, v10, v192
  v_add_f32 v11, v11, v193
  v_lshlrev_b32 v192, 16, v162
  v_and_b32 v193, 0xffff0000, v162
  v_add_f32 v12, v12, v192
  v_add_f32 v13, v13, v193
  v_lshlrev_b32 v192, 16, v163
  v_and_b32 v193, 0xffff0000, v163
  v_add_f32 v14, v14, v192
  v_add_f32 v15, v15, v193
  v_lshlrev_b32 v192, 16, v164
  v_and_b32 v193, 0xffff0000, v164
  v_add_f32 v16, v16, v192
  v_add_f32 v17, v17, v193
  v_lshlrev_b32 v192, 16, v165
  v_and_b32 v193, 0xffff0000, v165
  v_add_f32 v18, v18, v192
  v_add_f32 v19, v19, v193
  v_lshlrev_b32 v192, 16, v166
  v_and_b32 v193, 0xffff0000, v166
  v_add_f32 v20, v20, v192
  v_add_f32 v21, v21, v193
  v_lshlrev_b32 v192, 16, v167
  v_and_b32 v193, 0xffff0000, v167
  v_add_f32 v22, v22, v192
  v_add_f32 v23, v23, v193
  s_waitcnt vmcnt(3)
  v_lshlrev_b32 v192, 16, v168
  v_and_b32 v193, 0xffff0000, v168
  v_add_f32 v0, v0, v192
  v_add_f32 v1, v1, v193
  v_lshlrev_b32 v192, 16, v169
  v_and_b32 v193, 0xffff0000, v169
  v_add_f32 v2, v2, v192
  v_add_f32 v3, v3, v193
  v_lshlrev_b32 v192, 16, v170
  v_and_b32 v193, 0xffff0000, v170
  v_add_f32 v4, v4, v192
  v_add_f32 v5, v5, v193
  v_lshlrev_b32 v192, 16, v171
  v_and_b32 v193, 0xffff0000, v171
  v_add_f32 v6, v6, v192
  v_add_f32 v7, v7, v193
  v_lshlrev_b32 v192, 16, v172
  v_and_b32 v193, 0xffff0000, v172
  v_add_f32 v8, v8, v192
  v_add_f32 v9, v9, v193
  v_lshlrev_b32 v192, 16, v173
  v_and_b32 v193, 0xffff0000, v173
  v_add_f32 v10, v10, v192
  v_add_f32 v11, v11, v193
  v_lshlrev_b32 v192, 16, v174
  v_and_b32 v193, 0xffff0000, v174
  v_add_f32 v12, v12, v192
  v_add_f32 v13, v13, v193
  v_lshlrev_b32 v192, 16, v175
  v_and_b32 v193, 0xffff0000, v175
  v_add_f32 v14, v14, v192
  v_add_f32 v15, v15, v193
  v_lshlrev_b32 v192, 16, v176
  v_and_b32 v193, 0xffff0000, v176
  v_add_f32 v16, v16, v192
  v_add_f32 v17, v17, v193
  v_lshlrev_b32 v192, 16, v177
  v_and_b32 v193, 0xffff0000, v177
  v_add_f32 v18, v18, v192
  v_add_f32 v19, v19, v193
  v_lshlrev_b32 v192, 16, v178
  v_and_b32 v193, 0xffff0000, v178
  v_add_f32 v20, v20, v192
  v_add_f32 v21, v21, v193
  v_lshlrev_b32 v192, 16, v179
  v_and_b32 v193, 0xffff0000, v179
  v_add_f32 v22, v22, v192
  v_add_f32 v23, v23, v193
  s_waitcnt lgkmcnt(0)
  v_add_f32 v0, v0, v48
  v_add_f32 v1, v1, v49
  v_add_f32 v2, v2, v50
  v_add_f32 v3, v3, v51
  v_add_f32 v4, v4, v52
  v_add_f32 v5, v5, v53
  v_add_f32 v6, v6, v54
  v_add_f32 v7, v7, v55
  v_add_f32 v8, v8, v56
  v_add_f32 v9, v9, v57
  v_add_f32 v10, v10, v58
  v_add_f32 v11, v11, v59
  v_add_f32 v12, v12, v60
  v_add_f32 v13, v13, v61
  v_add_f32 v14, v14, v62
  v_add_f32 v15, v15, v63
  v_add_f32 v16, v16, v64
  v_add_f32 v17, v17, v65
  v_add_f32 v18, v18, v66
  v_add_f32 v19, v19, v67
  v_add_f32 v20, v20, v68
  v_add_f32 v21, v21, v69
  v_add_f32 v22, v22, v70
  v_add_f32 v23, v23, v71
  s_nop 1
  v_permlane32_swap_b32 v0, v4
  v_permlane32_swap_b32 v1, v5
  v_permlane32_swap_b32 v2, v6
  v_permlane32_swap_b32 v3, v7
  v_permlane32_swap_b32 v8, v12
  v_permlane32_swap_b32 v9, v13
  v_permlane32_swap_b32 v10, v14
  v_permlane32_swap_b32 v11, v15
  v_permlane32_swap_b32 v16, v20
  v_permlane32_swap_b32 v17, v21
  v_permlane32_swap_b32 v18, v22
  v_permlane32_swap_b32 v19, v23
  s_nop 1
  s_waitcnt vmcnt(0)
  v_lshlrev_b32 v192, 16, v180
  v_and_b32 v193, 0xffff0000, v180
  v_add_f32 v0, v0, v192
  v_add_f32 v1, v1, v193
  v_cvt_pk_bf16_f32 v180, v0, v1
  v_lshlrev_b32 v192, 16, v181
  v_and_b32 v193, 0xffff0000, v181
  v_add_f32 v2, v2, v192
  v_add_f32 v3, v3, v193
  v_cvt_pk_bf16_f32 v181, v2, v3
  v_lshlrev_b32 v192, 16, v182
  v_and_b32 v193, 0xffff0000, v182
  v_add_f32 v4, v4, v192
  v_add_f32 v5, v5, v193
  v_cvt_pk_bf16_f32 v182, v4, v5
  v_lshlrev_b32 v192, 16, v183
  v_and_b32 v193, 0xffff0000, v183
  v_add_f32 v6, v6, v192
  v_add_f32 v7, v7, v193
  v_cvt_pk_bf16_f32 v183, v6, v7
  buffer_store_dwordx4 v[180:183], v235, s[20:23], 0 offen offset:0
  v_lshlrev_b32 v192, 16, v184
  v_and_b32 v193, 0xffff0000, v184
  v_add_f32 v8, v8, v192
  v_add_f32 v9, v9, v193
  v_cvt_pk_bf16_f32 v184, v8, v9
  v_lshlrev_b32 v192, 16, v185
  v_and_b32 v193, 0xffff0000, v185
  v_add_f32 v10, v10, v192
  v_add_f32 v11, v11, v193
  v_cvt_pk_bf16_f32 v185, v10, v11
  v_lshlrev_b32 v192, 16, v186
  v_and_b32 v193, 0xffff0000, v186
  v_add_f32 v12, v12, v192
  v_add_f32 v13, v13, v193
  v_cvt_pk_bf16_f32 v186, v12, v13
  v_lshlrev_b32 v192, 16, v187
  v_and_b32 v193, 0xffff0000, v187
  v_add_f32 v14, v14, v192
  v_add_f32 v15, v15, v193
  v_cvt_pk_bf16_f32 v187, v14, v15
  buffer_store_dwordx4 v[184:187], v235, s[20:23], 0 offen offset:32
  v_lshlrev_b32 v192, 16, v188
  v_and_b32 v193, 0xffff0000, v188
  v_add_f32 v16, v16, v192
  v_add_f32 v17, v17, v193
  v_cvt_pk_bf16_f32 v188, v16, v17
  v_lshlrev_b32 v192, 16, v189
  v_and_b32 v193, 0xffff0000, v189
  v_add_f32 v18, v18, v192
  v_add_f32 v19, v19, v193
  v_cvt_pk_bf16_f32 v189, v18, v19
  v_lshlrev_b32 v192, 16, v190
  v_and_b32 v193, 0xffff0000, v190
  v_add_f32 v20, v20, v192
  v_add_f32 v21, v21, v193
  v_cvt_pk_bf16_f32 v190, v20, v21
  v_lshlrev_b32 v192, 16, v191
  v_and_b32 v193, 0xffff0000, v191
  v_add_f32 v22, v22, v192
  v_add_f32 v23, v23, v193
  v_cvt_pk_bf16_f32 v191, v22, v23
  buffer_store_dwordx4 v[188:191], v235, s[20:23], 0 offen offset:64
  s_endpgm
FN_K1:
  ds_write_b128 v240, v[0:3] offset:0
  ds_write_b128 v240, v[4:7] offset:1024
  ds_write_b128 v240, v[8:11] offset:2048
  ds_write_b128 v240, v[12:15] offset:3072
  ds_write_b128 v240, v[16:19] offset:4096
  ds_write_b128 v240, v[20:23] offset:5120
  s_waitcnt lgkmcnt(0)
  s_barrier
  ds_read_b128 v[48:51], v241 offset:0
  ds_read_b128 v[52:55], v241 offset:1024
  ds_read_b128 v[56:59], v241 offset:2048
  ds_read_b128 v[60:63], v241 offset:3072
  ds_read_b128 v[64:67], v241 offset:4096
  ds_read_b128 v[68:71], v241 offset:5120
  s_waitcnt vmcnt(15)
  v_lshlrev_b32 v192, 16, v120
  v_and_b32 v193, 0xffff0000, v120
  v_add_f32 v24, v24, v192
  v_add_f32 v25, v25, v193
  v_lshlrev_b32 v192, 16, v121
  v_and_b32 v193, 0xffff0000, v121
  v_add_f32 v26, v26, v192
  v_add_f32 v27, v27, v193
  v_lshlrev_b32 v192, 16, v122
  v_and_b32 v193, 0xffff0000, v122
  v_add_f32 v28, v28, v192
  v_add_f32 v29, v29, v193
  v_lshlrev_b32 v192, 16, v123
  v_and_b32 v193, 0xffff0000, v123
  v_add_f32 v30, v30, v192
  v_add_f32 v31, v31, v193
  v_lshlrev_b32 v192, 16, v124
  v_and_b32 v193, 0xffff0000, v124
  v_add_f32 v32, v32, v192
  v_add_f32 v33, v33, v193
  v_lshlrev_b32 v192, 16, v125
  v_and_b32 v193, 0xffff0000, v125
  v_add_f32 v34, v34, v192
  v_add_f32 v35, v35, v193
  v_lshlrev_b32 v192, 16, v126
  v_and_b32 v193, 0xffff0000, v126
  v_add_f32 v36, v36, v192
  v_add_f32 v37, v37, v193
  v_lshlrev_b32 v192, 16, v127
  v_and_b32 v193, 0xffff0000, v127
  v_add_f32 v38, v38, v192
  v_add_f32 v39, v39, v193
  v_lshlrev_b32 v192, 16, v128
  v_and_b32 v193, 0xffff0000, v128
  v_add_f32 v40, v40, v192
  v_add_f32 v41, v41, v193
  v_lshlrev_b32 v192, 16, v129
  v_and_b32 v193, 0xffff0000, v129
  v_add_f32 v42, v42, v192
  v_add_f32 v43, v43, v193
  v_lshlrev_b32 v192, 16, v130
  v_and_b32 v193, 0xffff0000, v130
  v_add_f32 v44, v44, v192
  v_add_f32 v45, v45, v193
  v_lshlrev_b32 v192, 16, v131
  v_and_b32 v193, 0xffff0000, v131
  v_add_f32 v46, v46, v192
  v_add_f32 v47, v47, v193
  s_waitcnt vmcnt(12)
  v_lshlrev_b32 v192, 16, v132
  v_and_b32 v193, 0xffff0000, v132
  v_add_f32 v24, v24, v192
  v_add_f32 v25, v25, v193
  v_lshlrev_b32 v192, 16, v133
  v_and_b32 v193, 0xffff0000, v133
  v_add_f32 v26, v26, v192
  v_add_f32 v27, v27, v193
  v_lshlrev_b32 v192, 16, v134
  v_and_b32 v193, 0xffff0000, v134
  v_add_f32 v28, v28, v192
  v_add_f32 v29, v29, v193
  v_lshlrev_b32 v192, 16, v135
  v_and_b32 v193, 0xffff0000, v135
  v_add_f32 v30, v30, v192
  v_add_f32 v31, v31, v193
  v_lshlrev_b32 v192, 16, v136
  v_and_b32 v193, 0xffff0000, v136
  v_add_f32 v32, v32, v192
  v_add_f32 v33, v33, v193
  v_lshlrev_b32 v192, 16, v137
  v_and_b32 v193, 0xffff0000, v137
  v_add_f32 v34, v34, v192
  v_add_f32 v35, v35, v193
  v_lshlrev_b32 v192, 16, v138
  v_and_b32 v193, 0xffff0000, v138
  v_add_f32 v36, v36, v192
  v_add_f32 v37, v37, v193
  v_lshlrev_b32 v192, 16, v139
  v_and_b32 v193, 0xffff0000, v139
  v_add_f32 v38, v38, v192
  v_add_f32 v39, v39, v193
  v_lshlrev_b32 v192, 16, v140
  v_and_b32 v193, 0xffff0000, v140
  v_add_f32 v40, v40, v192
  v_add_f32 v41, v41, v193
  v_lshlrev_b32 v192, 16, v141
  v_and_b32 v193, 0xffff0000, v141
  v_add_f32 v42, v42, v192
  v_add_f32 v43, v43, v193
  v_lshlrev_b32 v192, 16, v142
  v_and_b32 v193, 0xffff0000, v142
  v_add_f32 v44, v44, v192
  v_add_f32 v45, v45, v193
  v_lshlrev_b32 v192, 16, v143
  v_and_b32 v193, 0xffff0000, v143
  v_add_f32 v46, v46, v192
  v_add_f32 v47, v47, v193
  s_waitcnt vmcnt(9)
  v_lshlrev_b32 v192, 16, v144
  v_and_b32 v193, 0xffff0000, v144
  v_add_f32 v24, v24, v192
  v_add_f32 v25, v25, v193
  v_lshlrev_b32 v192, 16, v145
  v_and_b32 v193, 0xffff0000, v145
  v_add_f32 v26, v26, v192
  v_add_f32 v27, v27, v193
  v_lshlrev_b32 v192, 16, v146
  v_and_b32 v193, 0xffff0000, v146
  v_add_f32 v28, v28, v192
  v_add_f32 v29, v29, v193
  v_lshlrev_b32 v192, 16, v147
  v_and_b32 v193, 0xffff0000, v147
  v_add_f32 v30, v30, v192
  v_add_f32 v31, v31, v193
  v_lshlrev_b32 v192, 16, v148
  v_and_b32 v193, 0xffff0000, v148
  v_add_f32 v32, v32, v192
  v_add_f32 v33, v33, v193
  v_lshlrev_b32 v192, 16, v149
  v_and_b32 v193, 0xffff0000, v149
  v_add_f32 v34, v34, v192
  v_add_f32 v35, v35, v193
  v_lshlrev_b32 v192, 16, v150
  v_and_b32 v193, 0xffff0000, v150
  v_add_f32 v36, v36, v192
  v_add_f32 v37, v37, v193
  v_lshlrev_b32 v192, 16, v151
  v_and_b32 v193, 0xffff0000, v151
  v_add_f32 v38, v38, v192
  v_add_f32 v39, v39, v193
  v_lshlrev_b32 v192, 16, v152
  v_and_b32 v193, 0xffff0000, v152
  v_add_f32 v40, v40, v192
  v_add_f32 v41, v41, v193
  v_lshlrev_b32 v192, 16, v153
  v_and_b32 v193, 0xffff0000, v153
  v_add_f32 v42, v42, v192
  v_add_f32 v43, v43, v193
  v_lshlrev_b32 v192, 16, v154
  v_and_b32 v193, 0xffff0000, v154
  v_add_f32 v44, v44, v192
  v_add_f32 v45, v45, v193
  v_lshlrev_b32 v192, 16, v155
  v_and_b32 v193, 0xffff0000, v155
  v_add_f32 v46, v46, v192
  v_add_f32 v47, v47, v193
  s_waitcnt vmcnt(6)
  v_lshlrev_b32 v192, 16, v156
  v_and_b32 v193, 0xffff0000, v156
  v_add_f32 v24, v24, v192
  v_add_f32 v25, v25, v193
  v_lshlrev_b32 v192, 16, v157
  v_and_b32 v193, 0xffff0000, v157
  v_add_f32 v26, v26, v192
  v_add_f32 v27, v27, v193
  v_lshlrev_b32 v192, 16, v158
  v_and_b32 v193, 0xffff0000, v158
  v_add_f32 v28, v28, v192
  v_add_f32 v29, v29, v193
  v_lshlrev_b32 v192, 16, v159
  v_and_b32 v193, 0xffff0000, v159
  v_add_f32 v30, v30, v192
  v_add_f32 v31, v31, v193
  v_lshlrev_b32 v192, 16, v160
  v_and_b32 v193, 0xffff0000, v160
  v_add_f32 v32, v32, v192
  v_add_f32 v33, v33, v193
  v_lshlrev_b32 v192, 16, v161
  v_and_b32 v193, 0xffff0000, v161
  v_add_f32 v34, v34, v192
  v_add_f32 v35, v35, v193
  v_lshlrev_b32 v192, 16, v162
  v_and_b32 v193, 0xffff0000, v162
  v_add_f32 v36, v36, v192
  v_add_f32 v37, v37, v193
  v_lshlrev_b32 v192, 16, v163
  v_and_b32 v193, 0xffff0000, v163
  v_add_f32 v38, v38, v192
  v_add_f32 v39, v39, v193
  v_lshlrev_b32 v192, 16, v164
  v_and_b32 v193, 0xffff0000, v164
  v_add_f32 v40, v40, v192
  v_add_f32 v41, v41, v193
  v_lshlrev_b32 v192, 16, v165
  v_and_b32 v193, 0xffff0000, v165
  v_add_f32 v42, v42, v192
  v_add_f32 v43, v43, v193
  v_lshlrev_b32 v192, 16, v166
  v_and_b32 v193, 0xffff0000, v166
  v_add_f32 v44, v44, v192
  v_add_f32 v45, v45, v193
  v_lshlrev_b32 v192, 16, v167
  v_and_b32 v193, 0xffff0000, v167
  v_add_f32 v46, v46, v192
  v_add_f32 v47, v47, v193
  s_waitcnt vmcnt(3)
  v_lshlrev_b32 v192, 16, v168
  v_and_b32 v193, 0xffff0000, v168
  v_add_f32 v24, v24, v192
  v_add_f32 v25, v25, v193
  v_lshlrev_b32 v192, 16, v169
  v_and_b32 v193, 0xffff0000, v169
  v_add_f32 v26, v26, v192
  v_add_f32 v27, v27, v193
  v_lshlrev_b32 v192, 16, v170
  v_and_b32 v193, 0xffff0000, v170
  v_add_f32 v28, v28, v192
  v_add_f32 v29, v29, v193
  v_lshlrev_b32 v192, 16, v171
  v_and_b32 v193, 0xffff0000, v171
  v_add_f32 v30, v30, v192
  v_add_f32 v31, v31, v193
  v_lshlrev_b32 v192, 16, v172
  v_and_b32 v193, 0xffff0000, v172
  v_add_f32 v32, v32, v192
  v_add_f32 v33, v33, v193
  v_lshlrev_b32 v192, 16, v173
  v_and_b32 v193, 0xffff0000, v173
  v_add_f32 v34, v34, v192
  v_add_f32 v35, v35, v193
  v_lshlrev_b32 v192, 16, v174
  v_and_b32 v193, 0xffff0000, v174
  v_add_f32 v36, v36, v192
  v_add_f32 v37, v37, v193
  v_lshlrev_b32 v192, 16, v175
  v_and_b32 v193, 0xffff0000, v175
  v_add_f32 v38, v38, v192
  v_add_f32 v39, v39, v193
  v_lshlrev_b32 v192, 16, v176
  v_and_b32 v193, 0xffff0000, v176
  v_add_f32 v40, v40, v192
  v_add_f32 v41, v41, v193
  v_lshlrev_b32 v192, 16, v177
  v_and_b32 v193, 0xffff0000, v177
  v_add_f32 v42, v42, v192
  v_add_f32 v43, v43, v193
  v_lshlrev_b32 v192, 16, v178
  v_and_b32 v193, 0xffff0000, v178
  v_add_f32 v44, v44, v192
  v_add_f32 v45, v45, v193
  v_lshlrev_b32 v192, 16, v179
  v_and_b32 v193, 0xffff0000, v179
  v_add_f32 v46, v46, v192
  v_add_f32 v47, v47, v193
  s_waitcnt lgkmcnt(0)
  v_add_f32 v24, v24, v48
  v_add_f32 v25, v25, v49
  v_add_f32 v26, v26, v50
  v_add_f32 v27, v27, v51
  v_add_f32 v28, v28, v52
  v_add_f32 v29, v29, v53
  v_add_f32 v30, v30, v54
  v_add_f32 v31, v31, v55
  v_add_f32 v32, v32, v56
  v_add_f32 v33, v33, v57
  v_add_f32 v34, v34, v58
  v_add_f32 v35, v35, v59
  v_add_f32 v36, v36, v60
  v_add_f32 v37, v37, v61
  v_add_f32 v38, v38, v62
  v_add_f32 v39, v39, v63
  v_add_f32 v40, v40, v64
  v_add_f32 v41, v41, v65
  v_add_f32 v42, v42, v66
  v_add_f32 v43, v43, v67
  v_add_f32 v44, v44, v68
  v_add_f32 v45, v45, v69
  v_add_f32 v46, v46, v70
  v_add_f32 v47, v47, v71
  s_nop 1
  v_permlane32_swap_b32 v24, v28
  v_permlane32_swap_b32 v25, v29
  v_permlane32_swap_b32 v26, v30
  v_permlane32_swap_b32 v27, v31
  v_permlane32_swap_b32 v32, v36
  v_permlane32_swap_b32 v33, v37
  v_permlane32_swap_b32 v34, v38
  v_permlane32_swap_b32 v35, v39
  v_permlane32_swap_b32 v40, v44
  v_permlane32_swap_b32 v41, v45
  v_permlane32_swap_b32 v42, v46
  v_permlane32_swap_b32 v43, v47
  s_nop 1
  s_waitcnt vmcnt(0)
  v_lshlrev_b32 v192, 16, v180
  v_and_b32 v193, 0xffff0000, v180
  v_add_f32 v24, v24, v192
  v_add_f32 v25, v25, v193
  v_cvt_pk_bf16_f32 v180, v24, v25
  v_lshlrev_b32 v192, 16, v181
  v_and_b32 v193, 0xffff0000, v181
  v_add_f32 v26, v26, v192
  v_add_f32 v27, v27, v193
  v_cvt_pk_bf16_f32 v181, v26, v27
  v_lshlrev_b32 v192, 16, v182
  v_and_b32 v193, 0xffff0000, v182
  v_add_f32 v28, v28, v192
  v_add_f32 v29, v29, v193
  v_cvt_pk_bf16_f32 v182, v28, v29
  v_lshlrev_b32 v192, 16, v183
  v_and_b32 v193, 0xffff0000, v183
  v_add_f32 v30, v30, v192
  v_add_f32 v31, v31, v193
  v_cvt_pk_bf16_f32 v183, v30, v31
  buffer_store_dwordx4 v[180:183], v235, s[20:23], 0 offen offset:0
  v_lshlrev_b32 v192, 16, v184
  v_and_b32 v193, 0xffff0000, v184
  v_add_f32 v32, v32, v192
  v_add_f32 v33, v33, v193
  v_cvt_pk_bf16_f32 v184, v32, v33
  v_lshlrev_b32 v192, 16, v185
  v_and_b32 v193, 0xffff0000, v185
  v_add_f32 v34, v34, v192
  v_add_f32 v35, v35, v193
  v_cvt_pk_bf16_f32 v185, v34, v35
  v_lshlrev_b32 v192, 16, v186
  v_and_b32 v193, 0xffff0000, v186
  v_add_f32 v36, v36, v192
  v_add_f32 v37, v37, v193
  v_cvt_pk_bf16_f32 v186, v36, v37
  v_lshlrev_b32 v192, 16, v187
  v_and_b32 v193, 0xffff0000, v187
  v_add_f32 v38, v38, v192
  v_add_f32 v39, v39, v193
  v_cvt_pk_bf16_f32 v187, v38, v39
  buffer_store_dwordx4 v[184:187], v235, s[20:23], 0 offen offset:32
  v_lshlrev_b32 v192, 16, v188
  v_and_b32 v193, 0xffff0000, v188
  v_add_f32 v40, v40, v192
  v_add_f32 v41, v41, v193
  v_cvt_pk_bf16_f32 v188, v40, v41
  v_lshlrev_b32 v192, 16, v189
  v_and_b32 v193, 0xffff0000, v189
  v_add_f32 v42, v42, v192
  v_add_f32 v43, v43, v193
  v_cvt_pk_bf16_f32 v189, v42, v43
  v_lshlrev_b32 v192, 16, v190
  v_and_b32 v193, 0xffff0000, v190
  v_add_f32 v44, v44, v192
  v_add_f32 v45, v45, v193
  v_cvt_pk_bf16_f32 v190, v44, v45
  v_lshlrev_b32 v192, 16, v191
  v_and_b32 v193, 0xffff0000, v191
  v_add_f32 v46, v46, v192
  v_add_f32 v47, v47, v193
  v_cvt_pk_bf16_f32 v191, v46, v47
  buffer_store_dwordx4 v[188:191], v235, s[20:23], 0 offen offset:64
  s_endpgm
FN_END:
  s_endpgm
.section .rodata,"a"
.p2align 6
.amdhsa_kernel ln_kernel
  .amdhsa_next_free_vgpr 80
  .amdhsa_next_free_sgpr 102
  .amdhsa_accum_offset 80
  .amdhsa_group_segment_fixed_size 0
  .amdhsa_kernarg_size 80
  .amdhsa_user_sgpr_count 2
  .amdhsa_user_sgpr_kernarg_segment_ptr 1
  .amdhsa_system_sgpr_workgroup_id_x 1
.end_amdhsa_kernel
.section .rodata,"a"
.p2align 6
.amdhsa_kernel gemm1_kernel
  .amdhsa_next_free_vgpr 256
  .amdhsa_next_free_sgpr 102
  .amdhsa_accum_offset 256
  .amdhsa_group_segment_fixed_size 0
  .amdhsa_kernarg_size 80
  .amdhsa_user_sgpr_count 2
  .amdhsa_user_sgpr_kernarg_segment_ptr 1
  .amdhsa_system_sgpr_workgroup_id_x 1
.end_amdhsa_kernel
.section .rodata,"a"
.p2align 6
.amdhsa_kernel attn_kernel
  .amdhsa_next_free_vgpr 128
  .amdhsa_next_free_sgpr 102
  .amdhsa_accum_offset 128
  .amdhsa_group_segment_fixed_size 0
  .amdhsa_kernarg_size 80
  .amdhsa_user_sgpr_count 2
  .amdhsa_user_sgpr_kernarg_segment_ptr 1
  .amdhsa_system_sgpr_workgroup_id_x 1
.end_amdhsa_kernel
.section .rodata,"a"
.p2align 6
.amdhsa_kernel fin_kernel
  .amdhsa_next_free_vgpr 244
  .amdhsa_next_free_sgpr 102
  .amdhsa_accum_offset 244
  .amdhsa_group_segment_fixed_size 0
  .amdhsa_kernarg_size 80
  .amdhsa_user_sgpr_count 2
  .amdhsa_user_sgpr_kernarg_segment_ptr 1
  .amdhsa_system_sgpr_workgroup_id_x 1
.end_amdhsa_kernel
```
